```python
import torch

def _softmax(x, axis=-1):
    return torch.softmax(x, dim=axis)
def _gelu(x):
    return torch.nn.functional.gelu(x, approximate="tanh")
def _silu(x):
    return torch.nn.functional.silu(x)
def _sigmoid(x):
    return torch.sigmoid(x)
def _layernorm(x, axis=-1, eps=1e-5):
    m = x.mean(dim=axis, keepdim=True)
    v = x.var(dim=axis, keepdim=True, unbiased=False)
    return (x - m) / torch.sqrt(v + eps)
def _scatter_add(tgt, idx, src, axis=0):
    return tgt.clone().index_add_(axis, idx, src)
def _segment_sum(src, seg, n):
    out = torch.zeros((n,) + src.shape[1:], dtype=src.dtype)
    return out.index_add_(0, seg, src)
def _pad(x, pw):
    flat = tuple(v for pair in reversed(pw) for v in pair)
    return torch.nn.functional.pad(x, flat)

kernel_name = 'parallel_sum__ssm_conv_h3__glu_gated_bilinear__prompt'

def setup_inputs():

    _w = (lambda a: (lambda t: t.to(torch.bfloat16) if t.is_floating_point() else t)(torch.as_tensor(a)))
    def _A_setup():
        B, S, D = 1, 2048, 640
        ks = 4
        return {
            "q": _w((lambda *s: torch.randn(*s, dtype=torch.bfloat16) * 0.05)(B, S, D)),
            "k": _w((lambda *s: torch.randn(*s, dtype=torch.bfloat16) * 0.2)(B, S, D)),
            "v": _w((lambda *s: torch.randn(*s, dtype=torch.bfloat16) * 0.2)(B, S, D)),
            "shift_k": _w((lambda *s: torch.randn(*s, dtype=torch.bfloat16) * 0.2)(D, ks) * 0.5),
            "ssm_k": _w((lambda *s: torch.randn(*s, dtype=torch.bfloat16) * 0.4)(D, S) * (1.0 / S ** 0.5)),
            "ssm_D": _w((lambda *s: torch.randn(*s, dtype=torch.bfloat16) * 0.2)(D)),
        }
    _A_in = _A_setup()

    def _B_setup():
        B, S, D, F = 1, 2048, 640, 1728
        return {
            "x": _w((lambda *s: torch.randn(*s, dtype=torch.bfloat16) * 0.05)(B, S, D)),
            "w_gate": _w((lambda *s: torch.randn(*s, dtype=torch.bfloat16) * 0.2)(D, F) * (D ** -0.5)),
            "w_up": _w((lambda *s: torch.randn(*s, dtype=torch.bfloat16) * 0.2)(D, F) * (D ** -0.5)),
            "w_down": _w((lambda *s: torch.randn(*s, dtype=torch.bfloat16) * 0.2)(F, D) * (F ** -0.5)),
        }
    _B_in = _B_setup()

    return {
        "A_q": _A_in["q"],
        "A_k": _A_in["k"],
        "A_v": _A_in["v"],
        "A_shift_k": _A_in["shift_k"],
        "A_ssm_k": _A_in["ssm_k"],
        "A_ssm_D": _A_in["ssm_D"],
        "B_x": _B_in["x"],
        "B_w_gate": _B_in["w_gate"],
        "B_w_up": _B_in["w_up"],
        "B_w_down": _B_in["w_down"],
    }

def reference(A_q, A_k, A_v, A_shift_k, A_ssm_k, A_ssm_D, B_x, B_w_gate, B_w_up, B_w_down):
    def _A_ref(q, k, v, shift_k, ssm_k, ssm_D):
        B, S, D = q.shape
        ks = shift_k.shape[-1]
        k_pad = _pad(k, ((0, 0), (ks - 1, 0), (0, 0)))
        k_shift = torch.zeros_like(k)
        for t in range(ks):
            k_shift = k_shift + k_pad[:, t:t + S, :] * shift_k[:, ks - 1 - t][None, None, :]
        kv = k_shift * v
        L = 2 * S
        kv_pad = _pad(kv, ((0, 0), (0, S), (0, 0)))
        kf_pad = _pad(ssm_k, ((0, 0), (0, S)))
        kv_f = (lambda x, axes=(-2,-1): torch.fft.rfft2(x.float(), dim=axes))(kv_pad[:, None, :, :], axes=(1, 2))
        kf_f = (lambda x, axes=(-2,-1): torch.fft.rfft2(x.float(), dim=axes))(kf_pad[:, None, :], axes=(1, 2))
        kf_f = (lambda x, *d: x.permute(*d))(kf_f, 1, 2, 0)
        y_f = kv_f * kf_f[None, :, :, :]
        y = (lambda x, s, axes=(-2,-1): torch.fft.irfft2(x, s=s, dim=axes).to(torch.bfloat16))(y_f, (1, L), axes=(1, 2))[:, 0, :S, :]
        y = y + kv * ssm_D[None, None, :]
        return q * y

    def _B_ref(x, w_gate, w_up, w_down):
        g = torch.einsum("bsd,df->bsf", x, w_gate)
        u = torch.einsum("bsd,df->bsf", x, w_up)
        h = g * u
        return torch.einsum("bsf,fd->bsd", h, w_down)

    x = A_q
    xn = _layernorm(x, axis=-1)
    return x + _A_ref(xn, A_k, A_v, A_shift_k, A_ssm_k, A_ssm_D) + _B_ref(xn, B_w_gate, B_w_up, B_w_down)
```

```asm
; @launch kernel=mid_kernel grid=(256,1,1) block=(1024,1,1) lds=163840
.amdgcn_target "amdgcn-amd-amdhsa--gfx950"
.text
.globl mid_kernel
.p2align 8
.type mid_kernel,@function
mid_kernel:
    s_cmp_ge_u32 s2, 256
    s_cbranch_scc1 K2_END
    s_load_dwordx4 s[4:7], s[0:1], 0
    s_load_dwordx4 s[8:11], s[0:1], 16
    s_load_dwordx2 s[12:13], s[0:1], 96
    s_load_dwordx2 s[88:89], s[0:1], 88
    v_subrev_u32 v80, 320, v0
    v_cmp_gt_u32 vcc, 256, v80
    s_cbranch_vccz PA_N
    v_lshrrev_b32 v1, 5, v80
    v_mul_u32_u24 v1, 1280, v1
    v_and_b32 v2, 31, v0
    v_lshl_add_u32 v3, v2, 3, v1
    v_lshl_add_u32 v1, v2, 4, v1
    s_mul_i32 s14, s2, 10240
    s_mov_b32 s18, 2621440
    s_mov_b32 s19, 0x00020000
    s_waitcnt lgkmcnt(0)
    s_mov_b32 s16, s4
    s_mov_b32 s17, s5
    buffer_load_dwordx4 v[4:7], v1, s[16:19], s14 offen offset:0
    buffer_load_dwordx4 v[8:11], v1, s[16:19], s14 offen offset:512
    buffer_load_dwordx2 v[12:13], v3, s[16:19], s14 offen offset:1024
PA_N:
    s_mov_b32 s70, 0
    s_getpc_b64 s[60:61]
CT_k2:
    v_subrev_u32 v126, 576, v0
    v_cmp_gt_u32 vcc, 384, v126
    v_lshlrev_b32 v126, 6, v126
    s_and_saveexec_b64 s[62:63], vcc
    global_load_dword v127, v126, s[60:61] offset:1024
    s_mov_b64 exec, s[62:63]
    v_lshrrev_b32 v1, 6, v0
    v_mov_b32 v2, 0
    v_lshlrev_b32 v3, 2, v0
    v_readfirstlane_b32 s3, v1
    v_add_u32 v3, 163584, v3
    s_cmp_lg_u32 s3, 0
    s_cbranch_scc1 K2_B0
    ds_write_b32 v3, v2
    s_waitcnt lgkmcnt(0)
K2_B0:
    s_lshl_b32 s14, s2, 4
    s_add_u32 s14, s14, s3
    s_cmp_lg_u32 s14, 15
    s_cbranch_scc1 K2_BS
    s_memrealtime s[100:101]
    s_waitcnt lgkmcnt(0)
    s_mov_b32 s90, 256
    s_mov_b32 s91, 0x00020000
    s_or_b32 s100, s100, 1
    v_mov_b32 v2, s100
    v_mov_b32 v3, s101
    s_mov_b64 exec, 1
    buffer_store_dwordx2 v[2:3], off, s[88:91], 0 sc1
    s_mov_b64 exec, -1
K2_BS:
    s_barrier
    s_cmp_lt_u32 s3, 9
    s_cbranch_scc1 K1_START
    s_cmp_eq_u32 s3, 15
    s_cbranch_scc1 K1_TC
K2_START:
    s_waitcnt lgkmcnt(0)
    s_load_dwordx2 s[88:89], s[0:1], 88
    s_load_dwordx4 s[4:7], s[0:1], 32
    s_load_dwordx2 s[12:13], s[0:1], 96
    s_load_dwordx4 s[8:11], s[0:1], 56
    s_load_dwordx2 s[50:51], s[0:1], 72
    v_lshrrev_b32 v1, 6, v0
    s_nop 0
    v_readfirstlane_b32 s3, v1
    v_and_b32 v1, 63, v0
    v_lshlrev_b32 v2, 4, v1
    s_and_b32 s14, s2, 7
    s_lshr_b32 s15, s2, 3
    s_lshr_b32 s28, s14, 2
    s_lshl_b32 s29, s28, 1
    s_sub_u32 s29, 28, s29
    s_and_b32 s31, s14, 3
    s_mul_i32 s32, s31, s29
    s_mul_i32 s33, s28, 112
    s_add_u32 s32, s32, s33
    s_add_u32 s65, s32, s15
    s_lshl_b32 s65, s65, 1
    s_add_u32 s69, s65, 1
    s_mov_b32 s66, 98304
    s_cmp_lt_u32 s15, s29
    s_cselect_b32 s64, 1, 0
    s_cbranch_scc1 K2_R
    s_sub_u32 s32, 32, s29
    s_mul_i32 s32, s32, s31
    s_lshl_b32 s33, s28, 4
    s_add_u32 s32, s32, s33
    s_add_u32 s32, s32, s15
    s_sub_u32 s32, s32, s29
    s_add_u32 s65, s32, 432
    s_add_u32 s69, s65, 120
    s_mov_b32 s66, 0
K2_R:
    s_mul_i32 s76, s28, 14
    s_lshr_b32 s33, s15, 1
    s_add_u32 s76, s76, s33
    s_lshl_b32 s77, s31, 1
    s_and_b32 s33, s15, 1
    s_add_u32 s77, s77, s33
    s_waitcnt lgkmcnt(0)
    s_mov_b32 s16, s4
    s_mov_b32 s17, s5
    s_mov_b32 s18, 2621440
    s_mov_b32 s19, 0x00020000
    s_mov_b32 s90, 256
    s_mov_b32 s91, 0x00020000
    s_cmp_lt_u32 s3, 12
    s_cbranch_scc1 K2_CW
    s_cmp_lt_u32 s3, 14
    s_cbranch_scc1 LC_LD
    s_cmp_eq_u32 s64, 1
    s_cselect_b32 s43, 0, 100
    s_branch F3_H
LC_LD:
    s_sub_u32 s3, s3, 12
    s_cmp_eq_u32 s64, 0
    s_cbranch_scc1 K2_RP
    s_add_u32 s52, s12, 15728640
    s_addc_u32 s53, s13, 0
    s_mov_b32 s54, 2621440
    s_mov_b32 s55, 0x00020000
    s_cmp_eq_u32 s3, 0
    s_cselect_b32 s56, s8, s10
    s_cselect_b32 s57, s9, s11
    s_mov_b32 s58, 2211840
    s_mov_b32 s59, 0x00020000
    v_lshrrev_b32 v3, 3, v1
    v_and_b32 v4, 7, v1
    v_bfe_u32 v5, v3, 1, 1
    v_lshlrev_b32 v5, 2, v5
    v_xor_b32 v4, v4, v5
    v_mul_u32_u24 v3, 3456, v3
    v_lshl_add_u32 v3, v4, 4, v3
    v_add_u32 v4, 26624, v3
    v_add_u32 v5, 53248, v3
    v_add_u32 v6, 79872, v3
    s_lshl_b32 s72, s3, 13
    s_lshl_b32 s73, s3, 12
    s_mul_i32 s74, s77, 327680
    s_add_u32 s74, s74, s72
    s_lshl_b32 s75, s76, 7
    s_add_u32 s73, s73, 16384
    s_mov_b32 m0, s73
    s_nop 0
    buffer_load_dwordx4 v3, s[56:59], s75 offen offset:0 lds
    buffer_load_dwordx4 v4, s[56:59], s75 offen offset:1024 lds
    buffer_load_dwordx4 v5, s[56:59], s75 offen offset:2048 lds
    buffer_load_dwordx4 v6, s[56:59], s75 offen offset:3072 lds
    s_add_u32 s75, s75, 110592
    s_add_u32 s73, s73, 24576
    s_mov_b32 m0, s73
    s_nop 0
    buffer_load_dwordx4 v3, s[56:59], s75 offen offset:0 lds
    buffer_load_dwordx4 v4, s[56:59], s75 offen offset:1024 lds
    buffer_load_dwordx4 v5, s[56:59], s75 offen offset:2048 lds
    buffer_load_dwordx4 v6, s[56:59], s75 offen offset:3072 lds
    s_add_u32 s75, s75, 110592
    s_add_u32 s73, s73, 24576
    s_mov_b32 m0, s73
    s_nop 0
    buffer_load_dwordx4 v3, s[56:59], s75 offen offset:0 lds
    buffer_load_dwordx4 v4, s[56:59], s75 offen offset:1024 lds
    buffer_load_dwordx4 v5, s[56:59], s75 offen offset:2048 lds
    buffer_load_dwordx4 v6, s[56:59], s75 offen offset:3072 lds
    s_add_u32 s75, s75, 110592
    s_add_u32 s73, s73, 24576
    s_mov_b32 m0, s73
    s_nop 0
    buffer_load_dwordx4 v3, s[56:59], s75 offen offset:0 lds
    buffer_load_dwordx4 v4, s[56:59], s75 offen offset:1024 lds
    buffer_load_dwordx4 v5, s[56:59], s75 offen offset:2048 lds
    buffer_load_dwordx4 v6, s[56:59], s75 offen offset:3072 lds
    s_add_u32 s75, s75, 110592
    s_add_u32 s73, s73, 24576
    s_add_u32 s60, s12, 50331648
    s_addc_u32 s61, s13, 0
    s_mov_b32 s62, 665600
    s_mov_b32 s63, 0x00020000
    s_lshl_b32 s48, s77, 1
    s_add_u32 s48, s48, s3
    s_lshl_b32 s48, s48, 12
    s_and_b32 s49, s76, 3
    s_lshl_b32 s49, s49, 8
    s_add_u32 s48, s48, s49
    v_mov_b32 v11, 163724
    s_mov_b32 s41, 0
PG_L:
    ds_read_b32 v10, v11
    s_add_u32 s41, s41, 1
    s_waitcnt lgkmcnt(0)
    v_readfirstlane_b32 s42, v10
    s_cmp_lg_u32 s42, 0
    s_cbranch_scc1 PG_LD
    s_sleep 1
    s_cmp_lt_u32 s41, 1600000
    s_cbranch_scc1 PG_L
PG_LD:
    ds_read_b32 v10, v11 offset:112
    s_mov_b32 s100, s42
    s_waitcnt lgkmcnt(0)
    v_readfirstlane_b32 s101, v10
    s_sleep 12
    s_mov_b32 s49, 0
    s_branch PL_L0
PL_F0:
    s_add_u32 s49, s49, 1
    s_cmp_ge_u32 s49, 100000
    s_cbranch_scc1 PL_LN_D
    s_sleep 2
PL_L0:
    s_buffer_load_dwordx16 s[16:31], s[60:63], s48 offset:0 glc
    s_buffer_load_dwordx16 s[32:47], s[60:63], s48 offset:1024 glc
    s_buffer_load_dwordx16 s[80:95], s[60:63], s48 offset:2048 glc
    s_buffer_load_dwordx8 s[4:11], s[60:63], s48 offset:3072 glc
    s_buffer_load_dwordx8 s[64:71], s[60:63], s48 offset:3104 glc
    s_waitcnt lgkmcnt(0)
    s_branch PL_C0
PL_F1:
    s_add_u32 s49, s49, 1
    s_cmp_ge_u32 s49, 100000
    s_cbranch_scc1 PL_LN_D
    s_sleep 2
PL_L1:
    s_buffer_load_dwordx16 s[32:47], s[60:63], s48 offset:1024 glc
    s_buffer_load_dwordx16 s[80:95], s[60:63], s48 offset:2048 glc
    s_buffer_load_dwordx8 s[4:11], s[60:63], s48 offset:3072 glc
    s_buffer_load_dwordx8 s[64:71], s[60:63], s48 offset:3104 glc
    s_waitcnt lgkmcnt(0)
    s_branch PL_C1
PL_F2:
    s_add_u32 s49, s49, 1
    s_cmp_ge_u32 s49, 100000
    s_cbranch_scc1 PL_LN_D
    s_sleep 2
PL_L2:
    s_buffer_load_dwordx16 s[80:95], s[60:63], s48 offset:2048 glc
    s_buffer_load_dwordx8 s[4:11], s[60:63], s48 offset:3072 glc
    s_buffer_load_dwordx8 s[64:71], s[60:63], s48 offset:3104 glc
    s_waitcnt lgkmcnt(0)
    s_branch PL_C2
PL_F3:
    s_add_u32 s49, s49, 1
    s_cmp_ge_u32 s49, 100000
    s_cbranch_scc1 PL_LN_D
    s_sleep 2
PL_L3:
    s_buffer_load_dwordx8 s[4:11], s[60:63], s48 offset:3072 glc
    s_buffer_load_dwordx8 s[64:71], s[60:63], s48 offset:3104 glc
    s_waitcnt lgkmcnt(0)
    s_branch PL_C3
PL_C0:
    s_cmp_eq_u64 s[16:17], s[100:101]
    s_cbranch_scc0 PL_F0
    s_cmp_eq_u64 s[18:19], s[100:101]
    s_cbranch_scc0 PL_F0
    s_cmp_eq_u64 s[20:21], s[100:101]
    s_cbranch_scc0 PL_F0
    s_cmp_eq_u64 s[22:23], s[100:101]
    s_cbranch_scc0 PL_F0
    s_cmp_eq_u64 s[24:25], s[100:101]
    s_cbranch_scc0 PL_F0
    s_cmp_eq_u64 s[26:27], s[100:101]
    s_cbranch_scc0 PL_F0
    s_cmp_eq_u64 s[28:29], s[100:101]
    s_cbranch_scc0 PL_F0
    s_cmp_eq_u64 s[30:31], s[100:101]
    s_cbranch_scc0 PL_F0
PL_C1:
    s_cmp_eq_u64 s[32:33], s[100:101]
    s_cbranch_scc0 PL_F1
    s_cmp_eq_u64 s[34:35], s[100:101]
    s_cbranch_scc0 PL_F1
    s_cmp_eq_u64 s[36:37], s[100:101]
    s_cbranch_scc0 PL_F1
    s_cmp_eq_u64 s[38:39], s[100:101]
    s_cbranch_scc0 PL_F1
    s_cmp_eq_u64 s[40:41], s[100:101]
    s_cbranch_scc0 PL_F1
    s_cmp_eq_u64 s[42:43], s[100:101]
    s_cbranch_scc0 PL_F1
    s_cmp_eq_u64 s[44:45], s[100:101]
    s_cbranch_scc0 PL_F1
    s_cmp_eq_u64 s[46:47], s[100:101]
    s_cbranch_scc0 PL_F1
PL_C2:
    s_cmp_eq_u64 s[80:81], s[100:101]
    s_cbranch_scc0 PL_F2
    s_cmp_eq_u64 s[82:83], s[100:101]
    s_cbranch_scc0 PL_F2
    s_cmp_eq_u64 s[84:85], s[100:101]
    s_cbranch_scc0 PL_F2
    s_cmp_eq_u64 s[86:87], s[100:101]
    s_cbranch_scc0 PL_F2
    s_cmp_eq_u64 s[88:89], s[100:101]
    s_cbranch_scc0 PL_F2
    s_cmp_eq_u64 s[90:91], s[100:101]
    s_cbranch_scc0 PL_F2
    s_cmp_eq_u64 s[92:93], s[100:101]
    s_cbranch_scc0 PL_F2
    s_cmp_eq_u64 s[94:95], s[100:101]
    s_cbranch_scc0 PL_F2
PL_C3:
    s_cmp_eq_u64 s[4:5], s[100:101]
    s_cbranch_scc0 PL_F3
    s_cmp_eq_u64 s[6:7], s[100:101]
    s_cbranch_scc0 PL_F3
    s_cmp_eq_u64 s[8:9], s[100:101]
    s_cbranch_scc0 PL_F3
    s_cmp_eq_u64 s[10:11], s[100:101]
    s_cbranch_scc0 PL_F3
    s_cmp_eq_u64 s[64:65], s[100:101]
    s_cbranch_scc0 PL_F3
    s_cmp_eq_u64 s[66:67], s[100:101]
    s_cbranch_scc0 PL_F3
    s_cmp_eq_u64 s[68:69], s[100:101]
    s_cbranch_scc0 PL_F3
    s_cmp_eq_u64 s[70:71], s[100:101]
    s_cbranch_scc0 PL_F3
PL_LN_D:
    s_mov_b32 s64, 1
    s_add_u32 s44, s12, 50331648
    s_addc_u32 s45, s13, 0
    s_mov_b32 s46, 665600
    s_mov_b32 s47, 0x00020000
    v_mov_b32 v10, 1
    v_mov_b32 v11, 163716
    ds_write_b32 v11, v10
    s_mov_b32 m0, s72
    s_add_u32 s34, s74, 4096
    buffer_load_dwordx4 v2, s[52:55], s74 offen offset:0 sc1 lds
    buffer_load_dwordx4 v2, s[52:55], s74 offen offset:1024 sc1 lds
    buffer_load_dwordx4 v2, s[52:55], s74 offen offset:2048 sc1 lds
    buffer_load_dwordx4 v2, s[52:55], s74 offen offset:3072 sc1 lds
    s_add_u32 m0, s72, 4096
    s_add_u32 s74, s74, 16384
    buffer_load_dwordx4 v2, s[52:55], s34 offen offset:0 sc1 lds
    buffer_load_dwordx4 v2, s[52:55], s34 offen offset:1024 sc1 lds
    buffer_load_dwordx4 v2, s[52:55], s34 offen offset:2048 sc1 lds
    buffer_load_dwordx4 v2, s[52:55], s34 offen offset:3072 sc1 lds
    s_add_u32 s72, s72, 24576
    s_mov_b32 m0, s72
    s_add_u32 s34, s74, 4096
    buffer_load_dwordx4 v2, s[52:55], s74 offen offset:0 sc1 lds
    buffer_load_dwordx4 v2, s[52:55], s74 offen offset:1024 sc1 lds
    buffer_load_dwordx4 v2, s[52:55], s74 offen offset:2048 sc1 lds
    buffer_load_dwordx4 v2, s[52:55], s74 offen offset:3072 sc1 lds
    s_add_u32 m0, s72, 4096
    s_add_u32 s74, s74, 16384
    buffer_load_dwordx4 v2, s[52:55], s34 offen offset:0 sc1 lds
    buffer_load_dwordx4 v2, s[52:55], s34 offen offset:1024 sc1 lds
    buffer_load_dwordx4 v2, s[52:55], s34 offen offset:2048 sc1 lds
    buffer_load_dwordx4 v2, s[52:55], s34 offen offset:3072 sc1 lds
    s_add_u32 s72, s72, 24576
    s_mov_b32 m0, s72
    s_add_u32 s34, s74, 4096
    buffer_load_dwordx4 v2, s[52:55], s74 offen offset:0 sc1 lds
    buffer_load_dwordx4 v2, s[52:55], s74 offen offset:1024 sc1 lds
    buffer_load_dwordx4 v2, s[52:55], s74 offen offset:2048 sc1 lds
    buffer_load_dwordx4 v2, s[52:55], s74 offen offset:3072 sc1 lds
    s_add_u32 m0, s72, 4096
    s_add_u32 s74, s74, 16384
    buffer_load_dwordx4 v2, s[52:55], s34 offen offset:0 sc1 lds
    buffer_load_dwordx4 v2, s[52:55], s34 offen offset:1024 sc1 lds
    buffer_load_dwordx4 v2, s[52:55], s34 offen offset:2048 sc1 lds
    buffer_load_dwordx4 v2, s[52:55], s34 offen offset:3072 sc1 lds
    s_add_u32 s72, s72, 24576
    s_waitcnt vmcnt(16)
    s_barrier
    s_mov_b32 m0, s72
    s_add_u32 s34, s74, 4096
    buffer_load_dwordx4 v2, s[52:55], s74 offen offset:0 sc1 lds
    buffer_load_dwordx4 v2, s[52:55], s74 offen offset:1024 sc1 lds
    buffer_load_dwordx4 v2, s[52:55], s74 offen offset:2048 sc1 lds
    buffer_load_dwordx4 v2, s[52:55], s74 offen offset:3072 sc1 lds
    s_add_u32 m0, s72, 4096
    s_add_u32 s74, s74, 16384
    buffer_load_dwordx4 v2, s[52:55], s34 offen offset:0 sc1 lds
    buffer_load_dwordx4 v2, s[52:55], s34 offen offset:1024 sc1 lds
    buffer_load_dwordx4 v2, s[52:55], s34 offen offset:2048 sc1 lds
    buffer_load_dwordx4 v2, s[52:55], s34 offen offset:3072 sc1 lds
    s_add_u32 s72, s72, 24576
    s_sub_u32 s72, s72, 98304
    s_sub_u32 s73, s73, 98304
    s_waitcnt vmcnt(16)
    s_barrier
    s_mov_b32 m0, s72
    s_add_u32 s34, s74, 4096
    buffer_load_dwordx4 v2, s[52:55], s74 offen offset:0 sc1 lds
    buffer_load_dwordx4 v2, s[52:55], s74 offen offset:1024 sc1 lds
    buffer_load_dwordx4 v2, s[52:55], s74 offen offset:2048 sc1 lds
    buffer_load_dwordx4 v2, s[52:55], s74 offen offset:3072 sc1 lds
    s_add_u32 m0, s72, 4096
    s_add_u32 s74, s74, 16384
    buffer_load_dwordx4 v2, s[52:55], s34 offen offset:0 sc1 lds
    buffer_load_dwordx4 v2, s[52:55], s34 offen offset:1024 sc1 lds
    buffer_load_dwordx4 v2, s[52:55], s34 offen offset:2048 sc1 lds
    buffer_load_dwordx4 v2, s[52:55], s34 offen offset:3072 sc1 lds
    s_add_u32 s72, s72, 24576
    s_mov_b32 m0, s73
    s_nop 0
    buffer_load_dwordx4 v3, s[56:59], s75 offen offset:0 lds
    buffer_load_dwordx4 v4, s[56:59], s75 offen offset:1024 lds
    buffer_load_dwordx4 v5, s[56:59], s75 offen offset:2048 lds
    buffer_load_dwordx4 v6, s[56:59], s75 offen offset:3072 lds
    s_add_u32 s75, s75, 110592
    s_add_u32 s73, s73, 24576
    s_load_dwordx2 s[28:29], s[0:1], 0
    s_and_b32 s14, s2, 7
    s_and_b32 s35, s14, 3
    s_lshl_b32 s35, s35, 1
    s_lshr_b32 s14, s14, 2
    s_add_u32 s14, s14, s35
    s_lshl_b32 s14, s14, 2
    s_lshr_b32 s15, s2, 3
    s_and_b32 s35, s15, 3
    s_add_u32 s14, s14, s35
    s_lshr_b32 s15, s15, 2
    s_add_u32 s16, s12, 5242880
    s_addc_u32 s17, s13, 0
    s_mov_b32 s18, 7077888
    s_mov_b32 s19, 0x00020000
    s_add_u32 s20, s12, 24117248
    s_addc_u32 s21, s13, 0
    s_mov_b32 s22, 2211840
    s_mov_b32 s23, 0x00020000
    s_add_u32 s24, s12, 41943040
    s_addc_u32 s25, s13, 0
    s_mov_b32 s26, 2621440
    s_mov_b32 s27, 0x00020000
    s_lshl_b32 s37, s3, 12
    s_mul_i32 s38, s3, 5120
    s_mul_i32 s35, s14, 221184
    s_add_u32 s35, s35, s37
    s_mul_i32 s36, s15, 276480
    s_add_u32 s36, s36, s38
    s_lshl_b32 s48, s14, 3
    s_add_u32 s48, s48, s15
    s_mul_i32 s48, s48, 10240
    s_add_u32 s48, s48, s38
    s_lshl_b32 s49, s14, 1
    s_add_u32 s49, s49, s3
    s_mul_i32 s49, s49, 40960
    s_mul_i32 s34, s15, 160
    s_add_u32 s49, s49, s34
    v_add_u32 v16, 0, v1
    v_mul_u32_u24 v17, 6554, v16
    v_lshrrev_b32 v17, 16, v17
    v_mul_u32_u24 v18, 10, v17
    v_sub_u32 v18, v16, v18
    v_mul_u32_u24 v17, 1280, v17
    v_lshl_add_u32 v24, v18, 4, v17
    v_add_u32 v16, 64, v1
    v_mul_u32_u24 v17, 6554, v16
    v_lshrrev_b32 v17, 16, v17
    v_mul_u32_u24 v18, 10, v17
    v_sub_u32 v18, v16, v18
    v_mul_u32_u24 v17, 1280, v17
    v_lshl_add_u32 v25, v18, 4, v17
    v_add_u32 v16, 128, v1
    v_mul_u32_u24 v17, 6554, v16
    v_lshrrev_b32 v17, 16, v17
    v_mul_u32_u24 v18, 10, v17
    v_sub_u32 v18, v16, v18
    v_mul_u32_u24 v17, 1280, v17
    v_lshl_add_u32 v26, v18, 4, v17
    v_add_u32 v16, 192, v1
    v_mul_u32_u24 v17, 6554, v16
    v_lshrrev_b32 v17, 16, v17
    v_mul_u32_u24 v18, 10, v17
    v_sub_u32 v18, v16, v18
    v_mul_u32_u24 v17, 1280, v17
    v_lshl_add_u32 v27, v18, 4, v17
    v_add_u32 v16, 256, v1
    v_mul_u32_u24 v17, 6554, v16
    v_lshrrev_b32 v17, 16, v17
    v_mul_u32_u24 v18, 10, v17
    v_sub_u32 v18, v16, v18
    v_mul_u32_u24 v17, 1280, v17
    v_lshl_add_u32 v28, v18, 4, v17
    s_mul_i32 s34, s15, 10
    v_add_u32 v16, s34, v1
    v_lshlrev_b32 v16, 5, v16
    v_add_u32 v16, 655360, v16
    s_lshr_b32 s34, s14, 4
    s_mul_i32 s34, s34, 640
    s_mul_i32 s33, s15, 80
    s_add_u32 s34, s34, s33
    s_mul_i32 s33, s3, 40
    s_add_u32 s34, s34, s33
    v_add_u32 v17, s34, v1
    v_lshlrev_b32 v17, 4, v17
    v_add_u32 v17, 491520, v17
    s_lshl_b32 s34, s14, 1
    s_add_u32 s34, s34, s3
    s_lshl_b32 s33, s34, 10
    s_sub_u32 s33, s33, 320
    v_lshl_add_u32 v18, v1, 3, s33
    v_cmp_gt_u32 vcc, 40, v1
    v_cndmask_b32 v17, v18, v17, vcc
    s_lshl_b32 s34, s34, 5
    v_add_u32 v18, s34, v1
    v_lshlrev_b32 v18, 5, v18
    v_add_u32 v18, 229376, v18
    s_waitcnt lgkmcnt(0)
    s_mov_b32 s30, 2621440
    s_mov_b32 s31, 0x00020000
    s_waitcnt vmcnt(20)
    s_barrier
    s_mov_b32 m0, s72
    s_add_u32 s34, s74, 4096
    buffer_load_dwordx4 v2, s[52:55], s74 offen offset:0 sc1 lds
    buffer_load_dwordx4 v2, s[52:55], s74 offen offset:1024 sc1 lds
    buffer_load_dwordx4 v2, s[52:55], s74 offen offset:2048 sc1 lds
    buffer_load_dwordx4 v2, s[52:55], s74 offen offset:3072 sc1 lds
    s_add_u32 m0, s72, 4096
    s_add_u32 s74, s74, 16384
    buffer_load_dwordx4 v2, s[52:55], s34 offen offset:0 sc1 lds
    buffer_load_dwordx4 v2, s[52:55], s34 offen offset:1024 sc1 lds
    buffer_load_dwordx4 v2, s[52:55], s34 offen offset:2048 sc1 lds
    buffer_load_dwordx4 v2, s[52:55], s34 offen offset:3072 sc1 lds
    s_add_u32 s72, s72, 24576
    s_mov_b32 m0, s73
    s_nop 0
    buffer_load_dwordx4 v3, s[56:59], s75 offen offset:0 lds
    buffer_load_dwordx4 v4, s[56:59], s75 offen offset:1024 lds
    buffer_load_dwordx4 v5, s[56:59], s75 offen offset:2048 lds
    buffer_load_dwordx4 v6, s[56:59], s75 offen offset:3072 lds
    s_add_u32 s75, s75, 110592
    s_add_u32 s73, s73, 24576
    s_mov_b32 s79, 6
    s_mov_b32 s80, 98304
K2_LGL:
    s_waitcnt vmcnt(24)
    s_barrier
    s_mov_b32 m0, s72
    s_add_u32 s34, s74, 4096
    buffer_load_dwordx4 v2, s[52:55], s74 offen offset:0 sc1 lds
    buffer_load_dwordx4 v2, s[52:55], s74 offen offset:1024 sc1 lds
    buffer_load_dwordx4 v2, s[52:55], s74 offen offset:2048 sc1 lds
    buffer_load_dwordx4 v2, s[52:55], s74 offen offset:3072 sc1 lds
    s_add_u32 m0, s72, 4096
    s_add_u32 s74, s74, 16384
    buffer_load_dwordx4 v2, s[52:55], s34 offen offset:0 sc1 lds
    buffer_load_dwordx4 v2, s[52:55], s34 offen offset:1024 sc1 lds
    buffer_load_dwordx4 v2, s[52:55], s34 offen offset:2048 sc1 lds
    buffer_load_dwordx4 v2, s[52:55], s34 offen offset:3072 sc1 lds
    s_add_u32 s72, s72, 24576
    s_mov_b32 m0, s73
    s_nop 0
    buffer_load_dwordx4 v3, s[56:59], s75 offen offset:0 lds
    buffer_load_dwordx4 v4, s[56:59], s75 offen offset:1024 lds
    buffer_load_dwordx4 v5, s[56:59], s75 offen offset:2048 lds
    buffer_load_dwordx4 v6, s[56:59], s75 offen offset:3072 lds
    s_add_u32 s75, s75, 110592
    s_add_u32 s73, s73, 24576
    s_cmp_ge_u32 s72, s80
    s_cselect_b32 s33, s80, 0
    s_sub_u32 s72, s72, s33
    s_sub_u32 s73, s73, s33
    s_add_u32 s79, s79, 1
    s_cmp_lt_u32 s79, 18
    s_cbranch_scc1 K2_LGL
    s_waitcnt vmcnt(24)
    s_barrier
    s_mov_b32 m0, s72
    s_add_u32 s34, s74, 4096
    buffer_load_dwordx4 v2, s[52:55], s74 offen offset:0 sc1 lds
    buffer_load_dwordx4 v2, s[52:55], s74 offen offset:1024 sc1 lds
    buffer_load_dwordx4 v2, s[52:55], s74 offen offset:2048 sc1 lds
    buffer_load_dwordx4 v2, s[52:55], s74 offen offset:3072 sc1 lds
    s_add_u32 m0, s72, 4096
    s_add_u32 s74, s74, 16384
    buffer_load_dwordx4 v2, s[52:55], s34 offen offset:0 sc1 lds
    buffer_load_dwordx4 v2, s[52:55], s34 offen offset:1024 sc1 lds
    buffer_load_dwordx4 v2, s[52:55], s34 offen offset:2048 sc1 lds
    buffer_load_dwordx4 v2, s[52:55], s34 offen offset:3072 sc1 lds
    s_add_u32 s72, s72, 24576
    s_mov_b32 m0, s73
    s_nop 0
    buffer_load_dwordx4 v3, s[56:59], s75 offen offset:0 lds
    buffer_load_dwordx4 v4, s[56:59], s75 offen offset:1024 lds
    buffer_load_dwordx4 v5, s[56:59], s75 offen offset:2048 lds
    buffer_load_dwordx4 v6, s[56:59], s75 offen offset:3072 lds
    s_add_u32 s75, s75, 110592
    s_add_u32 s73, s73, 24576
    s_cmp_ge_u32 s72, s80
    s_cselect_b32 s33, s80, 0
    s_sub_u32 s72, s72, s33
    s_sub_u32 s73, s73, s33
    s_waitcnt vmcnt(24)
    s_barrier
    s_mov_b32 m0, s72
    s_add_u32 s34, s74, 4096
    buffer_load_dwordx4 v2, s[52:55], s74 offen offset:0 sc1 lds
    buffer_load_dwordx4 v2, s[52:55], s74 offen offset:1024 sc1 lds
    buffer_load_dwordx4 v2, s[52:55], s74 offen offset:2048 sc1 lds
    buffer_load_dwordx4 v2, s[52:55], s74 offen offset:3072 sc1 lds
    s_add_u32 m0, s72, 4096
    s_add_u32 s74, s74, 16384
    buffer_load_dwordx4 v2, s[52:55], s34 offen offset:0 sc1 lds
    buffer_load_dwordx4 v2, s[52:55], s34 offen offset:1024 sc1 lds
    buffer_load_dwordx4 v2, s[52:55], s34 offen offset:2048 sc1 lds
    buffer_load_dwordx4 v2, s[52:55], s34 offen offset:3072 sc1 lds
    s_add_u32 s72, s72, 24576
    s_mov_b32 m0, s73
    s_nop 0
    buffer_load_dwordx4 v3, s[56:59], s75 offen offset:0 lds
    buffer_load_dwordx4 v4, s[56:59], s75 offen offset:1024 lds
    buffer_load_dwordx4 v5, s[56:59], s75 offen offset:2048 lds
    buffer_load_dwordx4 v6, s[56:59], s75 offen offset:3072 lds
    s_add_u32 s75, s75, 110592
    s_add_u32 s73, s73, 24576
    s_cmp_ge_u32 s72, s80
    s_cselect_b32 s33, s80, 0
    s_sub_u32 s72, s72, s33
    s_sub_u32 s73, s73, s33
    s_waitcnt vmcnt(24)
    s_barrier
    s_waitcnt vmcnt(12)
    s_barrier
    s_waitcnt vmcnt(0)
    s_barrier
    s_mov_b32 s43, 22
    s_barrier
    s_barrier
    s_branch F3_LK
    s_waitcnt vmcnt(24)
    s_barrier
    s_mov_b32 m0, s72
    s_add_u32 s34, s74, 4096
    buffer_load_dwordx4 v2, s[52:55], s74 offen offset:0 sc1 lds
    buffer_load_dwordx4 v2, s[52:55], s74 offen offset:1024 sc1 lds
    buffer_load_dwordx4 v2, s[52:55], s74 offen offset:2048 sc1 lds
    buffer_load_dwordx4 v2, s[52:55], s74 offen offset:3072 sc1 lds
    s_add_u32 m0, s72, 4096
    s_add_u32 s74, s74, 16384
    buffer_load_dwordx4 v2, s[52:55], s34 offen offset:0 sc1 lds
    buffer_load_dwordx4 v2, s[52:55], s34 offen offset:1024 sc1 lds
    buffer_load_dwordx4 v2, s[52:55], s34 offen offset:2048 sc1 lds
    buffer_load_dwordx4 v2, s[52:55], s34 offen offset:3072 sc1 lds
    s_add_u32 s72, s72, 24576
    s_mov_b32 m0, s73
    s_nop 0
    buffer_load_dwordx4 v3, s[56:59], s75 offen offset:0 lds
    buffer_load_dwordx4 v4, s[56:59], s75 offen offset:1024 lds
    buffer_load_dwordx4 v5, s[56:59], s75 offen offset:2048 lds
    buffer_load_dwordx4 v6, s[56:59], s75 offen offset:3072 lds
    s_add_u32 s75, s75, 110592
    s_add_u32 s73, s73, 24576
    s_cmp_ge_u32 s72, s80
    s_cselect_b32 s33, s80, 0
    s_sub_u32 s72, s72, s33
    s_sub_u32 s73, s73, s33
    s_mov_b64 exec, 0x3ff
    buffer_load_dwordx2 v[10:11], v16, s[44:47], 0 offen sc1
    s_mov_b64 exec, -1
    s_waitcnt vmcnt(25)
    s_barrier
    s_mov_b32 m0, s72
    s_add_u32 s34, s74, 4096
    buffer_load_dwordx4 v2, s[52:55], s74 offen offset:0 sc1 lds
    buffer_load_dwordx4 v2, s[52:55], s74 offen offset:1024 sc1 lds
    buffer_load_dwordx4 v2, s[52:55], s74 offen offset:2048 sc1 lds
    buffer_load_dwordx4 v2, s[52:55], s74 offen offset:3072 sc1 lds
    s_add_u32 m0, s72, 4096
    s_add_u32 s74, s74, 16384
    buffer_load_dwordx4 v2, s[52:55], s34 offen offset:0 sc1 lds
    buffer_load_dwordx4 v2, s[52:55], s34 offen offset:1024 sc1 lds
    buffer_load_dwordx4 v2, s[52:55], s34 offen offset:2048 sc1 lds
    buffer_load_dwordx4 v2, s[52:55], s34 offen offset:3072 sc1 lds
    s_add_u32 s72, s72, 24576
    s_mov_b32 m0, s73
    s_nop 0
    buffer_load_dwordx4 v3, s[56:59], s75 offen offset:0 lds
    buffer_load_dwordx4 v4, s[56:59], s75 offen offset:1024 lds
    buffer_load_dwordx4 v5, s[56:59], s75 offen offset:2048 lds
    buffer_load_dwordx4 v6, s[56:59], s75 offen offset:3072 lds
    s_add_u32 s75, s75, 110592
    s_add_u32 s73, s73, 24576
    s_waitcnt vmcnt(25)
    s_barrier
    s_waitcnt vmcnt(12)
    v_cmp_ne_u64 vcc, s[100:101], v[10:11]
    s_mov_b32 s43, 21
    s_and_b32 s33, vcc_lo, 0x3ff
    s_mov_b32 s43, 22
    s_cbranch_scc1 F3_LB
    s_mov_b32 s36, 0
    s_mul_i32 s36, s36, 10240
    s_mul_i32 s53, s15, 276480
    s_add_u32 s53, s53, s38
    s_add_u32 s36, s36, s53
    s_add_u32 s53, s53, 276480
    s_add_u32 m0, s38, 141824
    s_add_u32 s34, s36, 4096
    buffer_load_dwordx4 v2, s[20:23], s36 offen offset:0 sc1 lds
    buffer_load_dwordx4 v2, s[20:23], s36 offen offset:1024 sc1 lds
    buffer_load_dwordx4 v2, s[20:23], s36 offen offset:2048 sc1 lds
    buffer_load_dwordx4 v2, s[20:23], s36 offen offset:3072 sc1 lds
    s_add_u32 m0, s38, 145920
    s_add_u32 s36, s36, 10240
    buffer_load_dwordx4 v2, s[20:23], s34 offen sc1 lds
    s_add_u32 m0, s38, 152064
    s_add_u32 s34, s36, 4096
    buffer_load_dwordx4 v2, s[20:23], s36 offen offset:0 sc1 lds
    buffer_load_dwordx4 v2, s[20:23], s36 offen offset:1024 sc1 lds
    buffer_load_dwordx4 v2, s[20:23], s36 offen offset:2048 sc1 lds
    buffer_load_dwordx4 v2, s[20:23], s36 offen offset:3072 sc1 lds
    s_add_u32 m0, s38, 156160
    s_add_u32 s36, s36, 10240
    buffer_load_dwordx4 v2, s[20:23], s34 offen sc1 lds
    s_add_u32 m0, s38, 0
    s_add_u32 s34, s36, 4096
    buffer_load_dwordx4 v2, s[20:23], s36 offen offset:0 sc1 lds
    buffer_load_dwordx4 v2, s[20:23], s36 offen offset:1024 sc1 lds
    buffer_load_dwordx4 v2, s[20:23], s36 offen offset:2048 sc1 lds
    buffer_load_dwordx4 v2, s[20:23], s36 offen offset:3072 sc1 lds
    s_add_u32 m0, s38, 4096
    s_add_u32 s36, s36, 10240
    buffer_load_dwordx4 v2, s[20:23], s34 offen sc1 lds
    s_add_u32 m0, s38, 10240
    s_add_u32 s34, s36, 4096
    buffer_load_dwordx4 v2, s[20:23], s36 offen offset:0 sc1 lds
    buffer_load_dwordx4 v2, s[20:23], s36 offen offset:1024 sc1 lds
    buffer_load_dwordx4 v2, s[20:23], s36 offen offset:2048 sc1 lds
    buffer_load_dwordx4 v2, s[20:23], s36 offen offset:3072 sc1 lds
    s_add_u32 m0, s38, 14336
    s_add_u32 s36, s36, 10240
    buffer_load_dwordx4 v2, s[20:23], s34 offen sc1 lds
    s_barrier
    s_add_u32 m0, s38, 20480
    s_add_u32 s34, s36, 4096
    buffer_load_dwordx4 v2, s[20:23], s36 offen offset:0 sc1 lds
    buffer_load_dwordx4 v2, s[20:23], s36 offen offset:1024 sc1 lds
    buffer_load_dwordx4 v2, s[20:23], s36 offen offset:2048 sc1 lds
    buffer_load_dwordx4 v2, s[20:23], s36 offen offset:3072 sc1 lds
    s_add_u32 m0, s38, 24576
    s_add_u32 s36, s36, 10240
    buffer_load_dwordx4 v2, s[20:23], s34 offen sc1 lds
    s_add_u32 m0, s38, 30720
    s_add_u32 s34, s36, 4096
    buffer_load_dwordx4 v2, s[20:23], s36 offen offset:0 sc1 lds
    buffer_load_dwordx4 v2, s[20:23], s36 offen offset:1024 sc1 lds
    buffer_load_dwordx4 v2, s[20:23], s36 offen offset:2048 sc1 lds
    buffer_load_dwordx4 v2, s[20:23], s36 offen offset:3072 sc1 lds
    s_add_u32 m0, s38, 34816
    s_add_u32 s36, s36, 10240
    buffer_load_dwordx4 v2, s[20:23], s34 offen sc1 lds
    v_min_u32 v13, 11, v1
    v_lshlrev_b32 v13, 2, v13
    v_add_u32 v13, 163776, v13
    s_waitcnt vmcnt(30)
    s_barrier
    ds_read_b32 v12, v13
    s_mov_b32 s39, 0
    s_waitcnt lgkmcnt(0)
    v_subrev_u32 v12, 1, v12
    v_cmp_le_u32 vcc, 20, v12
    s_cmp_eq_u64 vcc, 0
    s_cbranch_scc0 F5_T1
    s_add_u32 m0, s38, 98304
    s_add_u32 s34, s36, 4096
    buffer_load_dwordx4 v2, s[20:23], s36 offen offset:0 sc1 lds
    buffer_load_dwordx4 v2, s[20:23], s36 offen offset:1024 sc1 lds
    buffer_load_dwordx4 v2, s[20:23], s36 offen offset:2048 sc1 lds
    buffer_load_dwordx4 v2, s[20:23], s36 offen offset:3072 sc1 lds
    s_add_u32 m0, s38, 102400
    s_add_u32 s36, s36, 10240
    buffer_load_dwordx4 v2, s[20:23], s34 offen sc1 lds
    s_add_u32 m0, s38, 108544
    s_add_u32 s34, s36, 4096
    buffer_load_dwordx4 v2, s[20:23], s36 offen offset:0 sc1 lds
    buffer_load_dwordx4 v2, s[20:23], s36 offen offset:1024 sc1 lds
    buffer_load_dwordx4 v2, s[20:23], s36 offen offset:2048 sc1 lds
    buffer_load_dwordx4 v2, s[20:23], s36 offen offset:3072 sc1 lds
    s_add_u32 m0, s38, 112640
    s_add_u32 s36, s36, 10240
    buffer_load_dwordx4 v2, s[20:23], s34 offen sc1 lds
    s_mov_b32 s39, 1
F5_T1:
    s_barrier
    s_barrier
    v_min_u32 v13, 11, v1
    v_lshlrev_b32 v13, 2, v13
    v_add_u32 v13, 163776, v13
    s_mov_b32 s41, 0
F3_SV1:
    ds_read_b32 v12, v13
    s_add_u32 s41, s41, 1
    s_waitcnt lgkmcnt(0)
    v_subrev_u32 v12, 1, v12
    v_cmp_le_u32 vcc, s43, v12
    s_cmp_eq_u64 vcc, 0
    s_cbranch_scc1 F3_SV1_D
    s_cmp_ge_u32 s41, 400000
    s_cbranch_scc1 F3_SV1_D
    s_barrier
    s_add_u32 s43, s43, 1
    s_branch F3_SV1
F3_SV1_D:
    s_cmp_eq_u32 s39, 1
    s_cbranch_scc1 F5_T2
    s_add_u32 m0, s38, 98304
    s_add_u32 s34, s36, 4096
    buffer_load_dwordx4 v2, s[20:23], s36 offen offset:0 sc1 lds
    buffer_load_dwordx4 v2, s[20:23], s36 offen offset:1024 sc1 lds
    buffer_load_dwordx4 v2, s[20:23], s36 offen offset:2048 sc1 lds
    buffer_load_dwordx4 v2, s[20:23], s36 offen offset:3072 sc1 lds
    s_add_u32 m0, s38, 102400
    s_add_u32 s36, s36, 10240
    buffer_load_dwordx4 v2, s[20:23], s34 offen sc1 lds
    s_add_u32 m0, s38, 108544
    s_add_u32 s34, s36, 4096
    buffer_load_dwordx4 v2, s[20:23], s36 offen offset:0 sc1 lds
    buffer_load_dwordx4 v2, s[20:23], s36 offen offset:1024 sc1 lds
    buffer_load_dwordx4 v2, s[20:23], s36 offen offset:2048 sc1 lds
    buffer_load_dwordx4 v2, s[20:23], s36 offen offset:3072 sc1 lds
    s_add_u32 m0, s38, 112640
    s_add_u32 s36, s36, 10240
    buffer_load_dwordx4 v2, s[20:23], s34 offen sc1 lds
F5_T2:
    s_branch F3_LK
F3_LB:
    s_barrier
    s_waitcnt vmcnt(0)
    s_barrier
    s_barrier
    s_barrier
    v_min_u32 v13, 11, v1
    v_lshlrev_b32 v13, 2, v13
    v_add_u32 v13, 163776, v13
    s_mov_b32 s41, 0
F3_SV2:
    ds_read_b32 v12, v13
    s_add_u32 s41, s41, 1
    s_waitcnt lgkmcnt(0)
    v_subrev_u32 v12, 1, v12
    v_cmp_le_u32 vcc, s43, v12
    s_cmp_eq_u64 vcc, 0
    s_cbranch_scc1 F3_SV2_D
    s_cmp_ge_u32 s41, 400000
    s_cbranch_scc1 F3_SV2_D
    s_barrier
    s_add_u32 s43, s43, 1
    s_branch F3_SV2
F3_SV2_D:
    s_branch F3_LS
    s_endpgm
K2_RP:
    s_mov_b32 s52, s50
    s_mov_b32 s53, s51
    s_mov_b32 s54, 2211840
    s_mov_b32 s55, 0x00020000
    s_add_u32 s56, s12, 24117248
    s_addc_u32 s57, s13, 0
    s_mov_b32 s58, 2211840
    s_mov_b32 s59, 0x00020000
    s_sub_u32 s28, s65, 432
    s_lshl_b32 s28, s28, 1
    s_add_u32 s28, s28, s3
    s_mul_hi_u32 s29, s28, 0x1999999a
    s_mul_i32 s30, s29, 10
    s_sub_u32 s30, s28, s30
    s_mul_i32 s30, s30, 1728
    s_mul_i32 s29, s29, 160
    s_mul_i32 s28, s28, 27648
    s_mov_b32 s31, 0xcccccccd
    v_add_u32 v3, s30, v1
    s_sleep 60
    s_mov_b32 s41, 0
NG_R:
    v_mov_b32 v9, 163704
    ds_read_b32 v8, v9
    ds_read_b32 v9, v9 offset:4
    s_waitcnt lgkmcnt(0)
    v_readfirstlane_b32 s100, v8
    v_readfirstlane_b32 s101, v9
    s_cmp_lg_u32 s100, 0
    s_cbranch_scc1 NG_R_D
    s_sleep 1
    s_add_u32 s41, s41, 1
    s_cmp_lt_u32 s41, 1600000
    s_cbranch_scc1 NG_R
NG_R_D:
    s_waitcnt vmcnt(0)
    v_mov_b32 v4, 163832
    s_mov_b32 s41, 0
LC_RG:
    ds_read_b32 v5, v4 offset:0
    s_add_u32 s41, s41, 1
    s_waitcnt lgkmcnt(0)
    v_readfirstlane_b32 s42, v5
    s_cmp_ge_u32 s42, 5
    s_cbranch_scc1 LC_RG_D
    s_sleep 2
    s_cmp_lt_u32 s41, 1600000
    s_cbranch_scc1 LC_RG
LC_RG_D:
    s_setprio 3
    v_add_u32 v4, 0, v3
    v_mul_hi_u32 v5, v4, s31
    v_lshrrev_b32 v5, 3, v5
    v_mul_u32_u24 v6, 10, v5
    v_sub_u32 v6, v4, v6
    v_mul_u32_u24 v5, 1280, v5
    v_lshl_add_u32 v5, v6, 4, v5
    buffer_load_dwordx4 v[8:11], v5, s[52:55], s29 offen
    v_add_u32 v4, 64, v3
    v_mul_hi_u32 v5, v4, s31
    v_lshrrev_b32 v5, 3, v5
    v_mul_u32_u24 v6, 10, v5
    v_sub_u32 v6, v4, v6
    v_mul_u32_u24 v5, 1280, v5
    v_lshl_add_u32 v5, v6, 4, v5
    buffer_load_dwordx4 v[12:15], v5, s[52:55], s29 offen
    v_add_u32 v4, 128, v3
    v_mul_hi_u32 v5, v4, s31
    v_lshrrev_b32 v5, 3, v5
    v_mul_u32_u24 v6, 10, v5
    v_sub_u32 v6, v4, v6
    v_mul_u32_u24 v5, 1280, v5
    v_lshl_add_u32 v5, v6, 4, v5
    buffer_load_dwordx4 v[16:19], v5, s[52:55], s29 offen
    v_add_u32 v4, 192, v3
    v_mul_hi_u32 v5, v4, s31
    v_lshrrev_b32 v5, 3, v5
    v_mul_u32_u24 v6, 10, v5
    v_sub_u32 v6, v4, v6
    v_mul_u32_u24 v5, 1280, v5
    v_lshl_add_u32 v5, v6, 4, v5
    buffer_load_dwordx4 v[20:23], v5, s[52:55], s29 offen
    v_add_u32 v4, 256, v3
    v_mul_hi_u32 v5, v4, s31
    v_lshrrev_b32 v5, 3, v5
    v_mul_u32_u24 v6, 10, v5
    v_sub_u32 v6, v4, v6
    v_mul_u32_u24 v5, 1280, v5
    v_lshl_add_u32 v5, v6, 4, v5
    buffer_load_dwordx4 v[24:27], v5, s[52:55], s29 offen
    v_add_u32 v4, 320, v3
    v_mul_hi_u32 v5, v4, s31
    v_lshrrev_b32 v5, 3, v5
    v_mul_u32_u24 v6, 10, v5
    v_sub_u32 v6, v4, v6
    v_mul_u32_u24 v5, 1280, v5
    v_lshl_add_u32 v5, v6, 4, v5
    buffer_load_dwordx4 v[28:31], v5, s[52:55], s29 offen
    v_add_u32 v4, 384, v3
    v_mul_hi_u32 v5, v4, s31
    v_lshrrev_b32 v5, 3, v5
    v_mul_u32_u24 v6, 10, v5
    v_sub_u32 v6, v4, v6
    v_mul_u32_u24 v5, 1280, v5
    v_lshl_add_u32 v5, v6, 4, v5
    buffer_load_dwordx4 v[32:35], v5, s[52:55], s29 offen
    s_sleep 8
    v_add_u32 v4, 448, v3
    v_mul_hi_u32 v5, v4, s31
    v_lshrrev_b32 v5, 3, v5
    v_mul_u32_u24 v6, 10, v5
    v_sub_u32 v6, v4, v6
    v_mul_u32_u24 v5, 1280, v5
    v_lshl_add_u32 v5, v6, 4, v5
    buffer_load_dwordx4 v[36:39], v5, s[52:55], s29 offen
    v_add_u32 v4, 512, v3
    v_mul_hi_u32 v5, v4, s31
    v_lshrrev_b32 v5, 3, v5
    v_mul_u32_u24 v6, 10, v5
    v_sub_u32 v6, v4, v6
    v_mul_u32_u24 v5, 1280, v5
    v_lshl_add_u32 v5, v6, 4, v5
    buffer_load_dwordx4 v[40:43], v5, s[52:55], s29 offen
    v_add_u32 v4, 576, v3
    v_mul_hi_u32 v5, v4, s31
    v_lshrrev_b32 v5, 3, v5
    v_mul_u32_u24 v6, 10, v5
    v_sub_u32 v6, v4, v6
    v_mul_u32_u24 v5, 1280, v5
    v_lshl_add_u32 v5, v6, 4, v5
    buffer_load_dwordx4 v[44:47], v5, s[52:55], s29 offen
    v_add_u32 v4, 640, v3
    v_mul_hi_u32 v5, v4, s31
    v_lshrrev_b32 v5, 3, v5
    v_mul_u32_u24 v6, 10, v5
    v_sub_u32 v6, v4, v6
    v_mul_u32_u24 v5, 1280, v5
    v_lshl_add_u32 v5, v6, 4, v5
    buffer_load_dwordx4 v[48:51], v5, s[52:55], s29 offen
    v_add_u32 v4, 704, v3
    v_mul_hi_u32 v5, v4, s31
    v_lshrrev_b32 v5, 3, v5
    v_mul_u32_u24 v6, 10, v5
    v_sub_u32 v6, v4, v6
    v_mul_u32_u24 v5, 1280, v5
    v_lshl_add_u32 v5, v6, 4, v5
    buffer_load_dwordx4 v[52:55], v5, s[52:55], s29 offen
    v_add_u32 v4, 768, v3
    v_mul_hi_u32 v5, v4, s31
    v_lshrrev_b32 v5, 3, v5
    v_mul_u32_u24 v6, 10, v5
    v_sub_u32 v6, v4, v6
    v_mul_u32_u24 v5, 1280, v5
    v_lshl_add_u32 v5, v6, 4, v5
    buffer_load_dwordx4 v[56:59], v5, s[52:55], s29 offen
    v_add_u32 v4, 832, v3
    v_mul_hi_u32 v5, v4, s31
    v_lshrrev_b32 v5, 3, v5
    v_mul_u32_u24 v6, 10, v5
    v_sub_u32 v6, v4, v6
    v_mul_u32_u24 v5, 1280, v5
    v_lshl_add_u32 v5, v6, 4, v5
    buffer_load_dwordx4 v[60:63], v5, s[52:55], s29 offen
    s_sleep 8
    v_add_u32 v4, 896, v3
    v_mul_hi_u32 v5, v4, s31
    v_lshrrev_b32 v5, 3, v5
    v_mul_u32_u24 v6, 10, v5
    v_sub_u32 v6, v4, v6
    v_mul_u32_u24 v5, 1280, v5
    v_lshl_add_u32 v5, v6, 4, v5
    buffer_load_dwordx4 v[64:67], v5, s[52:55], s29 offen
    v_add_u32 v4, 960, v3
    v_mul_hi_u32 v5, v4, s31
    v_lshrrev_b32 v5, 3, v5
    v_mul_u32_u24 v6, 10, v5
    v_sub_u32 v6, v4, v6
    v_mul_u32_u24 v5, 1280, v5
    v_lshl_add_u32 v5, v6, 4, v5
    buffer_load_dwordx4 v[68:71], v5, s[52:55], s29 offen
    v_add_u32 v4, 1024, v3
    v_mul_hi_u32 v5, v4, s31
    v_lshrrev_b32 v5, 3, v5
    v_mul_u32_u24 v6, 10, v5
    v_sub_u32 v6, v4, v6
    v_mul_u32_u24 v5, 1280, v5
    v_lshl_add_u32 v5, v6, 4, v5
    buffer_load_dwordx4 v[72:75], v5, s[52:55], s29 offen
    v_add_u32 v4, 1088, v3
    v_mul_hi_u32 v5, v4, s31
    v_lshrrev_b32 v5, 3, v5
    v_mul_u32_u24 v6, 10, v5
    v_sub_u32 v6, v4, v6
    v_mul_u32_u24 v5, 1280, v5
    v_lshl_add_u32 v5, v6, 4, v5
    buffer_load_dwordx4 v[76:79], v5, s[52:55], s29 offen
    v_add_u32 v4, 1152, v3
    v_mul_hi_u32 v5, v4, s31
    v_lshrrev_b32 v5, 3, v5
    v_mul_u32_u24 v6, 10, v5
    v_sub_u32 v6, v4, v6
    v_mul_u32_u24 v5, 1280, v5
    v_lshl_add_u32 v5, v6, 4, v5
    buffer_load_dwordx4 v[80:83], v5, s[52:55], s29 offen
    v_add_u32 v4, 1216, v3
    v_mul_hi_u32 v5, v4, s31
    v_lshrrev_b32 v5, 3, v5
    v_mul_u32_u24 v6, 10, v5
    v_sub_u32 v6, v4, v6
    v_mul_u32_u24 v5, 1280, v5
    v_lshl_add_u32 v5, v6, 4, v5
    buffer_load_dwordx4 v[84:87], v5, s[52:55], s29 offen
    v_add_u32 v4, 1280, v3
    v_mul_hi_u32 v5, v4, s31
    v_lshrrev_b32 v5, 3, v5
    v_mul_u32_u24 v6, 10, v5
    v_sub_u32 v6, v4, v6
    v_mul_u32_u24 v5, 1280, v5
    v_lshl_add_u32 v5, v6, 4, v5
    buffer_load_dwordx4 v[88:91], v5, s[52:55], s29 offen
    s_sleep 8
    v_add_u32 v4, 1344, v3
    v_mul_hi_u32 v5, v4, s31
    v_lshrrev_b32 v5, 3, v5
    v_mul_u32_u24 v6, 10, v5
    v_sub_u32 v6, v4, v6
    v_mul_u32_u24 v5, 1280, v5
    v_lshl_add_u32 v5, v6, 4, v5
    buffer_load_dwordx4 v[92:95], v5, s[52:55], s29 offen
    v_add_u32 v4, 1408, v3
    v_mul_hi_u32 v5, v4, s31
    v_lshrrev_b32 v5, 3, v5
    v_mul_u32_u24 v6, 10, v5
    v_sub_u32 v6, v4, v6
    v_mul_u32_u24 v5, 1280, v5
    v_lshl_add_u32 v5, v6, 4, v5
    buffer_load_dwordx4 v[96:99], v5, s[52:55], s29 offen
    v_add_u32 v4, 1472, v3
    v_mul_hi_u32 v5, v4, s31
    v_lshrrev_b32 v5, 3, v5
    v_mul_u32_u24 v6, 10, v5
    v_sub_u32 v6, v4, v6
    v_mul_u32_u24 v5, 1280, v5
    v_lshl_add_u32 v5, v6, 4, v5
    buffer_load_dwordx4 v[100:103], v5, s[52:55], s29 offen
    v_add_u32 v4, 1536, v3
    v_mul_hi_u32 v5, v4, s31
    v_lshrrev_b32 v5, 3, v5
    v_mul_u32_u24 v6, 10, v5
    v_sub_u32 v6, v4, v6
    v_mul_u32_u24 v5, 1280, v5
    v_lshl_add_u32 v5, v6, 4, v5
    buffer_load_dwordx4 v[104:107], v5, s[52:55], s29 offen
    v_add_u32 v4, 1600, v3
    v_mul_hi_u32 v5, v4, s31
    v_lshrrev_b32 v5, 3, v5
    v_mul_u32_u24 v6, 10, v5
    v_sub_u32 v6, v4, v6
    v_mul_u32_u24 v5, 1280, v5
    v_lshl_add_u32 v5, v6, 4, v5
    buffer_load_dwordx4 v[108:111], v5, s[52:55], s29 offen
    v_add_u32 v4, 1664, v3
    v_mul_hi_u32 v5, v4, s31
    v_lshrrev_b32 v5, 3, v5
    v_mul_u32_u24 v6, 10, v5
    v_sub_u32 v6, v4, v6
    v_mul_u32_u24 v5, 1280, v5
    v_lshl_add_u32 v5, v6, 4, v5
    buffer_load_dwordx4 v[112:115], v5, s[52:55], s29 offen
    s_waitcnt vmcnt(0)
    buffer_store_dwordx4 v[8:11], v2, s[56:59], s28 offen offset:0 sc1
    buffer_store_dwordx4 v[12:15], v2, s[56:59], s28 offen offset:1024 sc1
    buffer_store_dwordx4 v[16:19], v2, s[56:59], s28 offen offset:2048 sc1
    buffer_store_dwordx4 v[20:23], v2, s[56:59], s28 offen offset:3072 sc1
    s_add_u32 s28, s28, 4096
    buffer_store_dwordx4 v[24:27], v2, s[56:59], s28 offen offset:0 sc1
    buffer_store_dwordx4 v[28:31], v2, s[56:59], s28 offen offset:1024 sc1
    buffer_store_dwordx4 v[32:35], v2, s[56:59], s28 offen offset:2048 sc1
    buffer_store_dwordx4 v[36:39], v2, s[56:59], s28 offen offset:3072 sc1
    s_add_u32 s28, s28, 4096
    buffer_store_dwordx4 v[40:43], v2, s[56:59], s28 offen offset:0 sc1
    buffer_store_dwordx4 v[44:47], v2, s[56:59], s28 offen offset:1024 sc1
    buffer_store_dwordx4 v[48:51], v2, s[56:59], s28 offen offset:2048 sc1
    buffer_store_dwordx4 v[52:55], v2, s[56:59], s28 offen offset:3072 sc1
    s_add_u32 s28, s28, 4096
    buffer_store_dwordx4 v[56:59], v2, s[56:59], s28 offen offset:0 sc1
    buffer_store_dwordx4 v[60:63], v2, s[56:59], s28 offen offset:1024 sc1
    s_sleep 8
    buffer_store_dwordx4 v[64:67], v2, s[56:59], s28 offen offset:2048 sc1
    buffer_store_dwordx4 v[68:71], v2, s[56:59], s28 offen offset:3072 sc1
    s_add_u32 s28, s28, 4096
    buffer_store_dwordx4 v[72:75], v2, s[56:59], s28 offen offset:0 sc1
    buffer_store_dwordx4 v[76:79], v2, s[56:59], s28 offen offset:1024 sc1
    buffer_store_dwordx4 v[80:83], v2, s[56:59], s28 offen offset:2048 sc1
    buffer_store_dwordx4 v[84:87], v2, s[56:59], s28 offen offset:3072 sc1
    s_add_u32 s28, s28, 4096
    buffer_store_dwordx4 v[88:91], v2, s[56:59], s28 offen offset:0 sc1
    buffer_store_dwordx4 v[92:95], v2, s[56:59], s28 offen offset:1024 sc1
    buffer_store_dwordx4 v[96:99], v2, s[56:59], s28 offen offset:2048 sc1
    buffer_store_dwordx4 v[100:103], v2, s[56:59], s28 offen offset:3072 sc1
    s_add_u32 s28, s28, 4096
    buffer_store_dwordx4 v[104:107], v2, s[56:59], s28 offen offset:0 sc1
    buffer_store_dwordx4 v[108:111], v2, s[56:59], s28 offen offset:1024 sc1
    buffer_store_dwordx4 v[112:115], v2, s[56:59], s28 offen offset:2048 sc1
    s_add_u32 s44, s12, 50331648
    s_addc_u32 s45, s13, 0
    s_mov_b32 s46, 665600
    s_mov_b32 s47, 0x00020000
    s_sub_u32 s40, s65, 432
    s_lshl_b32 s40, s40, 1
    s_add_u32 s40, s40, s3
    s_mul_hi_u32 s41, s40, 0x1999999a
    s_mul_i32 s41, s41, 432
    s_lshl_b32 s40, s40, 3
    s_add_u32 s40, s40, s41
    s_add_u32 s40, s40, 655360
    s_mov_b32 s43, 6
    s_load_dwordx2 s[28:29], s[0:1], 0
    s_and_b32 s14, s2, 7
    s_and_b32 s35, s14, 3
    s_lshl_b32 s35, s35, 1
    s_lshr_b32 s14, s14, 2
    s_add_u32 s14, s14, s35
    s_lshl_b32 s14, s14, 2
    s_lshr_b32 s15, s2, 3
    s_and_b32 s35, s15, 3
    s_add_u32 s14, s14, s35
    s_lshr_b32 s15, s15, 2
    s_add_u32 s16, s12, 5242880
    s_addc_u32 s17, s13, 0
    s_mov_b32 s18, 7077888
    s_mov_b32 s19, 0x00020000
    s_add_u32 s20, s12, 24117248
    s_addc_u32 s21, s13, 0
    s_mov_b32 s22, 2211840
    s_mov_b32 s23, 0x00020000
    s_add_u32 s24, s12, 41943040
    s_addc_u32 s25, s13, 0
    s_mov_b32 s26, 2621440
    s_mov_b32 s27, 0x00020000
    s_lshl_b32 s37, s3, 12
    s_mul_i32 s38, s3, 5120
    s_mul_i32 s35, s14, 221184
    s_add_u32 s35, s35, s37
    s_mul_i32 s36, s15, 276480
    s_add_u32 s36, s36, s38
    s_lshl_b32 s48, s14, 3
    s_add_u32 s48, s48, s15
    s_mul_i32 s48, s48, 10240
    s_add_u32 s48, s48, s38
    s_lshl_b32 s49, s14, 1
    s_add_u32 s49, s49, s3
    s_mul_i32 s49, s49, 40960
    s_mul_i32 s34, s15, 160
    s_add_u32 s49, s49, s34
    v_add_u32 v16, 0, v1
    v_mul_u32_u24 v17, 6554, v16
    v_lshrrev_b32 v17, 16, v17
    v_mul_u32_u24 v18, 10, v17
    v_sub_u32 v18, v16, v18
    v_mul_u32_u24 v17, 1280, v17
    v_lshl_add_u32 v24, v18, 4, v17
    v_add_u32 v16, 64, v1
    v_mul_u32_u24 v17, 6554, v16
    v_lshrrev_b32 v17, 16, v17
    v_mul_u32_u24 v18, 10, v17
    v_sub_u32 v18, v16, v18
    v_mul_u32_u24 v17, 1280, v17
    v_lshl_add_u32 v25, v18, 4, v17
    v_add_u32 v16, 128, v1
    v_mul_u32_u24 v17, 6554, v16
    v_lshrrev_b32 v17, 16, v17
    v_mul_u32_u24 v18, 10, v17
    v_sub_u32 v18, v16, v18
    v_mul_u32_u24 v17, 1280, v17
    v_lshl_add_u32 v26, v18, 4, v17
    v_add_u32 v16, 192, v1
    v_mul_u32_u24 v17, 6554, v16
    v_lshrrev_b32 v17, 16, v17
    v_mul_u32_u24 v18, 10, v17
    v_sub_u32 v18, v16, v18
    v_mul_u32_u24 v17, 1280, v17
    v_lshl_add_u32 v27, v18, 4, v17
    v_add_u32 v16, 256, v1
    v_mul_u32_u24 v17, 6554, v16
    v_lshrrev_b32 v17, 16, v17
    v_mul_u32_u24 v18, 10, v17
    v_sub_u32 v18, v16, v18
    v_mul_u32_u24 v17, 1280, v17
    v_lshl_add_u32 v28, v18, 4, v17
    s_mul_i32 s34, s15, 10
    v_add_u32 v16, s34, v1
    v_lshlrev_b32 v16, 5, v16
    v_add_u32 v16, 655360, v16
    s_lshr_b32 s34, s14, 4
    s_mul_i32 s34, s34, 640
    s_mul_i32 s33, s15, 80
    s_add_u32 s34, s34, s33
    s_mul_i32 s33, s3, 40
    s_add_u32 s34, s34, s33
    v_add_u32 v17, s34, v1
    v_lshlrev_b32 v17, 4, v17
    v_add_u32 v17, 491520, v17
    s_lshl_b32 s34, s14, 1
    s_add_u32 s34, s34, s3
    s_lshl_b32 s33, s34, 10
    s_sub_u32 s33, s33, 320
    v_lshl_add_u32 v18, v1, 3, s33
    v_cmp_gt_u32 vcc, 40, v1
    v_cndmask_b32 v17, v18, v17, vcc
    s_lshl_b32 s34, s34, 5
    v_add_u32 v18, s34, v1
    v_lshlrev_b32 v18, 5, v18
    v_add_u32 v18, 229376, v18
    s_waitcnt lgkmcnt(0)
    s_mov_b32 s30, 2621440
    s_mov_b32 s31, 0x00020000
    v_mov_b32 v14, s100
    v_mov_b32 v15, s101
    s_waitcnt vmcnt(0)
    s_mov_b64 exec, 1
    buffer_store_dwordx2 v[14:15], off, s[44:47], s40 sc1
    buffer_store_dwordx2 v[14:15], off, s[44:47], s40 offset:256 sc1
    s_mov_b64 exec, -1
    s_setprio 0
    v_mov_b32 v12, 163776
    s_mov_b32 s41, 0
LC_RC:
    ds_read_b32 v13, v12 offset:0
    s_add_u32 s41, s41, 1
    s_waitcnt lgkmcnt(0)
    v_readfirstlane_b32 s42, v13
    s_cmp_ge_u32 s42, 12
    s_cbranch_scc1 LC_RC_D
    s_sleep 2
    s_cmp_lt_u32 s41, 1600000
    s_cbranch_scc1 LC_RC
LC_RC_D:
    s_branch F3_LS
    s_endpgm
K2_CW:
    s_cmp_lt_u32 s3, 8
    s_cselect_b32 s33, s64, 0
    s_cmp_eq_u32 s33, 1
    s_cbranch_scc1 K2_G
    s_add_u32 s20, s12, 2621440
    s_addc_u32 s21, s13, 0
    s_mov_b32 s22, 2621440
    s_mov_b32 s23, 0x00020000
    s_add_u32 s24, s12, 41943040
    s_addc_u32 s25, s13, 0
    s_mov_b32 s26, 2621440
    s_mov_b32 s27, 0x00020000
    s_and_b32 s39, s3, 3
    s_lshr_b32 s38, s3, 2
    s_cmp_eq_u32 s64, 1
    s_cselect_b32 s38, 0, s38
    s_mul_i32 s33, s38, 40
    s_add_u32 s65, s65, s33
    s_add_u32 s69, s69, s33
    s_mul_i32 s33, s38, 43520
    s_add_u32 s66, s66, s33
    s_lshr_b32 s38, s39, 1
    s_min_u32 s68, s69, 639
    s_lshr_b32 s28, s65, 1
    s_lshl_b32 s28, s28, 2
    s_load_dword s70, s[6:7], s28
    s_lshr_b32 s28, s68, 1
    s_lshl_b32 s28, s28, 2
    s_load_dword s71, s[6:7], s28
    s_lshl_b32 s32, s65, 12
    s_lshl_b32 s33, s68, 12
    v_lshl_add_u32 v16, s39, 6, v1
    v_lshlrev_b32 v12, 4, v16
    s_cmp_lt_u32 s3, 9
    s_cbranch_scc1 K2_ND
    s_sleep 60
K2_ND:
    s_cmp_lt_u32 s3, 8
    s_cbranch_scc1 CPA_1
    buffer_load_dwordx4 v[104:107], v12, s[16:19], s32 offen
    buffer_load_dwordx2 v[108:109], v12, s[16:19], s32 offen offset:16
    buffer_load_dwordx4 v[120:123], v12, s[16:19], s33 offen
    buffer_load_dwordx2 v[124:125], v12, s[16:19], s33 offen offset:16
    s_cmp_eq_u32 s64, 1
    s_cbranch_scc1 CPA_1
    s_add_i32 s34, s32, -327680
    buffer_load_dwordx4 v[48:51], v12, s[16:19], s34 offen
    buffer_load_dwordx2 v[52:53], v12, s[16:19], s34 offen offset:16
    s_add_i32 s34, s32, 163840
    buffer_load_dwordx4 v[56:59], v12, s[16:19], s34 offen
    buffer_load_dwordx2 v[60:61], v12, s[16:19], s34 offen offset:16
    s_add_i32 s34, s32, -163840
    buffer_load_dwordx4 v[64:67], v12, s[16:19], s34 offen
    buffer_load_dwordx2 v[68:69], v12, s[16:19], s34 offen offset:16
    s_add_i32 s34, s32, 327680
    buffer_load_dwordx4 v[72:75], v12, s[16:19], s34 offen
    buffer_load_dwordx2 v[76:77], v12, s[16:19], s34 offen offset:16
CPA_1:
    s_mov_b32 s58, s32
    s_mov_b32 s59, s33
    v_mov_b32 v119, v12
    s_add_u32 s34, s66, 9344
    v_add_u32 v117, s34, v12
    v_mov_b32 v28, 0
    v_mov_b32 v29, 0
    v_mov_b32 v30, 0
    v_mov_b32 v31, 0
    v_lshrrev_b32 v21, 3, v1
    v_mul_u32_u24 v20, 4288, v21
    v_and_b32 v21, 7, v1
    v_lshl_add_u32 v20, v21, 4, v20
    s_add_u32 s34, s66, 9216
    v_add_u32 v20, s34, v20
    v_and_b32 v22, 31, v1
    v_lshrrev_b32 v21, 5, v1
    v_mul_u32_u24 v21, 4608, v21
    v_lshl_add_u32 v21, v22, 4, v21
    v_add_u32 v21, s66, v21
    s_mov_b64 vcc, -1
    s_cmp_eq_u32 s39, 0
    s_cbranch_scc0 CF_0
    s_cmp_lt_u32 s3, 8
    s_cbranch_scc1 CPA_2
    ds_write_b128 v20, v[28:31]
    s_cmp_eq_u32 s64, 1
    s_cbranch_scc1 CPA_2
    v_subrev_u32 v20, 43520, v20
    ds_write_b128 v20, v[28:31]
    v_subrev_u32 v20, 43520, v20
    ds_write_b128 v20, v[28:31]
CPA_2:
    s_and_saveexec_b64 s[36:37], vcc
    ds_write_b128 v21, v[28:31]
    s_mov_b64 exec, s[36:37]
CF_0:
    s_add_u32 s34, s66, 512
    v_add_u32 v118, s34, v12
    v_and_b32 v40, 15, v1
    v_lshrrev_b32 v41, 4, v1
    v_add_u32 v16, 1, v40
    v_and_b32 v16, 3, v16
    v_mul_u32_u24 v8, 4286, v16
    v_lshl_add_u32 v8, v40, 1, v8
    v_lshl_add_u32 v8, v41, 4, v8
    s_and_b32 s37, s39, 1
    s_lshl_b32 s41, s37, 8
    s_mul_i32 s42, s38, 17152
    s_add_u32 s42, s42, s66
    s_add_u32 s42, s42, 9216
    s_add_u32 s43, s42, s41
    s_add_u32 s43, s43, 98
    v_add_u32 v8, s43, v8
    s_lshl_b32 s43, s37, 12
    s_add_u32 s44, s42, s43
    v_add_u32 v14, s44, v2
    s_xor_b32 s43, s43, 4096
    s_add_u32 s44, s42, s43
    v_add_u32 v15, s44, v2
    s_mul_i32 s42, s38, 4608
    s_add_u32 s42, s42, s66
    v_lshlrev_b32 v10, 5, v40
    v_lshlrev_b32 v11, 4, v41
    v_sub_u32 v10, v10, v11
    s_sub_u32 s43, s42, s41
    s_add_u32 s43, s43, 336
    v_add_u32 v10, s43, v10
    v_lshlrev_b32 v13, 5, v40
    v_lshrrev_b32 v42, 1, v41
    v_lshl_add_u32 v13, v42, 4, v13
    v_and_b32 v42, 1, v41
    v_lshlrev_b32 v42, 3, v42
    v_xor_b32 v42, 8, v42
    v_add_u32 v13, v13, v42
    s_lshl_b32 s43, s37, 11
    s_add_u32 s43, s43, s42
    s_add_u32 s43, s43, 512
    v_add_u32 v13, s43, v13
    v_lshrrev_b32 v42, 2, v40
    v_mul_u32_u24 v2, 81920, v42
    v_and_b32 v42, 3, v40
    v_lshl_add_u32 v2, v42, 5, v2
    v_lshl_add_u32 v2, v41, 3, v2
    s_mov_b32 s49, s37
    s_cmp_lt_u32 s3, 8
    s_cbranch_scc1 CPA_4
    s_cmp_eq_u32 s64, 1
    s_cbranch_scc1 CPA_3
    v_subrev_u32 v116, 87040, v117
    v_subrev_u32 v110, 43520, v117
    s_waitcnt vmcnt(0)
    ds_write_b128 v116, v[48:51] offset:0
    v_alignbit_b32 v16, v49, v48, 16
    v_alignbit_b32 v17, v50, v49, 16
    v_alignbit_b32 v18, v51, v50, 16
    v_alignbit_b32 v19, v52, v51, 16
    ds_write_b128 v116, v[16:19] offset:4288
    v_mov_b32 v20, v49
    v_mov_b32 v21, v50
    v_mov_b32 v22, v51
    v_mov_b32 v23, v52
    ds_write_b128 v116, v[20:23] offset:8576
    v_alignbit_b32 v24, v50, v49, 16
    v_alignbit_b32 v25, v51, v50, 16
    v_alignbit_b32 v26, v52, v51, 16
    v_alignbit_b32 v27, v53, v52, 16
    ds_write_b128 v116, v[24:27] offset:12864
    s_cmp_eq_u32 s39, 0
    s_cbranch_scc0 CPA_W0
    v_mov_b32 v28, 0
    v_lshlrev_b32 v29, 16, v48
    v_mov_b32 v32, 0
    v_mov_b32 v33, v48
    v_mov_b32 v34, v29
    v_mov_b32 v35, v16
    s_mov_b64 exec, 1
    ds_write_b64 v116, v[28:29] offset:4280
    ds_write_b64 v116, v[32:33] offset:8568
    ds_write_b64 v116, v[34:35] offset:12856
    s_mov_b64 exec, -1
CPA_W0:
    ds_write_b128 v116, v[56:59] offset:17152
    v_alignbit_b32 v16, v57, v56, 16
    v_alignbit_b32 v17, v58, v57, 16
    v_alignbit_b32 v18, v59, v58, 16
    v_alignbit_b32 v19, v60, v59, 16
    ds_write_b128 v116, v[16:19] offset:21440
    v_mov_b32 v20, v57
    v_mov_b32 v21, v58
    v_mov_b32 v22, v59
    v_mov_b32 v23, v60
    ds_write_b128 v116, v[20:23] offset:25728
    v_alignbit_b32 v24, v58, v57, 16
    v_alignbit_b32 v25, v59, v58, 16
    v_alignbit_b32 v26, v60, v59, 16
    v_alignbit_b32 v27, v61, v60, 16
    ds_write_b128 v116, v[24:27] offset:30016
    s_cmp_eq_u32 s39, 0
    s_cbranch_scc0 CPA_W1
    v_mov_b32 v28, 0
    v_lshlrev_b32 v29, 16, v56
    v_mov_b32 v32, 0
    v_mov_b32 v33, v56
    v_mov_b32 v34, v29
    v_mov_b32 v35, v16
    s_mov_b64 exec, 1
    ds_write_b64 v116, v[28:29] offset:21432
    ds_write_b64 v116, v[32:33] offset:25720
    ds_write_b64 v116, v[34:35] offset:30008
    s_mov_b64 exec, -1
CPA_W1:
    ds_write_b128 v110, v[64:67] offset:0
    v_alignbit_b32 v16, v65, v64, 16
    v_alignbit_b32 v17, v66, v65, 16
    v_alignbit_b32 v18, v67, v66, 16
    v_alignbit_b32 v19, v68, v67, 16
    ds_write_b128 v110, v[16:19] offset:4288
    v_mov_b32 v20, v65
    v_mov_b32 v21, v66
    v_mov_b32 v22, v67
    v_mov_b32 v23, v68
    ds_write_b128 v110, v[20:23] offset:8576
    v_alignbit_b32 v24, v66, v65, 16
    v_alignbit_b32 v25, v67, v66, 16
    v_alignbit_b32 v26, v68, v67, 16
    v_alignbit_b32 v27, v69, v68, 16
    ds_write_b128 v110, v[24:27] offset:12864
    s_cmp_eq_u32 s39, 0
    s_cbranch_scc0 CPA_W2
    v_mov_b32 v28, 0
    v_lshlrev_b32 v29, 16, v64
    v_mov_b32 v32, 0
    v_mov_b32 v33, v64
    v_mov_b32 v34, v29
    v_mov_b32 v35, v16
    s_mov_b64 exec, 1
    ds_write_b64 v110, v[28:29] offset:4280
    ds_write_b64 v110, v[32:33] offset:8568
    ds_write_b64 v110, v[34:35] offset:12856
    s_mov_b64 exec, -1
CPA_W2:
    ds_write_b128 v110, v[72:75] offset:17152
    v_alignbit_b32 v16, v73, v72, 16
    v_alignbit_b32 v17, v74, v73, 16
    v_alignbit_b32 v18, v75, v74, 16
    v_alignbit_b32 v19, v76, v75, 16
    ds_write_b128 v110, v[16:19] offset:21440
    v_mov_b32 v20, v73
    v_mov_b32 v21, v74
    v_mov_b32 v22, v75
    v_mov_b32 v23, v76
    ds_write_b128 v110, v[20:23] offset:25728
    v_alignbit_b32 v24, v74, v73, 16
    v_alignbit_b32 v25, v75, v74, 16
    v_alignbit_b32 v26, v76, v75, 16
    v_alignbit_b32 v27, v77, v76, 16
    ds_write_b128 v110, v[24:27] offset:30016
    s_cmp_eq_u32 s39, 0
    s_cbranch_scc0 CPA_W3
    v_mov_b32 v28, 0
    v_lshlrev_b32 v29, 16, v72
    v_mov_b32 v32, 0
    v_mov_b32 v33, v72
    v_mov_b32 v34, v29
    v_mov_b32 v35, v16
    s_mov_b64 exec, 1
    ds_write_b64 v110, v[28:29] offset:21432
    ds_write_b64 v110, v[32:33] offset:25720
    ds_write_b64 v110, v[34:35] offset:30008
    s_mov_b64 exec, -1
CPA_W3:
CPA_3:
    s_waitcnt vmcnt(2)
    ds_write_b128 v117, v[104:107] offset:0
    v_alignbit_b32 v16, v105, v104, 16
    v_alignbit_b32 v17, v106, v105, 16
    v_alignbit_b32 v18, v107, v106, 16
    v_alignbit_b32 v19, v108, v107, 16
    ds_write_b128 v117, v[16:19] offset:4288
    v_mov_b32 v20, v105
    v_mov_b32 v21, v106
    v_mov_b32 v22, v107
    v_mov_b32 v23, v108
    ds_write_b128 v117, v[20:23] offset:8576
    v_alignbit_b32 v24, v106, v105, 16
    v_alignbit_b32 v25, v107, v106, 16
    v_alignbit_b32 v26, v108, v107, 16
    v_alignbit_b32 v27, v109, v108, 16
    ds_write_b128 v117, v[24:27] offset:12864
    s_cmp_eq_u32 s39, 0
    s_cbranch_scc0 CF_1
    v_mov_b32 v28, 0
    v_lshlrev_b32 v29, 16, v104
    v_mov_b32 v32, 0
    v_mov_b32 v33, v104
    v_mov_b32 v34, v29
    v_mov_b32 v35, v16
    s_mov_b64 exec, 1
    ds_write_b64 v117, v[28:29] offset:4280
    ds_write_b64 v117, v[32:33] offset:8568
    ds_write_b64 v117, v[34:35] offset:12856
    s_mov_b64 exec, -1
CF_1:
    s_waitcnt vmcnt(0)
    ds_write_b128 v117, v[120:123] offset:17152
    v_alignbit_b32 v16, v121, v120, 16
    v_alignbit_b32 v17, v122, v121, 16
    v_alignbit_b32 v18, v123, v122, 16
    v_alignbit_b32 v19, v124, v123, 16
    ds_write_b128 v117, v[16:19] offset:21440
    v_mov_b32 v20, v121
    v_mov_b32 v21, v122
    v_mov_b32 v22, v123
    v_mov_b32 v23, v124
    ds_write_b128 v117, v[20:23] offset:25728
    v_alignbit_b32 v24, v122, v121, 16
    v_alignbit_b32 v25, v123, v122, 16
    v_alignbit_b32 v26, v124, v123, 16
    v_alignbit_b32 v27, v125, v124, 16
    ds_write_b128 v117, v[24:27] offset:30016
    s_cmp_eq_u32 s39, 0
    s_cbranch_scc0 CF_2
    v_mov_b32 v28, 0
    v_lshlrev_b32 v29, 16, v120
    v_mov_b32 v32, 0
    v_mov_b32 v33, v120
    v_mov_b32 v34, v29
    v_mov_b32 v35, v16
    s_mov_b64 exec, 1
    ds_write_b64 v117, v[28:29] offset:21432
    ds_write_b64 v117, v[32:33] offset:25720
    ds_write_b64 v117, v[34:35] offset:30008
    s_mov_b64 exec, -1
CF_2:
    s_waitcnt lgkmcnt(0)
    v_mov_b32 v16, 163780
    v_mov_b32 v17, 1
    s_mov_b64 exec, 1
    ds_add_u32 v16, v17
    s_mov_b64 exec, -1
CPA_4:
    s_add_u32 s52, s12, 50331648
    s_addc_u32 s53, s13, 0
    s_mov_b32 s54, 665600
    s_mov_b32 s55, 0x00020000
    s_mul_i32 s30, s65, 52429
    s_lshr_b32 s30, s30, 22
    s_mul_i32 s31, s30, 80
    s_sub_u32 s31, s65, s31
    s_cmp_ge_u32 s31, 40
    s_cselect_b32 s34, 40, 0
    s_sub_u32 s31, s31, s34
    s_lshr_b32 s31, s31, 3
    s_mul_i32 s30, s30, 5
    s_add_u32 s30, s30, s31
    s_lshl_b32 s30, s30, 2
    s_add_u32 s30, s30, s39
    s_lshl_b32 s28, s30, 10
    s_mul_i32 s30, s68, 52429
    s_lshr_b32 s30, s30, 22
    s_mul_i32 s31, s30, 80
    s_sub_u32 s31, s68, s31
    s_cmp_ge_u32 s31, 40
    s_cselect_b32 s34, 40, 0
    s_sub_u32 s31, s31, s34
    s_lshr_b32 s31, s31, 3
    s_mul_i32 s30, s30, 5
    s_add_u32 s30, s30, s31
    s_lshl_b32 s30, s30, 2
    s_add_u32 s30, s30, s39
    s_lshl_b32 s29, s30, 10
    v_mov_b32 v16, s28
    v_mov_b32 v17, s29
    v_cmp_gt_u32 vcc, 8, v1
    v_cndmask_b32 v16, v17, v16, vcc
    v_and_b32 v17, 7, v1
    v_lshl_add_u32 v16, v17, 7, v16
    v_mov_b32 v21, 163716
    s_lshr_b32 s34, s3, 2
    s_lshl_b32 s34, s34, 4
    s_add_u32 s34, s34, 163728
    v_mov_b32 v22, s34
    s_lshl_b32 s35, s39, 2
    v_add_u32 v23, s35, v22
    s_mov_b32 s40, 65536
    s_mov_b32 s41, 0
NG_C:
    v_mov_b32 v19, 163704
    ds_read_b32 v18, v19
    ds_read_b32 v19, v19 offset:4
    s_waitcnt lgkmcnt(0)
    v_readfirstlane_b32 s100, v18
    v_readfirstlane_b32 s101, v19
    s_cmp_lg_u32 s100, 0
    s_cbranch_scc1 NG_C_D
    s_sleep 1
    s_add_u32 s41, s41, 1
    s_cmp_lt_u32 s41, 1600000
    s_cbranch_scc1 NG_C
NG_C_D:
    s_waitcnt vmcnt(0)
    s_mov_b32 s41, 0
    s_mov_b32 s43, 0
    s_cmp_eq_u32 s64, 1
    s_cselect_b32 s57, 22, 0
    s_mov_b64 exec, 0xffff
    s_bfe_u32 s30, s65, 0x20001
    s_lshl_b32 s30, s30, 8
    s_add_u32 s28, s28, s30
    s_bfe_u32 s30, s68, 0x20001
    s_lshl_b32 s30, s30, 8
    s_add_u32 s29, s29, s30
    s_cmp_eq_u32 s64, 1
    s_cbranch_scc1 CP_A
    v_mov_b32 v16, s28
    v_mov_b32 v17, s29
    v_cmp_gt_u32 vcc, 8, v1
    v_cndmask_b32 v16, v17, v16, vcc
    v_and_b32 v17, 7, v1
    v_lshl_add_u32 v16, v17, 3, v16
PG_V:
    ds_read_b32 v20, v21 offset:116
    s_add_u32 s41, s41, 1
    s_waitcnt lgkmcnt(0)
    v_readfirstlane_b32 s42, v20
    s_cmp_ge_u32 s42, 5
    s_cbranch_scc1 PG_VD
    s_sleep 1
    s_cmp_lt_u32 s41, 400000
    s_cbranch_scc1 PG_V
PG_VD:
    s_sleep 6
    s_mov_b32 s41, 0
    s_mov_b32 s42, 0
CP_V:
    buffer_load_dwordx2 v[18:19], v16, s[52:55], s40 offen sc1
    s_waitcnt vmcnt(0)
    v_cmp_ne_u64 vcc, s[100:101], v[18:19]
    s_cmp_eq_u64 vcc, 0
    s_cbranch_scc1 CP_R
    s_mov_b64 exec, vcc
    s_sleep 4
    s_add_u32 s41, s41, 1
    s_cmp_lt_u32 s41, 100000
    s_cbranch_scc1 CP_V
    s_branch CP_R
CP_A:
    ds_read_b32 v20, v21
    ds_read_b32 v19, v21 offset:116
    s_add_u32 s41, s41, 1
    s_waitcnt lgkmcnt(0)
    v_readfirstlane_b32 s42, v20
    v_readfirstlane_b32 s30, v19
    s_cmp_ge_u32 s30, 5
    s_cbranch_scc1 PG_AD
    s_cmp_ge_u32 s41, 400000
    s_cbranch_scc1 PG_AD
    s_cmp_lg_u32 s42, 0
    s_cbranch_scc1 PG_AB
    s_sleep 1
    s_branch CP_A
PG_AB:
    s_cmp_ge_u32 s43, s57
    s_cbranch_scc1 TKA_1
    s_barrier
    s_add_u32 s43, s43, 1
TKA_1:
    s_branch CP_A
PG_AD:
    s_mov_b32 s41, 0
    s_cmp_lg_u32 s42, 0
    s_cbranch_scc1 CP_B
    s_sleep 6
CP_A2:
    s_buffer_load_dwordx16 s[72:87], s[52:55], s28 offset:65536 glc
    s_cmp_eq_u32 s28, s29
    s_cbranch_scc1 CP_N1
    s_buffer_load_dwordx8 s[88:95], s[52:55], s29 offset:65536 glc
    s_buffer_load_dwordx8 s[4:11], s[52:55], s29 offset:65568 glc
CP_N1:
    ds_read_b32 v20, v21
    s_waitcnt lgkmcnt(0)
    v_readfirstlane_b32 s42, v20
CP_K:
    s_cmp_eq_u64 s[72:73], s[100:101]
    s_cbranch_scc0 CP_F
    s_cmp_eq_u64 s[74:75], s[100:101]
    s_cbranch_scc0 CP_F
    s_cmp_eq_u64 s[76:77], s[100:101]
    s_cbranch_scc0 CP_F
    s_cmp_eq_u64 s[78:79], s[100:101]
    s_cbranch_scc0 CP_F
    s_cmp_eq_u64 s[80:81], s[100:101]
    s_cbranch_scc0 CP_F
    s_cmp_eq_u64 s[82:83], s[100:101]
    s_cbranch_scc0 CP_F
    s_cmp_eq_u64 s[84:85], s[100:101]
    s_cbranch_scc0 CP_F
    s_cmp_eq_u64 s[86:87], s[100:101]
    s_cbranch_scc0 CP_F
    s_cmp_eq_u32 s28, s29
    s_cbranch_scc1 CP_R
    s_cmp_eq_u64 s[88:89], s[100:101]
    s_cbranch_scc0 CP_F
    s_cmp_eq_u64 s[90:91], s[100:101]
    s_cbranch_scc0 CP_F
    s_cmp_eq_u64 s[92:93], s[100:101]
    s_cbranch_scc0 CP_F
    s_cmp_eq_u64 s[94:95], s[100:101]
    s_cbranch_scc0 CP_F
    s_cmp_eq_u64 s[4:5], s[100:101]
    s_cbranch_scc0 CP_F
    s_cmp_eq_u64 s[6:7], s[100:101]
    s_cbranch_scc0 CP_F
    s_cmp_eq_u64 s[8:9], s[100:101]
    s_cbranch_scc0 CP_F
    s_cmp_eq_u64 s[10:11], s[100:101]
    s_cbranch_scc0 CP_F
    s_branch CP_R
CP_F:
    s_add_u32 s41, s41, 1
    s_cmp_ge_u32 s41, 100000
    s_cbranch_scc1 CP_R
    s_cmp_lg_u32 s42, 0
    s_cbranch_scc1 CP_B
    s_sleep 2
    s_branch CP_A2
CP_B:
    s_buffer_load_dwordx16 s[72:87], s[52:55], s28 offset:65536 glc
    s_cmp_eq_u32 s28, s29
    s_cbranch_scc1 CP_N2
    s_buffer_load_dwordx8 s[88:95], s[52:55], s29 offset:65536 glc
    s_buffer_load_dwordx8 s[4:11], s[52:55], s29 offset:65568 glc
CP_N2:
CP_B2:
    s_cmp_ge_u32 s43, s57
    s_cbranch_scc1 CP_B2_D
    s_barrier
    s_add_u32 s43, s43, 1
    s_getreg_b32 s36, hwreg(HW_REG_IB_STS, 8, 4)
    s_cmp_lg_u32 s36, 0
    s_cbranch_scc1 CP_B2
CP_B2_D:
    s_waitcnt lgkmcnt(0)
    s_branch CP_K
CP_R:
    s_mov_b64 exec, -1
    buffer_load_dwordx4 v[4:7], v119, s[20:23], s58 offen sc1
    buffer_load_dwordx4 v[112:115], v119, s[20:23], s59 offen sc1
    s_cmp_eq_u32 s42, 0
    s_cbranch_scc1 CP_W
CP_W2:
    s_cmp_ge_u32 s43, s57
    s_cbranch_scc1 CP_W2_D
    s_barrier
    s_add_u32 s43, s43, 1
    s_getreg_b32 s36, hwreg(HW_REG_IB_STS, 0, 4)
    s_cmp_lg_u32 s36, 0
    s_cbranch_scc1 CP_W2
CP_W2_D:
CP_W:
    s_add_u32 s42, s43, 1
    v_mov_b32 v20, s42
    s_waitcnt vmcnt(1)
    ds_write_b128 v118, v[4:7]
    s_waitcnt vmcnt(0)
    ds_write_b128 v118, v[112:115] offset:4608
    ds_write_b32 v23, v20
    s_waitcnt lgkmcnt(0)
    s_lshr_b32 s34, s3, 2
    s_lshl_b32 s34, s34, 2
    s_add_u32 s34, s34, 163784
    v_mov_b32 v22, s34
    v_mov_b32 v20, 1
    s_mov_b64 exec, 1
    ds_add_u32 v22, v20
    s_mov_b64 exec, -1
    s_mov_b32 s41, 0
LC_C1:
    ds_read_b32 v20, v22 offset:0
    s_add_u32 s41, s41, 1
    s_waitcnt lgkmcnt(0)
    v_readfirstlane_b32 s42, v20
    s_cmp_ge_u32 s42, 4
    s_cbranch_scc1 LC_C1_D
    s_cmp_ge_u32 s43, s57
    s_cbranch_scc1 TKA_2
    s_barrier
    s_add_u32 s43, s43, 1
TKA_2:
    s_sleep 1
    s_cmp_lt_u32 s41, 1600000
    s_cbranch_scc1 LC_C1
LC_C1_D:
    v_mov_b32 v22, 163780
    s_mov_b32 s41, 0
LC_C2:
    ds_read_b32 v20, v22 offset:0
    s_add_u32 s41, s41, 1
    s_waitcnt lgkmcnt(0)
    v_readfirstlane_b32 s42, v20
    s_cmp_ge_u32 s42, 4
    s_cbranch_scc1 LC_C2_D
    s_cmp_ge_u32 s43, s57
    s_cbranch_scc1 TKA_3
    s_barrier
    s_add_u32 s43, s43, 1
TKA_3:
    s_sleep 1
    s_cmp_lt_u32 s41, 1600000
    s_cbranch_scc1 LC_C2
LC_C2_D:
    s_cmp_eq_u32 s64, 1
    s_cselect_b32 s43, s43, 100
    s_branch CP_D
    s_mov_b32 s41, 0
CP_C:
    s_barrier
    s_add_u32 s43, s43, 1
    ds_read_b128 v[24:27], v22
    s_add_u32 s41, s41, 1
    s_waitcnt lgkmcnt(0)
    v_subrev_u32 v24, 1, v24
    v_subrev_u32 v25, 1, v25
    v_subrev_u32 v26, 1, v26
    v_subrev_u32 v27, 1, v27
    v_max_u32 v24, v24, v25
    v_max_u32 v26, v26, v27
    v_max_u32 v24, v24, v26
    s_nop 0
    v_readfirstlane_b32 s42, v24
    s_cmp_ge_u32 s41, 400000
    s_cbranch_scc1 CP_D
    s_cmp_ge_u32 s42, s43
    s_cbranch_scc1 CP_C
CP_D:
    s_cmp_ge_u32 s43, 5
    s_cbranch_scc1 LC_SD
    s_barrier
    s_add_u32 s43, s43, 1
    s_branch CP_D
LC_SD:
    s_add_u32 s60, s12, 27262976
    s_addc_u32 s61, s13, 0
    s_mov_b32 s62, 12582912
    s_mov_b32 s63, 0x00020000
    s_cmp_eq_u32 s38, 0
    s_cselect_b32 s48, s65, s69
    s_cselect_b32 s29, s70, s71
    s_cmp_ge_u32 s48, 640
    s_cbranch_scc1 LC_I
    s_mul_i32 s40, s49, 640
    s_add_u32 s40, s40, s48
    s_lshl_b32 s40, s40, 4
    s_add_u32 s40, s40, 491520
    s_and_b32 s28, s48, 1
    s_lshl_b32 s28, s28, 4
    s_lshr_b32 s29, s29, s28
    s_lshl_b32 s29, s29, 16
    s_lshl_b32 s48, s48, 7
    s_mul_i32 s28, s49, 1310720
    s_add_u32 s48, s48, s28
    ds_read_b64 v[112:113], v8 offset:0
    ds_read_b64 v[114:115], v8 offset:8
    ds_read_b128 v[48:51], v10 offset:192
    ds_read_b128 v[52:55], v10 offset:704
    ds_read_b64 v[116:117], v8 offset:512
    ds_read_b64 v[118:119], v8 offset:520
    ds_read_b128 v[56:59], v10 offset:1216
    ds_read_b128 v[60:63], v10 offset:1728
    ds_read_b128 v[64:67], v10 offset:2240
    ds_read_b128 v[68:71], v10 offset:2752
    ds_read_b128 v[72:75], v10 offset:3264
    ds_read_b128 v[76:79], v10 offset:3776
    s_setprio 3
    s_mov_b32 s56, 0
    s_cmp_lt_u32 s3, 8
    s_cselect_b32 s28, 108, 0
    s_add_u32 s28, s28, 163720
    v_mov_b32 v6, s28
    v_mov_b32 v5, 0
    s_cmp_ge_u32 s43, s57
    s_cbranch_scc1 TKA_4
    s_barrier
    s_add_u32 s43, s43, 1
TKA_4:
    s_waitcnt lgkmcnt(9)
    v_mfma_f32_16x16x32_bf16 v[16:19], v[112:115], v[48:51], 0
    ds_read_b64 v[120:121], v8 offset:1024
    s_waitcnt lgkmcnt(9)
    v_mfma_f32_16x16x32_bf16 v[20:23], v[112:115], v[52:55], 0
    ds_read_b64 v[122:123], v8 offset:1032
    s_waitcnt lgkmcnt(7)
    v_mfma_f32_16x16x32_bf16 v[24:27], v[112:115], v[56:59], 0
    ds_read_b128 v[80:83], v10 offset:128
    s_waitcnt lgkmcnt(7)
    v_mfma_f32_16x16x32_bf16 v[28:31], v[112:115], v[60:63], 0
    ds_read_b128 v[84:87], v10 offset:640
    s_waitcnt lgkmcnt(7)
    v_mfma_f32_16x16x32_bf16 v[32:35], v[112:115], v[64:67], 0
    s_cmp_ge_u32 s43, s57
    s_cbranch_scc1 TKA_5
    s_barrier
    s_add_u32 s43, s43, 1
TKA_5:
    s_waitcnt lgkmcnt(6)
    v_mfma_f32_16x16x32_bf16 v[36:39], v[112:115], v[68:71], 0
    s_waitcnt lgkmcnt(5)
    v_mfma_f32_16x16x32_bf16 v[40:43], v[112:115], v[72:75], 0
    s_waitcnt lgkmcnt(4)
    v_mfma_f32_16x16x32_bf16 v[44:47], v[112:115], v[76:79], 0
    s_waitcnt lgkmcnt(10)
    v_mfma_f32_16x16x32_bf16 v[20:23], v[116:119], v[48:51], v[20:23]
    ds_read_b64 v[112:113], v8 offset:1536
    s_waitcnt lgkmcnt(11)
    v_mfma_f32_16x16x32_bf16 v[24:27], v[116:119], v[52:55], v[24:27]
    ds_read_b64 v[114:115], v8 offset:1544
    s_cmp_ge_u32 s43, s57
    s_cbranch_scc1 TKA_6
    s_barrier
    s_add_u32 s43, s43, 1
TKA_6:
    s_waitcnt lgkmcnt(11)
    v_mfma_f32_16x16x32_bf16 v[28:31], v[116:119], v[56:59], v[28:31]
    ds_read_b128 v[88:91], v10 offset:1152
    s_waitcnt lgkmcnt(11)
    v_mfma_f32_16x16x32_bf16 v[32:35], v[116:119], v[60:63], v[32:35]
    ds_read_b128 v[92:95], v10 offset:1664
    s_waitcnt lgkmcnt(11)
    v_mfma_f32_16x16x32_bf16 v[36:39], v[116:119], v[64:67], v[36:39]
    s_waitcnt lgkmcnt(10)
    v_mfma_f32_16x16x32_bf16 v[40:43], v[116:119], v[68:71], v[40:43]
    s_waitcnt lgkmcnt(9)
    v_mfma_f32_16x16x32_bf16 v[44:47], v[116:119], v[72:75], v[44:47]
    s_cmp_ge_u32 s43, s57
    s_cbranch_scc1 TKA_7
    s_barrier
    s_add_u32 s43, s43, 1
TKA_7:
    s_waitcnt lgkmcnt(6)
    v_mfma_f32_16x16x32_bf16 v[24:27], v[120:123], v[48:51], v[24:27]
    ds_read_b64 v[116:117], v8 offset:2048
    s_waitcnt lgkmcnt(7)
    v_mfma_f32_16x16x32_bf16 v[28:31], v[120:123], v[52:55], v[28:31]
    ds_read_b64 v[118:119], v8 offset:2056
    s_waitcnt lgkmcnt(8)
    v_mfma_f32_16x16x32_bf16 v[32:35], v[120:123], v[56:59], v[32:35]
    ds_read_b128 v[96:99], v10 offset:2176
    s_waitcnt lgkmcnt(9)
    v_mfma_f32_16x16x32_bf16 v[36:39], v[120:123], v[60:63], v[36:39]
    s_waitcnt lgkmcnt(9)
    v_mfma_f32_16x16x32_bf16 v[40:43], v[120:123], v[64:67], v[40:43]
    s_cmp_ge_u32 s43, s57
    s_cbranch_scc1 TKA_8
    s_barrier
    s_add_u32 s43, s43, 1
TKA_8:
    s_waitcnt lgkmcnt(9)
    v_mfma_f32_16x16x32_bf16 v[44:47], v[120:123], v[68:71], v[44:47]
    s_waitcnt lgkmcnt(5)
    v_mfma_f32_16x16x32_bf16 v[28:31], v[112:115], v[48:51], v[28:31]
    ds_read_b64 v[120:121], v8 offset:2560
    s_waitcnt lgkmcnt(6)
    v_mfma_f32_16x16x32_bf16 v[32:35], v[112:115], v[52:55], v[32:35]
    ds_read_b64 v[122:123], v8 offset:2568
    s_waitcnt lgkmcnt(7)
    v_mfma_f32_16x16x32_bf16 v[36:39], v[112:115], v[56:59], v[36:39]
    ds_read_b128 v[100:103], v10 offset:2688
    s_waitcnt lgkmcnt(8)
    v_mfma_f32_16x16x32_bf16 v[40:43], v[112:115], v[60:63], v[40:43]
    s_cmp_ge_u32 s43, s57
    s_cbranch_scc1 TKA_9
    s_barrier
    s_add_u32 s43, s43, 1
TKA_9:
    s_waitcnt lgkmcnt(8)
    v_mfma_f32_16x16x32_bf16 v[44:47], v[112:115], v[64:67], v[44:47]
    s_waitcnt lgkmcnt(4)
    v_mfma_f32_16x16x32_bf16 v[32:35], v[116:119], v[48:51], v[32:35]
    ds_read_b64 v[112:113], v8 offset:3072
    s_waitcnt lgkmcnt(5)
    v_mfma_f32_16x16x32_bf16 v[36:39], v[116:119], v[52:55], v[36:39]
    ds_read_b64 v[114:115], v8 offset:3080
    s_waitcnt lgkmcnt(6)
    v_mfma_f32_16x16x32_bf16 v[40:43], v[116:119], v[56:59], v[40:43]
    ds_read_b128 v[104:107], v10 offset:3200
    s_waitcnt lgkmcnt(7)
    v_mfma_f32_16x16x32_bf16 v[44:47], v[116:119], v[60:63], v[44:47]
    s_cmp_ge_u32 s43, s57
    s_cbranch_scc1 TKA_10
    s_barrier
    s_add_u32 s43, s43, 1
TKA_10:
    s_waitcnt lgkmcnt(4)
    v_mfma_f32_16x16x32_bf16 v[44:47], v[120:123], v[56:59], v[44:47]
    ds_read_b64 v[116:117], v8 offset:3584
    s_waitcnt lgkmcnt(5)
    v_mfma_f32_16x16x32_bf16 v[40:43], v[120:123], v[52:55], v[40:43]
    ds_read_b64 v[118:119], v8 offset:3592
    s_waitcnt lgkmcnt(6)
    v_mfma_f32_16x16x32_bf16 v[36:39], v[120:123], v[48:51], v[36:39]
    ds_read_b128 v[108:111], v10 offset:3712
    s_waitcnt lgkmcnt(4)
    v_mfma_f32_16x16x32_bf16 v[44:47], v[112:115], v[52:55], v[44:47]
    ds_read_b64 v[120:121], v8 offset:64
    s_waitcnt lgkmcnt(5)
    v_mfma_f32_16x16x32_bf16 v[40:43], v[112:115], v[48:51], v[40:43]
    ds_read_b64 v[122:123], v8 offset:72
    s_cmp_ge_u32 s43, s57
    s_cbranch_scc1 TKA_11
    s_barrier
    s_add_u32 s43, s43, 1
TKA_11:
    s_waitcnt lgkmcnt(3)
    v_mfma_f32_16x16x32_bf16 v[44:47], v[116:119], v[48:51], v[44:47]
    ds_read_b64 v[112:113], v8 offset:576
    ds_read_b64 v[114:115], v8 offset:584
    s_waitcnt lgkmcnt(2)
    v_mfma_f32_16x16x32_bf16 v[16:19], v[120:123], v[80:83], v[16:19]
    ds_read_b64 v[116:117], v8 offset:1088
    s_waitcnt lgkmcnt(3)
    v_mfma_f32_16x16x32_bf16 v[20:23], v[120:123], v[84:87], v[20:23]
    ds_read_b64 v[118:119], v8 offset:1096
    s_waitcnt lgkmcnt(4)
    v_mfma_f32_16x16x32_bf16 v[24:27], v[120:123], v[88:91], v[24:27]
    ds_read_b128 v[48:51], v10 offset:64
    s_waitcnt lgkmcnt(5)
    v_mfma_f32_16x16x32_bf16 v[28:31], v[120:123], v[92:95], v[28:31]
    ds_read_b128 v[52:55], v10 offset:576
    s_cmp_ge_u32 s43, s57
    s_cbranch_scc1 TKA_12
    s_barrier
    s_add_u32 s43, s43, 1
TKA_12:
    s_waitcnt lgkmcnt(6)
    v_mfma_f32_16x16x32_bf16 v[32:35], v[120:123], v[96:99], v[32:35]
    s_waitcnt lgkmcnt(6)
    v_mfma_f32_16x16x32_bf16 v[36:39], v[120:123], v[100:103], v[36:39]
    s_waitcnt lgkmcnt(6)
    v_mfma_f32_16x16x32_bf16 v[40:43], v[120:123], v[104:107], v[40:43]
    s_waitcnt lgkmcnt(6)
    v_mfma_f32_16x16x32_bf16 v[44:47], v[120:123], v[108:111], v[44:47]
    s_waitcnt lgkmcnt(4)
    v_mfma_f32_16x16x32_bf16 v[20:23], v[112:115], v[80:83], v[20:23]
    ds_read_b64 v[120:121], v8 offset:1600
    s_cmp_ge_u32 s43, s57
    s_cbranch_scc1 TKA_13
    s_barrier
    s_add_u32 s43, s43, 1
TKA_13:
    s_waitcnt lgkmcnt(5)
    v_mfma_f32_16x16x32_bf16 v[24:27], v[112:115], v[84:87], v[24:27]
    ds_read_b64 v[122:123], v8 offset:1608
    s_waitcnt lgkmcnt(6)
    v_mfma_f32_16x16x32_bf16 v[28:31], v[112:115], v[88:91], v[28:31]
    ds_read_b128 v[56:59], v10 offset:1088
    s_waitcnt lgkmcnt(7)
    v_mfma_f32_16x16x32_bf16 v[32:35], v[112:115], v[92:95], v[32:35]
    ds_read_b128 v[60:63], v10 offset:1600
    s_waitcnt lgkmcnt(8)
    v_mfma_f32_16x16x32_bf16 v[36:39], v[112:115], v[96:99], v[36:39]
    s_waitcnt lgkmcnt(8)
    v_mfma_f32_16x16x32_bf16 v[40:43], v[112:115], v[100:103], v[40:43]
    s_cmp_ge_u32 s43, s57
    s_cbranch_scc1 TKA_14
    s_barrier
    s_add_u32 s43, s43, 1
TKA_14:
    s_waitcnt lgkmcnt(8)
    v_mfma_f32_16x16x32_bf16 v[44:47], v[112:115], v[104:107], v[44:47]
    s_waitcnt lgkmcnt(6)
    v_mfma_f32_16x16x32_bf16 v[24:27], v[116:119], v[80:83], v[24:27]
    ds_read_b64 v[112:113], v8 offset:2112
    s_waitcnt lgkmcnt(7)
    v_mfma_f32_16x16x32_bf16 v[28:31], v[116:119], v[84:87], v[28:31]
    ds_read_b64 v[114:115], v8 offset:2120
    s_waitcnt lgkmcnt(8)
    v_mfma_f32_16x16x32_bf16 v[32:35], v[116:119], v[88:91], v[32:35]
    ds_read_b128 v[64:67], v10 offset:2112
    s_waitcnt lgkmcnt(9)
    v_mfma_f32_16x16x32_bf16 v[36:39], v[116:119], v[92:95], v[36:39]
    s_cmp_ge_u32 s43, s57
    s_cbranch_scc1 TKA_15
    s_barrier
    s_add_u32 s43, s43, 1
TKA_15:
    s_waitcnt lgkmcnt(9)
    v_mfma_f32_16x16x32_bf16 v[40:43], v[116:119], v[96:99], v[40:43]
    s_waitcnt lgkmcnt(9)
    v_mfma_f32_16x16x32_bf16 v[44:47], v[116:119], v[100:103], v[44:47]
    s_waitcnt lgkmcnt(5)
    v_mfma_f32_16x16x32_bf16 v[28:31], v[120:123], v[80:83], v[28:31]
    ds_read_b64 v[116:117], v8 offset:2624
    s_waitcnt lgkmcnt(6)
    v_mfma_f32_16x16x32_bf16 v[32:35], v[120:123], v[84:87], v[32:35]
    ds_read_b64 v[118:119], v8 offset:2632
    s_waitcnt lgkmcnt(7)
    v_mfma_f32_16x16x32_bf16 v[36:39], v[120:123], v[88:91], v[36:39]
    ds_read_b128 v[68:71], v10 offset:2624
    s_cmp_ge_u32 s43, s57
    s_cbranch_scc1 TKA_16
    s_barrier
    s_add_u32 s43, s43, 1
TKA_16:
    s_waitcnt lgkmcnt(8)
    v_mfma_f32_16x16x32_bf16 v[40:43], v[120:123], v[92:95], v[40:43]
    s_waitcnt lgkmcnt(8)
    v_mfma_f32_16x16x32_bf16 v[44:47], v[120:123], v[96:99], v[44:47]
    s_waitcnt lgkmcnt(4)
    v_mfma_f32_16x16x32_bf16 v[32:35], v[112:115], v[80:83], v[32:35]
    ds_read_b64 v[120:121], v8 offset:3136
    s_waitcnt lgkmcnt(5)
    v_mfma_f32_16x16x32_bf16 v[36:39], v[112:115], v[84:87], v[36:39]
    ds_read_b64 v[122:123], v8 offset:3144
    s_waitcnt lgkmcnt(6)
    v_mfma_f32_16x16x32_bf16 v[40:43], v[112:115], v[88:91], v[40:43]
    ds_read_b128 v[72:75], v10 offset:3136
    s_cmp_ge_u32 s43, s57
    s_cbranch_scc1 TKA_17
    s_barrier
    s_add_u32 s43, s43, 1
TKA_17:
    s_waitcnt lgkmcnt(7)
    v_mfma_f32_16x16x32_bf16 v[44:47], v[112:115], v[92:95], v[44:47]
    s_waitcnt lgkmcnt(4)
    v_mfma_f32_16x16x32_bf16 v[44:47], v[116:119], v[88:91], v[44:47]
    ds_read_b64 v[112:113], v8 offset:3648
    s_waitcnt lgkmcnt(5)
    v_mfma_f32_16x16x32_bf16 v[40:43], v[116:119], v[84:87], v[40:43]
    ds_read_b64 v[114:115], v8 offset:3656
    s_waitcnt lgkmcnt(6)
    v_mfma_f32_16x16x32_bf16 v[36:39], v[116:119], v[80:83], v[36:39]
    ds_read_b128 v[76:79], v10 offset:3648
    s_waitcnt lgkmcnt(4)
    v_mfma_f32_16x16x32_bf16 v[44:47], v[120:123], v[84:87], v[44:47]
    ds_read_b64 v[116:117], v8 offset:128
    s_cmp_ge_u32 s43, s57
    s_cbranch_scc1 TKA_18
    s_barrier
    s_add_u32 s43, s43, 1
TKA_18:
    s_waitcnt lgkmcnt(5)
    v_mfma_f32_16x16x32_bf16 v[40:43], v[120:123], v[80:83], v[40:43]
    ds_read_b64 v[118:119], v8 offset:136
    s_waitcnt lgkmcnt(3)
    v_mfma_f32_16x16x32_bf16 v[44:47], v[112:115], v[80:83], v[44:47]
    ds_read_b64 v[120:121], v8 offset:640
    ds_read_b64 v[122:123], v8 offset:648
    s_waitcnt lgkmcnt(2)
    v_mfma_f32_16x16x32_bf16 v[16:19], v[116:119], v[48:51], v[16:19]
    ds_read_b64 v[112:113], v8 offset:1152
    s_waitcnt lgkmcnt(3)
    v_mfma_f32_16x16x32_bf16 v[20:23], v[116:119], v[52:55], v[20:23]
    ds_read_b64 v[114:115], v8 offset:1160
    s_waitcnt lgkmcnt(4)
    v_mfma_f32_16x16x32_bf16 v[24:27], v[116:119], v[56:59], v[24:27]
    ds_read_b128 v[80:83], v10 offset:0
    s_cmp_ge_u32 s43, s57
    s_cbranch_scc1 TKA_19
    s_barrier
    s_add_u32 s43, s43, 1
TKA_19:
    s_cmp_ge_u32 s43, s57
    s_cbranch_scc1 TKA_20
    s_barrier
    s_add_u32 s43, s43, 1
TKA_20:
    s_waitcnt lgkmcnt(5)
    v_mfma_f32_16x16x32_bf16 v[28:31], v[116:119], v[60:63], v[28:31]
    ds_read_b128 v[84:87], v10 offset:512
    s_waitcnt lgkmcnt(6)
    v_mfma_f32_16x16x32_bf16 v[32:35], v[116:119], v[64:67], v[32:35]
    s_waitcnt lgkmcnt(6)
    v_mfma_f32_16x16x32_bf16 v[36:39], v[116:119], v[68:71], v[36:39]
    s_waitcnt lgkmcnt(6)
    v_mfma_f32_16x16x32_bf16 v[40:43], v[116:119], v[72:75], v[40:43]
    s_waitcnt lgkmcnt(6)
    v_mfma_f32_16x16x32_bf16 v[44:47], v[116:119], v[76:79], v[44:47]
    s_waitcnt lgkmcnt(4)
    v_mfma_f32_16x16x32_bf16 v[20:23], v[120:123], v[48:51], v[20:23]
    ds_read_b64 v[116:117], v8 offset:1664
    s_waitcnt lgkmcnt(5)
    v_mfma_f32_16x16x32_bf16 v[24:27], v[120:123], v[52:55], v[24:27]
    ds_read_b64 v[118:119], v8 offset:1672
    s_waitcnt lgkmcnt(6)
    v_mfma_f32_16x16x32_bf16 v[28:31], v[120:123], v[56:59], v[28:31]
    ds_read_b128 v[88:91], v10 offset:1024
    s_waitcnt lgkmcnt(7)
    v_mfma_f32_16x16x32_bf16 v[32:35], v[120:123], v[60:63], v[32:35]
    ds_read_b128 v[92:95], v10 offset:1536
    s_waitcnt lgkmcnt(8)
    v_mfma_f32_16x16x32_bf16 v[36:39], v[120:123], v[64:67], v[36:39]
    s_waitcnt lgkmcnt(8)
    v_mfma_f32_16x16x32_bf16 v[40:43], v[120:123], v[68:71], v[40:43]
    s_waitcnt lgkmcnt(8)
    v_mfma_f32_16x16x32_bf16 v[44:47], v[120:123], v[72:75], v[44:47]
    s_waitcnt lgkmcnt(6)
    v_mfma_f32_16x16x32_bf16 v[24:27], v[112:115], v[48:51], v[24:27]
    ds_read_b64 v[120:121], v8 offset:2176
    s_waitcnt lgkmcnt(7)
    v_mfma_f32_16x16x32_bf16 v[28:31], v[112:115], v[52:55], v[28:31]
    ds_read_b64 v[122:123], v8 offset:2184
    s_waitcnt lgkmcnt(8)
    v_mfma_f32_16x16x32_bf16 v[32:35], v[112:115], v[56:59], v[32:35]
    ds_read_b128 v[96:99], v10 offset:2048
    s_waitcnt lgkmcnt(9)
    v_mfma_f32_16x16x32_bf16 v[36:39], v[112:115], v[60:63], v[36:39]
    s_waitcnt lgkmcnt(9)
    v_mfma_f32_16x16x32_bf16 v[40:43], v[112:115], v[64:67], v[40:43]
    s_waitcnt lgkmcnt(9)
    v_mfma_f32_16x16x32_bf16 v[44:47], v[112:115], v[68:71], v[44:47]
    s_waitcnt lgkmcnt(5)
    v_mfma_f32_16x16x32_bf16 v[28:31], v[116:119], v[48:51], v[28:31]
    ds_read_b64 v[112:113], v8 offset:2688
    s_waitcnt lgkmcnt(6)
    v_mfma_f32_16x16x32_bf16 v[32:35], v[116:119], v[52:55], v[32:35]
    ds_read_b64 v[114:115], v8 offset:2696
    s_waitcnt lgkmcnt(7)
    v_mfma_f32_16x16x32_bf16 v[36:39], v[116:119], v[56:59], v[36:39]
    ds_read_b128 v[100:103], v10 offset:2560
    s_waitcnt lgkmcnt(8)
    v_mfma_f32_16x16x32_bf16 v[40:43], v[116:119], v[60:63], v[40:43]
    s_waitcnt lgkmcnt(8)
    v_mfma_f32_16x16x32_bf16 v[44:47], v[116:119], v[64:67], v[44:47]
    s_waitcnt lgkmcnt(4)
    v_mfma_f32_16x16x32_bf16 v[32:35], v[120:123], v[48:51], v[32:35]
    ds_read_b64 v[116:117], v8 offset:3200
    s_waitcnt lgkmcnt(5)
    v_mfma_f32_16x16x32_bf16 v[36:39], v[120:123], v[52:55], v[36:39]
    ds_read_b64 v[118:119], v8 offset:3208
    s_waitcnt lgkmcnt(6)
    v_mfma_f32_16x16x32_bf16 v[40:43], v[120:123], v[56:59], v[40:43]
    ds_read_b128 v[104:107], v10 offset:3072
    s_waitcnt lgkmcnt(7)
    v_mfma_f32_16x16x32_bf16 v[44:47], v[120:123], v[60:63], v[44:47]
    s_waitcnt lgkmcnt(4)
    v_mfma_f32_16x16x32_bf16 v[44:47], v[112:115], v[56:59], v[44:47]
    ds_read_b64 v[120:121], v8 offset:3712
    s_waitcnt lgkmcnt(5)
    v_mfma_f32_16x16x32_bf16 v[40:43], v[112:115], v[52:55], v[40:43]
    ds_read_b64 v[122:123], v8 offset:3720
    s_waitcnt lgkmcnt(6)
    v_mfma_f32_16x16x32_bf16 v[36:39], v[112:115], v[48:51], v[36:39]
    ds_read_b128 v[108:111], v10 offset:3584
    s_waitcnt lgkmcnt(4)
    v_mfma_f32_16x16x32_bf16 v[44:47], v[116:119], v[52:55], v[44:47]
    ds_read_b64 v[112:113], v8 offset:192
    s_waitcnt lgkmcnt(5)
    v_mfma_f32_16x16x32_bf16 v[40:43], v[116:119], v[48:51], v[40:43]
    ds_read_b64 v[114:115], v8 offset:200
    s_waitcnt lgkmcnt(3)
    v_mfma_f32_16x16x32_bf16 v[44:47], v[120:123], v[48:51], v[44:47]
    ds_read_b64 v[116:117], v8 offset:704
    ds_read_b64 v[118:119], v8 offset:712
    s_waitcnt lgkmcnt(2)
    v_mfma_f32_16x16x32_bf16 v[16:19], v[112:115], v[80:83], v[16:19]
    ds_read_b64 v[120:121], v8 offset:1216
    s_waitcnt lgkmcnt(3)
    v_mfma_f32_16x16x32_bf16 v[20:23], v[112:115], v[84:87], v[20:23]
    ds_read_b64 v[122:123], v8 offset:1224
    s_waitcnt lgkmcnt(4)
    v_mfma_f32_16x16x32_bf16 v[24:27], v[112:115], v[88:91], v[24:27]
    ds_read_b64 v[48:49], v13 offset:0
    s_waitcnt lgkmcnt(5)
    v_mfma_f32_16x16x32_bf16 v[28:31], v[112:115], v[92:95], v[28:31]
    ds_read_b64 v[50:51], v13 offset:512
    s_waitcnt lgkmcnt(6)
    v_mfma_f32_16x16x32_bf16 v[32:35], v[112:115], v[96:99], v[32:35]
    ds_read_b64 v[52:53], v13 offset:1024
    s_waitcnt lgkmcnt(7)
    v_mfma_f32_16x16x32_bf16 v[36:39], v[112:115], v[100:103], v[36:39]
    ds_read_b64 v[54:55], v13 offset:1536
    s_waitcnt lgkmcnt(8)
    v_mfma_f32_16x16x32_bf16 v[40:43], v[112:115], v[104:107], v[40:43]
    s_waitcnt lgkmcnt(8)
    v_mfma_f32_16x16x32_bf16 v[44:47], v[112:115], v[108:111], v[44:47]
    s_waitcnt lgkmcnt(6)
    v_mfma_f32_16x16x32_bf16 v[20:23], v[116:119], v[80:83], v[20:23]
    ds_read_b64 v[112:113], v8 offset:1728
    s_waitcnt lgkmcnt(1)
    v_and_b32 v56, 0xffff0000, v49
    s_waitcnt lgkmcnt(7)
    v_mfma_f32_16x16x32_bf16 v[24:27], v[116:119], v[84:87], v[24:27]
    ds_read_b64 v[114:115], v8 offset:1736
    v_lshlrev_b32 v57, 16, v49
    v_and_b32 v58, 0xffff0000, v48
    s_waitcnt lgkmcnt(8)
    v_mfma_f32_16x16x32_bf16 v[28:31], v[116:119], v[88:91], v[28:31]
    v_lshlrev_b32 v59, 16, v48
    v_mul_f32 v56, s29, v56
    s_waitcnt lgkmcnt(8)
    v_mfma_f32_16x16x32_bf16 v[32:35], v[116:119], v[92:95], v[32:35]
    v_mul_f32 v57, s29, v57
    v_mul_f32 v58, s29, v58
    s_waitcnt lgkmcnt(8)
    v_mfma_f32_16x16x32_bf16 v[36:39], v[116:119], v[96:99], v[36:39]
    v_mul_f32 v59, s29, v59
    s_waitcnt lgkmcnt(8)
    v_mfma_f32_16x16x32_bf16 v[40:43], v[116:119], v[100:103], v[40:43]
    v_cvt_pk_bf16_f32 v48, v56, v57
    s_waitcnt lgkmcnt(8)
    v_mfma_f32_16x16x32_bf16 v[44:47], v[116:119], v[104:107], v[44:47]
    v_cvt_pk_bf16_f32 v49, v58, v59
    s_waitcnt lgkmcnt(6)
    v_mfma_f32_16x16x32_bf16 v[24:27], v[120:123], v[80:83], v[24:27]
    ds_read_b64 v[116:117], v8 offset:2240
    v_and_b32 v56, 0xffff0000, v51
    v_lshlrev_b32 v57, 16, v51
    s_waitcnt lgkmcnt(7)
    v_mfma_f32_16x16x32_bf16 v[28:31], v[120:123], v[84:87], v[28:31]
    ds_read_b64 v[118:119], v8 offset:2248
    v_and_b32 v58, 0xffff0000, v50
    v_lshlrev_b32 v59, 16, v50
    s_waitcnt lgkmcnt(8)
    v_mfma_f32_16x16x32_bf16 v[32:35], v[120:123], v[88:91], v[32:35]
    v_mul_f32 v56, s29, v56
    v_mul_f32 v57, s29, v57
    s_waitcnt lgkmcnt(8)
    v_mfma_f32_16x16x32_bf16 v[36:39], v[120:123], v[92:95], v[36:39]
    v_mul_f32 v58, s29, v58
    v_mul_f32 v59, s29, v59
    s_waitcnt lgkmcnt(8)
    v_mfma_f32_16x16x32_bf16 v[40:43], v[120:123], v[96:99], v[40:43]
    v_cvt_pk_bf16_f32 v50, v56, v57
    s_waitcnt lgkmcnt(8)
    v_mfma_f32_16x16x32_bf16 v[44:47], v[120:123], v[100:103], v[44:47]
    v_cvt_pk_bf16_f32 v51, v58, v59
    s_waitcnt lgkmcnt(2)
    v_mfma_f32_16x16x32_bf16 v[28:31], v[112:115], v[80:83], v[28:31]
    ds_read_b64 v[120:121], v8 offset:2752
    v_and_b32 v56, 0xffff0000, v53
    v_lshlrev_b32 v57, 16, v53
    s_waitcnt lgkmcnt(3)
    v_mfma_f32_16x16x32_bf16 v[32:35], v[112:115], v[84:87], v[32:35]
    ds_read_b64 v[122:123], v8 offset:2760
    v_and_b32 v58, 0xffff0000, v52
    v_lshlrev_b32 v59, 16, v52
    s_waitcnt lgkmcnt(4)
    v_mfma_f32_16x16x32_bf16 v[36:39], v[112:115], v[88:91], v[36:39]
    v_mul_f32 v56, s29, v56
    v_mul_f32 v57, s29, v57
    s_waitcnt lgkmcnt(4)
    v_mfma_f32_16x16x32_bf16 v[40:43], v[112:115], v[92:95], v[40:43]
    v_mul_f32 v58, s29, v58
    v_mul_f32 v59, s29, v59
    s_waitcnt lgkmcnt(4)
    v_mfma_f32_16x16x32_bf16 v[44:47], v[112:115], v[96:99], v[44:47]
    v_cvt_pk_bf16_f32 v52, v56, v57
    v_cvt_pk_bf16_f32 v53, v58, v59
    s_waitcnt lgkmcnt(2)
    v_mfma_f32_16x16x32_bf16 v[32:35], v[116:119], v[80:83], v[32:35]
    ds_read_b64 v[112:113], v8 offset:3264
    v_and_b32 v56, 0xffff0000, v55
    v_lshlrev_b32 v57, 16, v55
    v_and_b32 v58, 0xffff0000, v54
    s_waitcnt lgkmcnt(3)
    v_mfma_f32_16x16x32_bf16 v[36:39], v[116:119], v[84:87], v[36:39]
    ds_read_b64 v[114:115], v8 offset:3272
    v_lshlrev_b32 v59, 16, v54
    v_mul_f32 v56, s29, v56
    v_mul_f32 v57, s29, v57
    s_waitcnt lgkmcnt(4)
    v_mfma_f32_16x16x32_bf16 v[40:43], v[116:119], v[88:91], v[40:43]
    v_mul_f32 v58, s29, v58
    v_mul_f32 v59, s29, v59
    s_waitcnt lgkmcnt(4)
    v_mfma_f32_16x16x32_bf16 v[44:47], v[116:119], v[92:95], v[44:47]
    v_cvt_pk_bf16_f32 v54, v56, v57
    v_cvt_pk_bf16_f32 v55, v58, v59
    s_waitcnt lgkmcnt(2)
    v_mfma_f32_16x16x32_bf16 v[44:47], v[120:123], v[88:91], v[44:47]
    ds_read_b64 v[116:117], v8 offset:3776
    s_waitcnt lgkmcnt(3)
    v_mfma_f32_16x16x32_bf16 v[40:43], v[120:123], v[84:87], v[40:43]
    ds_read_b64 v[118:119], v8 offset:3784
    s_waitcnt lgkmcnt(4)
    v_mfma_f32_16x16x32_bf16 v[36:39], v[120:123], v[80:83], v[36:39]
    s_waitcnt lgkmcnt(2)
    v_mfma_f32_16x16x32_bf16 v[44:47], v[112:115], v[84:87], v[44:47]
    s_waitcnt lgkmcnt(2)
    v_mfma_f32_16x16x32_bf16 v[40:43], v[112:115], v[80:83], v[40:43]
    s_waitcnt lgkmcnt(0)
    v_mfma_f32_16x16x32_bf16 v[44:47], v[116:119], v[80:83], v[44:47]
    s_setprio 3
    s_lshr_b32 s28, s3, 1
    s_lshl_b32 s28, s28, 2
    s_add_u32 s28, s28, 163796
    v_mov_b32 v3, s28
    s_waitcnt lgkmcnt(0)
    v_mov_b32 v4, 1
    s_mov_b64 exec, 1
    ds_add_u32 v3, v4
    s_mov_b64 exec, -1
    s_mov_b32 s41, 0
C2_S1:
    ds_read_b32 v4, v3
    s_add_u32 s41, s41, 1
    s_waitcnt lgkmcnt(0)
    v_readfirstlane_b32 s42, v4
    s_cmp_ge_u32 s42, 2
    s_cbranch_scc1 C2_S1_D
    s_cmp_lt_u32 s41, 3
    s_cbranch_scc1 C2_S1
    s_cmp_ge_u32 s43, s57
    s_cbranch_scc1 TKA_21
    s_barrier
    s_add_u32 s43, s43, 1
TKA_21:
    s_cmp_lt_u32 s41, 400000
    s_cbranch_scc1 C2_S1
C2_S1_D:
    s_nop 7
    s_cmp_eq_u32 s49, 0
    s_cbranch_scc1 C2_X
    v_swap_b32 v16, v32
    v_swap_b32 v17, v33
    v_swap_b32 v18, v34
    v_swap_b32 v19, v35
    v_swap_b32 v20, v36
    v_swap_b32 v21, v37
    v_swap_b32 v22, v38
    v_swap_b32 v23, v39
    v_swap_b32 v24, v40
    v_swap_b32 v25, v41
    v_swap_b32 v26, v42
    v_swap_b32 v27, v43
    v_swap_b32 v28, v44
    v_swap_b32 v29, v45
    v_swap_b32 v30, v46
    v_swap_b32 v31, v47
C2_X:
    s_nop 1
    ds_write_b128 v14, v[32:35] offset:0
    ds_write_b128 v14, v[36:39] offset:1024
    ds_write_b128 v14, v[40:43] offset:2048
    ds_write_b128 v14, v[44:47] offset:3072
    s_waitcnt lgkmcnt(0)
    v_mov_b32 v4, 1
    s_mov_b64 exec, 1
    ds_add_u32 v3, v4
    s_mov_b64 exec, -1
    s_mov_b32 s41, 0
C2_S2:
    ds_read_b32 v4, v3
    s_add_u32 s41, s41, 1
    s_waitcnt lgkmcnt(0)
    v_readfirstlane_b32 s42, v4
    s_cmp_ge_u32 s42, 4
    s_cbranch_scc1 C2_S2_D
    s_cmp_lt_u32 s41, 3
    s_cbranch_scc1 C2_S2
    s_cmp_ge_u32 s43, s57
    s_cbranch_scc1 TKA_22
    s_barrier
    s_add_u32 s43, s43, 1
TKA_22:
    s_cmp_lt_u32 s41, 400000
    s_cbranch_scc1 C2_S2
C2_S2_D:
    ds_read_b128 v[32:35], v15 offset:0
    ds_read_b128 v[36:39], v15 offset:1024
    ds_read_b128 v[40:43], v15 offset:2048
    ds_read_b128 v[44:47], v15 offset:3072
    s_waitcnt lgkmcnt(3)
    v_add_f32 v16, v16, v32
    v_add_f32 v17, v17, v33
    v_add_f32 v18, v18, v34
    v_add_f32 v19, v19, v35
    v_cvt_pk_bf16_f32 v16, 0, v16
    v_cvt_pk_bf16_f32 v17, 0, v17
    v_cvt_pk_bf16_f32 v18, 0, v18
    v_cvt_pk_bf16_f32 v19, 0, v19
    v_lshlrev_b32 v34, 16, v48
    v_and_b32 v35, 0xffff0000, v48
    v_add_f32 v16, v16, v34
    v_add_f32 v17, v17, v35
    v_lshlrev_b32 v34, 16, v49
    v_and_b32 v35, 0xffff0000, v49
    v_add_f32 v18, v18, v34
    v_add_f32 v19, v19, v35
    v_cvt_pk_bf16_f32 v32, v16, v17
    v_cvt_pk_bf16_f32 v33, v18, v19
    buffer_store_dwordx2 v[32:33], v2, s[24:27], s48 offen sc1
    s_add_u32 s48, s48, 327680
    s_waitcnt lgkmcnt(0)
    v_mov_b32 v3, 163776
    v_mov_b32 v4, 1
    s_mov_b64 exec, 1
    ds_add_u32 v3, v4
    s_mov_b64 exec, -1
    v_add_f32 v20, v20, v36
    v_add_f32 v21, v21, v37
    v_add_f32 v22, v22, v38
    v_add_f32 v23, v23, v39
    v_cvt_pk_bf16_f32 v20, 0, v20
    v_cvt_pk_bf16_f32 v21, 0, v21
    v_cvt_pk_bf16_f32 v22, 0, v22
    v_cvt_pk_bf16_f32 v23, 0, v23
    v_lshlrev_b32 v38, 16, v50
    v_and_b32 v39, 0xffff0000, v50
    v_add_f32 v20, v20, v38
    v_add_f32 v21, v21, v39
    v_lshlrev_b32 v38, 16, v51
    v_and_b32 v39, 0xffff0000, v51
    v_add_f32 v22, v22, v38
    v_add_f32 v23, v23, v39
    v_cvt_pk_bf16_f32 v36, v20, v21
    v_cvt_pk_bf16_f32 v37, v22, v23
    buffer_store_dwordx2 v[36:37], v2, s[24:27], s48 offen sc1
    s_add_u32 s48, s48, 327680
    v_add_f32 v24, v24, v40
    v_add_f32 v25, v25, v41
    v_add_f32 v26, v26, v42
    v_add_f32 v27, v27, v43
    v_cvt_pk_bf16_f32 v24, 0, v24
    v_cvt_pk_bf16_f32 v25, 0, v25
    v_cvt_pk_bf16_f32 v26, 0, v26
    v_cvt_pk_bf16_f32 v27, 0, v27
    v_lshlrev_b32 v42, 16, v52
    v_and_b32 v43, 0xffff0000, v52
    v_add_f32 v24, v24, v42
    v_add_f32 v25, v25, v43
    v_lshlrev_b32 v42, 16, v53
    v_and_b32 v43, 0xffff0000, v53
    v_add_f32 v26, v26, v42
    v_add_f32 v27, v27, v43
    v_cvt_pk_bf16_f32 v40, v24, v25
    v_cvt_pk_bf16_f32 v41, v26, v27
    buffer_store_dwordx2 v[40:41], v2, s[24:27], s48 offen sc1
    s_add_u32 s48, s48, 327680
    v_add_f32 v28, v28, v44
    v_add_f32 v29, v29, v45
    v_add_f32 v30, v30, v46
    v_add_f32 v31, v31, v47
    v_cvt_pk_bf16_f32 v28, 0, v28
    v_cvt_pk_bf16_f32 v29, 0, v29
    v_cvt_pk_bf16_f32 v30, 0, v30
    v_cvt_pk_bf16_f32 v31, 0, v31
    v_lshlrev_b32 v46, 16, v54
    v_and_b32 v47, 0xffff0000, v54
    v_add_f32 v28, v28, v46
    v_add_f32 v29, v29, v47
    v_lshlrev_b32 v46, 16, v55
    v_and_b32 v47, 0xffff0000, v55
    v_add_f32 v30, v30, v46
    v_add_f32 v31, v31, v47
    v_cvt_pk_bf16_f32 v44, v28, v29
    v_cvt_pk_bf16_f32 v45, v30, v31
    buffer_store_dwordx2 v[44:45], v2, s[24:27], s48 offen sc1
    s_add_u32 s48, s48, 327680
    s_setprio 0
    v_mov_b32 v18, 163720
    s_cmp_lt_u32 s3, 8
    s_cbranch_scc1 CE_D
    s_mov_b32 s41, 0
CE_L:
    ds_read_b32 v19, v18
    s_getreg_b32 s36, hwreg(HW_REG_IB_STS, 0, 4)
    s_cmp_eq_u32 s36, 0
    s_cbranch_scc1 CE_D
    s_add_u32 s41, s41, 1
    s_cmp_ge_u32 s41, 400000
    s_cbranch_scc1 CE_D
    s_waitcnt lgkmcnt(0)
    v_readfirstlane_b32 s42, v19
    s_cmp_eq_u32 s42, 0
    s_cbranch_scc1 CE_L
    s_cmp_ge_u32 s56, 6
    s_cbranch_scc1 CE_D
    s_barrier
    s_add_u32 s56, s56, 1
    s_branch CE_L
CE_D:
    v_mov_b32 v16, s100
    v_mov_b32 v17, s101
    s_waitcnt vmcnt(0) lgkmcnt(0)
    s_mov_b64 exec, 1
    buffer_store_dwordx2 v[16:17], off, s[52:55], s40 sc1
    s_mov_b64 exec, -1
    s_cmp_lt_u32 s3, 8
    s_cbranch_scc1 CE_Q
CE_L2:
    ds_read_b32 v19, v18
    s_getreg_b32 s36, hwreg(HW_REG_IB_STS, 0, 4)
    s_cmp_eq_u32 s36, 0
    s_cbranch_scc1 CE_Q
    s_add_u32 s41, s41, 1
    s_cmp_ge_u32 s41, 400000
    s_cbranch_scc1 CE_Q
    s_waitcnt lgkmcnt(0)
    v_readfirstlane_b32 s42, v19
    s_cmp_eq_u32 s42, 0
    s_cbranch_scc1 CE_L2
    s_cmp_ge_u32 s56, 20
    s_cbranch_scc1 CE_Q
    s_barrier
    s_add_u32 s56, s56, 1
    s_branch CE_L2
    s_branch CE_Q
LC_I:
    s_mov_b32 s56, 0
    v_mov_b32 v3, 163776
    v_mov_b32 v4, 1
    s_mov_b64 exec, 1
    ds_add_u32 v3, v4
    s_mov_b64 exec, -1
CE_Q:
    s_cmp_lt_u32 s3, 8
    s_cbranch_scc1 F3_C
    s_endpgm
    s_cmp_lt_u32 s3, 10
    s_cbranch_scc1 K2_END
    s_branch F3_H
K2_G:
    s_add_u32 s60, s12, 5242880
    s_addc_u32 s61, s13, 0
    s_mov_b32 s62, 7077888
    s_mov_b32 s63, 0x00020000
    s_lshr_b32 s47, s3, 1
    s_and_b32 s48, s3, 1
    v_and_b32 v4, 31, v1
    v_lshrrev_b32 v3, 5, v1
    s_lshl_b32 s49, s47, 6
    v_add_u32 v4, s49, v4
    v_lshrrev_b32 v7, 2, v4
    v_and_b32 v5, 3, v4
    v_lshl_add_u32 v5, v5, 2, v3
    v_and_b32 v6, 3, v7
    v_xor_b32 v5, v5, v6
    v_lshlrev_b32 v5, 4, v5
    v_lshl_add_u32 v12, v7, 8, v5
    v_xor_b32 v13, 32, v12
    v_lshrrev_b32 v8, 4, v1
    v_bfe_u32 v3, v1, 2, 2
    v_and_b32 v4, 3, v1
    v_lshrrev_b32 v5, 1, v8
    v_lshl_add_u32 v5, v5, 3, v3
    v_lshlrev_b32 v5, 7, v5
    v_and_b32 v6, 1, v8
    v_lshlrev_b32 v6, 1, v6
    v_lshrrev_b32 v7, 1, v4
    v_add_u32 v6, v6, v7
    s_lshl_b32 s49, s48, 2
    v_add_u32 v6, s49, v6
    v_bfe_u32 v7, v3, 1, 1
    v_lshlrev_b32 v7, 2, v7
    v_xor_b32 v6, v6, v7
    v_lshl_add_u32 v5, v6, 4, v5
    v_and_b32 v7, 1, v4
    v_lshl_add_u32 v5, v7, 3, v5
    v_add_u32 v14, 16384, v5
    s_cmp_lg_u32 s3, 7
    s_cbranch_scc1 G_NN
    s_mov_b32 s41, 0
NG_G:
    v_mov_b32 v17, 163704
    ds_read_b32 v16, v17
    ds_read_b32 v17, v17 offset:4
    s_waitcnt lgkmcnt(0)
    v_readfirstlane_b32 s100, v16
    v_readfirstlane_b32 s101, v17
    s_cmp_lg_u32 s100, 0
    s_cbranch_scc1 NG_G_D
    s_sleep 1
    s_add_u32 s41, s41, 1
    s_cmp_lt_u32 s41, 1600000
    s_cbranch_scc1 NG_G
NG_G_D:
G_NN:
    v_mov_b32 v64, 0
    v_mov_b32 v65, 0
    v_mov_b32 v66, 0
    v_mov_b32 v67, 0
    v_mov_b32 v68, 0
    v_mov_b32 v69, 0
    v_mov_b32 v70, 0
    v_mov_b32 v71, 0
    v_mov_b32 v72, 0
    v_mov_b32 v73, 0
    v_mov_b32 v74, 0
    v_mov_b32 v75, 0
    v_mov_b32 v76, 0
    v_mov_b32 v77, 0
    v_mov_b32 v78, 0
    v_mov_b32 v79, 0
    v_mov_b32 v80, 0
    v_mov_b32 v81, 0
    v_mov_b32 v82, 0
    v_mov_b32 v83, 0
    v_mov_b32 v84, 0
    v_mov_b32 v85, 0
    v_mov_b32 v86, 0
    v_mov_b32 v87, 0
    v_mov_b32 v88, 0
    v_mov_b32 v89, 0
    v_mov_b32 v90, 0
    v_mov_b32 v91, 0
    v_mov_b32 v92, 0
    v_mov_b32 v93, 0
    v_mov_b32 v94, 0
    v_mov_b32 v95, 0
    v_mov_b32 v96, 0
    v_mov_b32 v97, 0
    v_mov_b32 v98, 0
    v_mov_b32 v99, 0
    v_mov_b32 v100, 0
    v_mov_b32 v101, 0
    v_mov_b32 v102, 0
    v_mov_b32 v103, 0
    v_mov_b32 v104, 0
    v_mov_b32 v105, 0
    v_mov_b32 v106, 0
    v_mov_b32 v107, 0
    v_mov_b32 v108, 0
    v_mov_b32 v109, 0
    v_mov_b32 v110, 0
    v_mov_b32 v111, 0
    v_mov_b32 v112, 0
    v_mov_b32 v113, 0
    v_mov_b32 v114, 0
    v_mov_b32 v115, 0
    v_mov_b32 v116, 0
    v_mov_b32 v117, 0
    v_mov_b32 v118, 0
    v_mov_b32 v119, 0
    v_mov_b32 v120, 0
    v_mov_b32 v121, 0
    v_mov_b32 v122, 0
    v_mov_b32 v123, 0
    v_mov_b32 v124, 0
    v_mov_b32 v125, 0
    v_mov_b32 v126, 0
    v_mov_b32 v127, 0
    v_add_u32 v9, 0x10000, v12
    v_add_u32 v10, 0x10000, v13
    v_add_u32 v11, 0x10000, v14
    v_lshrrev_b32 v3, 5, v1
    v_and_b32 v4, 31, v1
    v_lshlrev_b32 v4, 4, v4
    v_lshl_add_u32 v4, v3, 10, v4
    s_lshl_b32 s46, s77, 2
    s_add_u32 s46, s46, s47
    s_mul_i32 s46, s46, 221184
    s_lshl_b32 s49, s76, 13
    s_add_u32 s46, s46, s49
    s_lshl_b32 s49, s48, 12
    s_add_u32 s46, s46, s49
    s_add_u32 s72, s12, 50331648
    s_addc_u32 s73, s13, 0
    s_mov_b32 s74, 665600
    s_mov_b32 s75, 0x00020000
    v_lshlrev_b32 v5, 8, v1
    v_mov_b32 v6, s100
    v_mov_b32 v7, s101
    v_mov_b32 v8, 163716
    v_mov_b32 v3, 1
    s_cmp_eq_u32 s70, 0
    s_cbranch_scc1 KD_X
    s_mov_b32 s41, 0
KD_L:
    ds_read_b32 v15, v8
    s_getreg_b32 s42, hwreg(HW_REG_IB_STS, 0, 4)
    s_add_u32 s41, s41, 1
    s_waitcnt lgkmcnt(0)
    s_cmp_eq_u32 s42, 0
    s_cbranch_scc1 KD_F
    v_readfirstlane_b32 s42, v15
    s_cmp_lg_u32 s42, 0
    s_cbranch_scc1 KD_X
    s_sleep 1
    s_cmp_lt_u32 s41, 400000
    s_cbranch_scc1 KD_L
KD_F:
    s_waitcnt vmcnt(0)
    s_mov_b64 exec, 15
    buffer_store_dwordx2 v[6:7], v5, s[72:75], s71 offen sc1
    s_mov_b64 exec, 1
    ds_add_u32 v8, v3 offset:116
    s_mov_b64 exec, -1
    s_mov_b32 s70, 0
KD_X:
    s_barrier
    ds_read_b64_tr_b16 v[24:25], v14 offset:0
    ds_read_b64_tr_b16 v[26:27], v14 offset:512
    ds_read_b64_tr_b16 v[28:29], v14 offset:4096
    ds_read_b64_tr_b16 v[30:31], v14 offset:4608
    ds_read_b128 v[16:19], v12 offset:0
    ds_read_b128 v[20:23], v12 offset:2048
    ds_read_b64_tr_b16 v[40:41], v14 offset:2048
    ds_read_b64_tr_b16 v[42:43], v14 offset:2560
    ds_read_b64_tr_b16 v[44:45], v14 offset:6144
    ds_read_b64_tr_b16 v[46:47], v14 offset:6656
    ds_read_b128 v[32:35], v13 offset:0
    ds_read_b128 v[36:39], v13 offset:2048
    s_cmp_eq_u32 s70, 0
    s_cbranch_scc1 KD_S0
    s_getreg_b32 s42, hwreg(HW_REG_IB_STS, 0, 4)
    s_cmp_lg_u32 s42, 0
    s_cbranch_scc1 KD_S0
    s_waitcnt vmcnt(0)
    s_mov_b64 exec, 15
    buffer_store_dwordx2 v[6:7], v5, s[72:75], s71 offen sc1
    s_mov_b64 exec, 1
    ds_add_u32 v8, v3 offset:116
    s_mov_b64 exec, -1
    s_mov_b32 s70, 0
KD_S0:
    s_waitcnt lgkmcnt(0)
    s_barrier
    s_waitcnt lgkmcnt(6)
    v_mfma_f32_32x32x16_bf16 v[64:79], v[24:27], v[16:19], v[64:79]
    ds_read_b64_tr_b16 v[56:57], v14 offset:24576
    ds_read_b64_tr_b16 v[58:59], v14 offset:25088
    v_mfma_f32_32x32x16_bf16 v[96:111], v[28:31], v[16:19], v[96:111]
    ds_read_b64_tr_b16 v[60:61], v14 offset:28672
    ds_read_b64_tr_b16 v[62:63], v14 offset:29184
    v_mfma_f32_32x32x16_bf16 v[80:95], v[24:27], v[20:23], v[80:95]
    ds_read_b128 v[48:51], v12 offset:24576
    v_mfma_f32_32x32x16_bf16 v[112:127], v[28:31], v[20:23], v[112:127]
    ds_read_b128 v[52:55], v12 offset:26624
    s_waitcnt lgkmcnt(6)
    v_mfma_f32_32x32x16_bf16 v[64:79], v[40:43], v[32:35], v[64:79]
    ds_read_b64_tr_b16 v[24:25], v14 offset:26624
    ds_read_b64_tr_b16 v[26:27], v14 offset:27136
    v_mfma_f32_32x32x16_bf16 v[96:111], v[44:47], v[32:35], v[96:111]
    ds_read_b64_tr_b16 v[28:29], v14 offset:30720
    ds_read_b64_tr_b16 v[30:31], v14 offset:31232
    v_mfma_f32_32x32x16_bf16 v[80:95], v[40:43], v[36:39], v[80:95]
    ds_read_b128 v[16:19], v13 offset:24576
    ds_read_b128 v[20:23], v13 offset:26624
    v_mfma_f32_32x32x16_bf16 v[112:127], v[44:47], v[36:39], v[112:127]
    s_cmp_eq_u32 s70, 0
    s_cbranch_scc1 KD_S2
    s_getreg_b32 s42, hwreg(HW_REG_IB_STS, 0, 4)
    s_cmp_lg_u32 s42, 0
    s_cbranch_scc1 KD_S2
    s_waitcnt vmcnt(0)
    s_mov_b64 exec, 15
    buffer_store_dwordx2 v[6:7], v5, s[72:75], s71 offen sc1
    s_mov_b64 exec, 1
    ds_add_u32 v8, v3 offset:116
    s_mov_b64 exec, -1
    s_mov_b32 s70, 0
KD_S2:
    s_waitcnt lgkmcnt(0)
    s_barrier
    s_waitcnt lgkmcnt(6)
    v_mfma_f32_32x32x16_bf16 v[64:79], v[56:59], v[48:51], v[64:79]
    ds_read_b64_tr_b16 v[40:41], v14 offset:49152
    ds_read_b64_tr_b16 v[42:43], v14 offset:49664
    v_mfma_f32_32x32x16_bf16 v[96:111], v[60:63], v[48:51], v[96:111]
    ds_read_b64_tr_b16 v[44:45], v14 offset:53248
    ds_read_b64_tr_b16 v[46:47], v14 offset:53760
    v_mfma_f32_32x32x16_bf16 v[80:95], v[56:59], v[52:55], v[80:95]
    ds_read_b128 v[32:35], v12 offset:49152
    v_mfma_f32_32x32x16_bf16 v[112:127], v[60:63], v[52:55], v[112:127]
    ds_read_b128 v[36:39], v12 offset:51200
    s_waitcnt lgkmcnt(6)
    v_mfma_f32_32x32x16_bf16 v[64:79], v[24:27], v[16:19], v[64:79]
    ds_read_b64_tr_b16 v[56:57], v14 offset:51200
    ds_read_b64_tr_b16 v[58:59], v14 offset:51712
    v_mfma_f32_32x32x16_bf16 v[96:111], v[28:31], v[16:19], v[96:111]
    ds_read_b64_tr_b16 v[60:61], v14 offset:55296
    ds_read_b64_tr_b16 v[62:63], v14 offset:55808
    v_mfma_f32_32x32x16_bf16 v[80:95], v[24:27], v[20:23], v[80:95]
    ds_read_b128 v[48:51], v13 offset:49152
    ds_read_b128 v[52:55], v13 offset:51200
    v_mfma_f32_32x32x16_bf16 v[112:127], v[28:31], v[20:23], v[112:127]
    s_cmp_eq_u32 s70, 0
    s_cbranch_scc1 KD_S4
    s_waitcnt vmcnt(0)
    s_mov_b64 exec, 15
    buffer_store_dwordx2 v[6:7], v5, s[72:75], s71 offen sc1
    s_mov_b64 exec, 1
    ds_add_u32 v8, v3 offset:116
    s_mov_b64 exec, -1
    s_mov_b32 s70, 0
KD_S4:
    s_waitcnt lgkmcnt(0)
    s_barrier
    s_waitcnt lgkmcnt(6)
    v_mfma_f32_32x32x16_bf16 v[64:79], v[40:43], v[32:35], v[64:79]
    ds_read_b64_tr_b16 v[24:25], v11 offset:8192
    ds_read_b64_tr_b16 v[26:27], v11 offset:8704
    v_mfma_f32_32x32x16_bf16 v[96:111], v[44:47], v[32:35], v[96:111]
    ds_read_b64_tr_b16 v[28:29], v11 offset:12288
    ds_read_b64_tr_b16 v[30:31], v11 offset:12800
    v_mfma_f32_32x32x16_bf16 v[80:95], v[40:43], v[36:39], v[80:95]
    ds_read_b128 v[16:19], v9 offset:8192
    v_mfma_f32_32x32x16_bf16 v[112:127], v[44:47], v[36:39], v[112:127]
    ds_read_b128 v[20:23], v9 offset:10240
    s_waitcnt lgkmcnt(6)
    v_mfma_f32_32x32x16_bf16 v[64:79], v[56:59], v[48:51], v[64:79]
    ds_read_b64_tr_b16 v[40:41], v11 offset:10240
    ds_read_b64_tr_b16 v[42:43], v11 offset:10752
    v_mfma_f32_32x32x16_bf16 v[96:111], v[60:63], v[48:51], v[96:111]
    ds_read_b64_tr_b16 v[44:45], v11 offset:14336
    ds_read_b64_tr_b16 v[46:47], v11 offset:14848
    v_mfma_f32_32x32x16_bf16 v[80:95], v[56:59], v[52:55], v[80:95]
    ds_read_b128 v[32:35], v10 offset:8192
    ds_read_b128 v[36:39], v10 offset:10240
    v_mfma_f32_32x32x16_bf16 v[112:127], v[60:63], v[52:55], v[112:127]
    s_waitcnt lgkmcnt(0)
    s_barrier
    s_waitcnt lgkmcnt(6)
    v_mfma_f32_32x32x16_bf16 v[64:79], v[24:27], v[16:19], v[64:79]
    ds_read_b64_tr_b16 v[56:57], v14 offset:0
    ds_read_b64_tr_b16 v[58:59], v14 offset:512
    v_mfma_f32_32x32x16_bf16 v[96:111], v[28:31], v[16:19], v[96:111]
    ds_read_b64_tr_b16 v[60:61], v14 offset:4096
    ds_read_b64_tr_b16 v[62:63], v14 offset:4608
    v_mfma_f32_32x32x16_bf16 v[80:95], v[24:27], v[20:23], v[80:95]
    ds_read_b128 v[48:51], v12 offset:0
    v_mfma_f32_32x32x16_bf16 v[112:127], v[28:31], v[20:23], v[112:127]
    ds_read_b128 v[52:55], v12 offset:2048
    s_waitcnt lgkmcnt(6)
    v_mfma_f32_32x32x16_bf16 v[64:79], v[40:43], v[32:35], v[64:79]
    ds_read_b64_tr_b16 v[24:25], v14 offset:2048
    ds_read_b64_tr_b16 v[26:27], v14 offset:2560
    v_mfma_f32_32x32x16_bf16 v[96:111], v[44:47], v[32:35], v[96:111]
    ds_read_b64_tr_b16 v[28:29], v14 offset:6144
    ds_read_b64_tr_b16 v[30:31], v14 offset:6656
    v_mfma_f32_32x32x16_bf16 v[80:95], v[40:43], v[36:39], v[80:95]
    ds_read_b128 v[16:19], v13 offset:0
    ds_read_b128 v[20:23], v13 offset:2048
    v_mfma_f32_32x32x16_bf16 v[112:127], v[44:47], v[36:39], v[112:127]
    s_waitcnt lgkmcnt(0)
    s_barrier
    s_waitcnt lgkmcnt(6)
    v_mfma_f32_32x32x16_bf16 v[64:79], v[56:59], v[48:51], v[64:79]
    ds_read_b64_tr_b16 v[40:41], v14 offset:24576
    ds_read_b64_tr_b16 v[42:43], v14 offset:25088
    v_mfma_f32_32x32x16_bf16 v[96:111], v[60:63], v[48:51], v[96:111]
    ds_read_b64_tr_b16 v[44:45], v14 offset:28672
    ds_read_b64_tr_b16 v[46:47], v14 offset:29184
    v_mfma_f32_32x32x16_bf16 v[80:95], v[56:59], v[52:55], v[80:95]
    ds_read_b128 v[32:35], v12 offset:24576
    v_mfma_f32_32x32x16_bf16 v[112:127], v[60:63], v[52:55], v[112:127]
    ds_read_b128 v[36:39], v12 offset:26624
    s_waitcnt lgkmcnt(6)
    v_mfma_f32_32x32x16_bf16 v[64:79], v[24:27], v[16:19], v[64:79]
    ds_read_b64_tr_b16 v[56:57], v14 offset:26624
    ds_read_b64_tr_b16 v[58:59], v14 offset:27136
    v_mfma_f32_32x32x16_bf16 v[96:111], v[28:31], v[16:19], v[96:111]
    ds_read_b64_tr_b16 v[60:61], v14 offset:30720
    ds_read_b64_tr_b16 v[62:63], v14 offset:31232
    v_mfma_f32_32x32x16_bf16 v[80:95], v[24:27], v[20:23], v[80:95]
    ds_read_b128 v[48:51], v13 offset:24576
    ds_read_b128 v[52:55], v13 offset:26624
    v_mfma_f32_32x32x16_bf16 v[112:127], v[28:31], v[20:23], v[112:127]
    s_waitcnt lgkmcnt(0)
    s_barrier
    s_waitcnt lgkmcnt(6)
    v_mfma_f32_32x32x16_bf16 v[64:79], v[40:43], v[32:35], v[64:79]
    ds_read_b64_tr_b16 v[24:25], v14 offset:49152
    ds_read_b64_tr_b16 v[26:27], v14 offset:49664
    v_mfma_f32_32x32x16_bf16 v[96:111], v[44:47], v[32:35], v[96:111]
    ds_read_b64_tr_b16 v[28:29], v14 offset:53248
    ds_read_b64_tr_b16 v[30:31], v14 offset:53760
    v_mfma_f32_32x32x16_bf16 v[80:95], v[40:43], v[36:39], v[80:95]
    ds_read_b128 v[16:19], v12 offset:49152
    v_mfma_f32_32x32x16_bf16 v[112:127], v[44:47], v[36:39], v[112:127]
    ds_read_b128 v[20:23], v12 offset:51200
    s_waitcnt lgkmcnt(6)
    v_mfma_f32_32x32x16_bf16 v[64:79], v[56:59], v[48:51], v[64:79]
    ds_read_b64_tr_b16 v[40:41], v14 offset:51200
    ds_read_b64_tr_b16 v[42:43], v14 offset:51712
    v_mfma_f32_32x32x16_bf16 v[96:111], v[60:63], v[48:51], v[96:111]
    ds_read_b64_tr_b16 v[44:45], v14 offset:55296
    ds_read_b64_tr_b16 v[46:47], v14 offset:55808
    v_mfma_f32_32x32x16_bf16 v[80:95], v[56:59], v[52:55], v[80:95]
    ds_read_b128 v[32:35], v13 offset:49152
    ds_read_b128 v[36:39], v13 offset:51200
    v_mfma_f32_32x32x16_bf16 v[112:127], v[60:63], v[52:55], v[112:127]
    s_waitcnt lgkmcnt(0)
    s_barrier
    s_waitcnt lgkmcnt(6)
    v_mfma_f32_32x32x16_bf16 v[64:79], v[24:27], v[16:19], v[64:79]
    ds_read_b64_tr_b16 v[56:57], v11 offset:8192
    ds_read_b64_tr_b16 v[58:59], v11 offset:8704
    v_mfma_f32_32x32x16_bf16 v[96:111], v[28:31], v[16:19], v[96:111]
    ds_read_b64_tr_b16 v[60:61], v11 offset:12288
    ds_read_b64_tr_b16 v[62:63], v11 offset:12800
    v_mfma_f32_32x32x16_bf16 v[80:95], v[24:27], v[20:23], v[80:95]
    ds_read_b128 v[48:51], v9 offset:8192
    v_mfma_f32_32x32x16_bf16 v[112:127], v[28:31], v[20:23], v[112:127]
    ds_read_b128 v[52:55], v9 offset:10240
    s_waitcnt lgkmcnt(6)
    v_mfma_f32_32x32x16_bf16 v[64:79], v[40:43], v[32:35], v[64:79]
    ds_read_b64_tr_b16 v[24:25], v11 offset:10240
    ds_read_b64_tr_b16 v[26:27], v11 offset:10752
    v_mfma_f32_32x32x16_bf16 v[96:111], v[44:47], v[32:35], v[96:111]
    ds_read_b64_tr_b16 v[28:29], v11 offset:14336
    ds_read_b64_tr_b16 v[30:31], v11 offset:14848
    v_mfma_f32_32x32x16_bf16 v[80:95], v[40:43], v[36:39], v[80:95]
    ds_read_b128 v[16:19], v10 offset:8192
    ds_read_b128 v[20:23], v10 offset:10240
    v_mfma_f32_32x32x16_bf16 v[112:127], v[44:47], v[36:39], v[112:127]
    s_waitcnt lgkmcnt(0)
    s_barrier
    s_waitcnt lgkmcnt(6)
    v_mfma_f32_32x32x16_bf16 v[64:79], v[56:59], v[48:51], v[64:79]
    ds_read_b64_tr_b16 v[40:41], v14 offset:0
    ds_read_b64_tr_b16 v[42:43], v14 offset:512
    v_mfma_f32_32x32x16_bf16 v[96:111], v[60:63], v[48:51], v[96:111]
    ds_read_b64_tr_b16 v[44:45], v14 offset:4096
    ds_read_b64_tr_b16 v[46:47], v14 offset:4608
    v_mfma_f32_32x32x16_bf16 v[80:95], v[56:59], v[52:55], v[80:95]
    ds_read_b128 v[32:35], v12 offset:0
    v_mfma_f32_32x32x16_bf16 v[112:127], v[60:63], v[52:55], v[112:127]
    ds_read_b128 v[36:39], v12 offset:2048
    s_waitcnt lgkmcnt(6)
    v_mfma_f32_32x32x16_bf16 v[64:79], v[24:27], v[16:19], v[64:79]
    ds_read_b64_tr_b16 v[56:57], v14 offset:2048
    ds_read_b64_tr_b16 v[58:59], v14 offset:2560
    v_mfma_f32_32x32x16_bf16 v[96:111], v[28:31], v[16:19], v[96:111]
    ds_read_b64_tr_b16 v[60:61], v14 offset:6144
    ds_read_b64_tr_b16 v[62:63], v14 offset:6656
    v_mfma_f32_32x32x16_bf16 v[80:95], v[24:27], v[20:23], v[80:95]
    ds_read_b128 v[48:51], v13 offset:0
    ds_read_b128 v[52:55], v13 offset:2048
    v_mfma_f32_32x32x16_bf16 v[112:127], v[28:31], v[20:23], v[112:127]
    s_waitcnt lgkmcnt(0)
    s_barrier
    s_waitcnt lgkmcnt(6)
    v_mfma_f32_32x32x16_bf16 v[64:79], v[40:43], v[32:35], v[64:79]
    ds_read_b64_tr_b16 v[24:25], v14 offset:24576
    ds_read_b64_tr_b16 v[26:27], v14 offset:25088
    v_mfma_f32_32x32x16_bf16 v[96:111], v[44:47], v[32:35], v[96:111]
    ds_read_b64_tr_b16 v[28:29], v14 offset:28672
    ds_read_b64_tr_b16 v[30:31], v14 offset:29184
    v_mfma_f32_32x32x16_bf16 v[80:95], v[40:43], v[36:39], v[80:95]
    ds_read_b128 v[16:19], v12 offset:24576
    v_mfma_f32_32x32x16_bf16 v[112:127], v[44:47], v[36:39], v[112:127]
    ds_read_b128 v[20:23], v12 offset:26624
    s_waitcnt lgkmcnt(6)
    v_mfma_f32_32x32x16_bf16 v[64:79], v[56:59], v[48:51], v[64:79]
    ds_read_b64_tr_b16 v[40:41], v14 offset:26624
    ds_read_b64_tr_b16 v[42:43], v14 offset:27136
    v_mfma_f32_32x32x16_bf16 v[96:111], v[60:63], v[48:51], v[96:111]
    ds_read_b64_tr_b16 v[44:45], v14 offset:30720
    ds_read_b64_tr_b16 v[46:47], v14 offset:31232
    v_mfma_f32_32x32x16_bf16 v[80:95], v[56:59], v[52:55], v[80:95]
    ds_read_b128 v[32:35], v13 offset:24576
    ds_read_b128 v[36:39], v13 offset:26624
    v_mfma_f32_32x32x16_bf16 v[112:127], v[60:63], v[52:55], v[112:127]
    s_waitcnt lgkmcnt(0)
    s_barrier
    s_waitcnt lgkmcnt(6)
    v_mfma_f32_32x32x16_bf16 v[64:79], v[24:27], v[16:19], v[64:79]
    ds_read_b64_tr_b16 v[56:57], v14 offset:49152
    ds_read_b64_tr_b16 v[58:59], v14 offset:49664
    v_mfma_f32_32x32x16_bf16 v[96:111], v[28:31], v[16:19], v[96:111]
    ds_read_b64_tr_b16 v[60:61], v14 offset:53248
    ds_read_b64_tr_b16 v[62:63], v14 offset:53760
    v_mfma_f32_32x32x16_bf16 v[80:95], v[24:27], v[20:23], v[80:95]
    ds_read_b128 v[48:51], v12 offset:49152
    v_mfma_f32_32x32x16_bf16 v[112:127], v[28:31], v[20:23], v[112:127]
    ds_read_b128 v[52:55], v12 offset:51200
    s_waitcnt lgkmcnt(6)
    v_mfma_f32_32x32x16_bf16 v[64:79], v[40:43], v[32:35], v[64:79]
    ds_read_b64_tr_b16 v[24:25], v14 offset:51200
    ds_read_b64_tr_b16 v[26:27], v14 offset:51712
    v_mfma_f32_32x32x16_bf16 v[96:111], v[44:47], v[32:35], v[96:111]
    ds_read_b64_tr_b16 v[28:29], v14 offset:55296
    ds_read_b64_tr_b16 v[30:31], v14 offset:55808
    v_mfma_f32_32x32x16_bf16 v[80:95], v[40:43], v[36:39], v[80:95]
    ds_read_b128 v[16:19], v13 offset:49152
    ds_read_b128 v[20:23], v13 offset:51200
    v_mfma_f32_32x32x16_bf16 v[112:127], v[44:47], v[36:39], v[112:127]
    s_waitcnt lgkmcnt(0)
    s_barrier
    s_waitcnt lgkmcnt(6)
    v_mfma_f32_32x32x16_bf16 v[64:79], v[56:59], v[48:51], v[64:79]
    ds_read_b64_tr_b16 v[40:41], v11 offset:8192
    ds_read_b64_tr_b16 v[42:43], v11 offset:8704
    v_mfma_f32_32x32x16_bf16 v[96:111], v[60:63], v[48:51], v[96:111]
    ds_read_b64_tr_b16 v[44:45], v11 offset:12288
    ds_read_b64_tr_b16 v[46:47], v11 offset:12800
    v_mfma_f32_32x32x16_bf16 v[80:95], v[56:59], v[52:55], v[80:95]
    ds_read_b128 v[32:35], v9 offset:8192
    v_mfma_f32_32x32x16_bf16 v[112:127], v[60:63], v[52:55], v[112:127]
    ds_read_b128 v[36:39], v9 offset:10240
    s_waitcnt lgkmcnt(6)
    v_mfma_f32_32x32x16_bf16 v[64:79], v[24:27], v[16:19], v[64:79]
    ds_read_b64_tr_b16 v[56:57], v11 offset:10240
    ds_read_b64_tr_b16 v[58:59], v11 offset:10752
    v_mfma_f32_32x32x16_bf16 v[96:111], v[28:31], v[16:19], v[96:111]
    ds_read_b64_tr_b16 v[60:61], v11 offset:14336
    ds_read_b64_tr_b16 v[62:63], v11 offset:14848
    v_mfma_f32_32x32x16_bf16 v[80:95], v[24:27], v[20:23], v[80:95]
    ds_read_b128 v[48:51], v10 offset:8192
    ds_read_b128 v[52:55], v10 offset:10240
    v_mfma_f32_32x32x16_bf16 v[112:127], v[28:31], v[20:23], v[112:127]
    s_waitcnt lgkmcnt(0)
    s_barrier
    s_waitcnt lgkmcnt(6)
    v_mfma_f32_32x32x16_bf16 v[64:79], v[40:43], v[32:35], v[64:79]
    ds_read_b64_tr_b16 v[24:25], v14 offset:0
    ds_read_b64_tr_b16 v[26:27], v14 offset:512
    v_mfma_f32_32x32x16_bf16 v[96:111], v[44:47], v[32:35], v[96:111]
    ds_read_b64_tr_b16 v[28:29], v14 offset:4096
    ds_read_b64_tr_b16 v[30:31], v14 offset:4608
    v_mfma_f32_32x32x16_bf16 v[80:95], v[40:43], v[36:39], v[80:95]
    ds_read_b128 v[16:19], v12 offset:0
    v_mfma_f32_32x32x16_bf16 v[112:127], v[44:47], v[36:39], v[112:127]
    ds_read_b128 v[20:23], v12 offset:2048
    s_waitcnt lgkmcnt(6)
    v_mfma_f32_32x32x16_bf16 v[64:79], v[56:59], v[48:51], v[64:79]
    ds_read_b64_tr_b16 v[40:41], v14 offset:2048
    ds_read_b64_tr_b16 v[42:43], v14 offset:2560
    v_mfma_f32_32x32x16_bf16 v[96:111], v[60:63], v[48:51], v[96:111]
    ds_read_b64_tr_b16 v[44:45], v14 offset:6144
    ds_read_b64_tr_b16 v[46:47], v14 offset:6656
    v_mfma_f32_32x32x16_bf16 v[80:95], v[56:59], v[52:55], v[80:95]
    ds_read_b128 v[32:35], v13 offset:0
    ds_read_b128 v[36:39], v13 offset:2048
    v_mfma_f32_32x32x16_bf16 v[112:127], v[60:63], v[52:55], v[112:127]
    s_waitcnt lgkmcnt(0)
    s_barrier
    s_waitcnt lgkmcnt(6)
    v_mfma_f32_32x32x16_bf16 v[64:79], v[24:27], v[16:19], v[64:79]
    ds_read_b64_tr_b16 v[56:57], v14 offset:24576
    ds_read_b64_tr_b16 v[58:59], v14 offset:25088
    v_mfma_f32_32x32x16_bf16 v[96:111], v[28:31], v[16:19], v[96:111]
    ds_read_b64_tr_b16 v[60:61], v14 offset:28672
    ds_read_b64_tr_b16 v[62:63], v14 offset:29184
    v_mfma_f32_32x32x16_bf16 v[80:95], v[24:27], v[20:23], v[80:95]
    ds_read_b128 v[48:51], v12 offset:24576
    v_mfma_f32_32x32x16_bf16 v[112:127], v[28:31], v[20:23], v[112:127]
    ds_read_b128 v[52:55], v12 offset:26624
    s_waitcnt lgkmcnt(6)
    v_mfma_f32_32x32x16_bf16 v[64:79], v[40:43], v[32:35], v[64:79]
    ds_read_b64_tr_b16 v[24:25], v14 offset:26624
    ds_read_b64_tr_b16 v[26:27], v14 offset:27136
    v_mfma_f32_32x32x16_bf16 v[96:111], v[44:47], v[32:35], v[96:111]
    ds_read_b64_tr_b16 v[28:29], v14 offset:30720
    ds_read_b64_tr_b16 v[30:31], v14 offset:31232
    v_mfma_f32_32x32x16_bf16 v[80:95], v[40:43], v[36:39], v[80:95]
    ds_read_b128 v[16:19], v13 offset:24576
    ds_read_b128 v[20:23], v13 offset:26624
    v_mfma_f32_32x32x16_bf16 v[112:127], v[44:47], v[36:39], v[112:127]
    s_waitcnt lgkmcnt(0)
    s_barrier
    s_waitcnt lgkmcnt(6)
    v_mfma_f32_32x32x16_bf16 v[64:79], v[56:59], v[48:51], v[64:79]
    ds_read_b64_tr_b16 v[40:41], v14 offset:49152
    ds_read_b64_tr_b16 v[42:43], v14 offset:49664
    v_mfma_f32_32x32x16_bf16 v[96:111], v[60:63], v[48:51], v[96:111]
    ds_read_b64_tr_b16 v[44:45], v14 offset:53248
    ds_read_b64_tr_b16 v[46:47], v14 offset:53760
    v_mfma_f32_32x32x16_bf16 v[80:95], v[56:59], v[52:55], v[80:95]
    ds_read_b128 v[32:35], v12 offset:49152
    v_mfma_f32_32x32x16_bf16 v[112:127], v[60:63], v[52:55], v[112:127]
    ds_read_b128 v[36:39], v12 offset:51200
    s_waitcnt lgkmcnt(6)
    v_mfma_f32_32x32x16_bf16 v[64:79], v[24:27], v[16:19], v[64:79]
    ds_read_b64_tr_b16 v[56:57], v14 offset:51200
    ds_read_b64_tr_b16 v[58:59], v14 offset:51712
    v_mfma_f32_32x32x16_bf16 v[96:111], v[28:31], v[16:19], v[96:111]
    ds_read_b64_tr_b16 v[60:61], v14 offset:55296
    ds_read_b64_tr_b16 v[62:63], v14 offset:55808
    v_mfma_f32_32x32x16_bf16 v[80:95], v[24:27], v[20:23], v[80:95]
    ds_read_b128 v[48:51], v13 offset:49152
    ds_read_b128 v[52:55], v13 offset:51200
    v_mfma_f32_32x32x16_bf16 v[112:127], v[28:31], v[20:23], v[112:127]
    s_waitcnt lgkmcnt(0)
    s_barrier
    s_waitcnt lgkmcnt(6)
    v_mfma_f32_32x32x16_bf16 v[64:79], v[40:43], v[32:35], v[64:79]
    ds_read_b64_tr_b16 v[24:25], v11 offset:8192
    ds_read_b64_tr_b16 v[26:27], v11 offset:8704
    v_mfma_f32_32x32x16_bf16 v[96:111], v[44:47], v[32:35], v[96:111]
    ds_read_b64_tr_b16 v[28:29], v11 offset:12288
    ds_read_b64_tr_b16 v[30:31], v11 offset:12800
    v_mfma_f32_32x32x16_bf16 v[80:95], v[40:43], v[36:39], v[80:95]
    ds_read_b128 v[16:19], v9 offset:8192
    v_mfma_f32_32x32x16_bf16 v[112:127], v[44:47], v[36:39], v[112:127]
    ds_read_b128 v[20:23], v9 offset:10240
    s_waitcnt lgkmcnt(6)
    v_mfma_f32_32x32x16_bf16 v[64:79], v[56:59], v[48:51], v[64:79]
    ds_read_b64_tr_b16 v[40:41], v11 offset:10240
    ds_read_b64_tr_b16 v[42:43], v11 offset:10752
    v_mfma_f32_32x32x16_bf16 v[96:111], v[60:63], v[48:51], v[96:111]
    ds_read_b64_tr_b16 v[44:45], v11 offset:14336
    ds_read_b64_tr_b16 v[46:47], v11 offset:14848
    v_mfma_f32_32x32x16_bf16 v[80:95], v[56:59], v[52:55], v[80:95]
    ds_read_b128 v[32:35], v10 offset:8192
    ds_read_b128 v[36:39], v10 offset:10240
    v_mfma_f32_32x32x16_bf16 v[112:127], v[60:63], v[52:55], v[112:127]
    s_waitcnt lgkmcnt(0)
    s_barrier
    s_waitcnt lgkmcnt(6)
    v_mfma_f32_32x32x16_bf16 v[64:79], v[24:27], v[16:19], v[64:79]
    ds_read_b64_tr_b16 v[56:57], v14 offset:0
    ds_read_b64_tr_b16 v[58:59], v14 offset:512
    v_mfma_f32_32x32x16_bf16 v[96:111], v[28:31], v[16:19], v[96:111]
    ds_read_b64_tr_b16 v[60:61], v14 offset:4096
    ds_read_b64_tr_b16 v[62:63], v14 offset:4608
    v_mfma_f32_32x32x16_bf16 v[80:95], v[24:27], v[20:23], v[80:95]
    ds_read_b128 v[48:51], v12 offset:0
    v_mfma_f32_32x32x16_bf16 v[112:127], v[28:31], v[20:23], v[112:127]
    ds_read_b128 v[52:55], v12 offset:2048
    s_waitcnt lgkmcnt(6)
    v_mfma_f32_32x32x16_bf16 v[64:79], v[40:43], v[32:35], v[64:79]
    ds_read_b64_tr_b16 v[24:25], v14 offset:2048
    ds_read_b64_tr_b16 v[26:27], v14 offset:2560
    v_mfma_f32_32x32x16_bf16 v[96:111], v[44:47], v[32:35], v[96:111]
    ds_read_b64_tr_b16 v[28:29], v14 offset:6144
    ds_read_b64_tr_b16 v[30:31], v14 offset:6656
    v_mfma_f32_32x32x16_bf16 v[80:95], v[40:43], v[36:39], v[80:95]
    ds_read_b128 v[16:19], v13 offset:0
    ds_read_b128 v[20:23], v13 offset:2048
    v_mfma_f32_32x32x16_bf16 v[112:127], v[44:47], v[36:39], v[112:127]
    s_waitcnt lgkmcnt(0)
    s_barrier
    s_waitcnt lgkmcnt(6)
    v_mfma_f32_32x32x16_bf16 v[64:79], v[56:59], v[48:51], v[64:79]
    ds_read_b64_tr_b16 v[40:41], v14 offset:24576
    ds_read_b64_tr_b16 v[42:43], v14 offset:25088
    v_mfma_f32_32x32x16_bf16 v[96:111], v[60:63], v[48:51], v[96:111]
    ds_read_b64_tr_b16 v[44:45], v14 offset:28672
    ds_read_b64_tr_b16 v[46:47], v14 offset:29184
    v_mfma_f32_32x32x16_bf16 v[80:95], v[56:59], v[52:55], v[80:95]
    ds_read_b128 v[32:35], v12 offset:24576
    v_mfma_f32_32x32x16_bf16 v[112:127], v[60:63], v[52:55], v[112:127]
    ds_read_b128 v[36:39], v12 offset:26624
    s_waitcnt lgkmcnt(6)
    v_mfma_f32_32x32x16_bf16 v[64:79], v[24:27], v[16:19], v[64:79]
    ds_read_b64_tr_b16 v[56:57], v14 offset:26624
    ds_read_b64_tr_b16 v[58:59], v14 offset:27136
    v_mfma_f32_32x32x16_bf16 v[96:111], v[28:31], v[16:19], v[96:111]
    ds_read_b64_tr_b16 v[60:61], v14 offset:30720
    ds_read_b64_tr_b16 v[62:63], v14 offset:31232
    v_mfma_f32_32x32x16_bf16 v[80:95], v[24:27], v[20:23], v[80:95]
    ds_read_b128 v[48:51], v13 offset:24576
    ds_read_b128 v[52:55], v13 offset:26624
    v_mfma_f32_32x32x16_bf16 v[112:127], v[28:31], v[20:23], v[112:127]
    s_waitcnt lgkmcnt(0)
    s_barrier
    s_waitcnt lgkmcnt(6)
    v_mfma_f32_32x32x16_bf16 v[64:79], v[40:43], v[32:35], v[64:79]
    ds_read_b64_tr_b16 v[24:25], v14 offset:49152
    ds_read_b64_tr_b16 v[26:27], v14 offset:49664
    v_mfma_f32_32x32x16_bf16 v[96:111], v[44:47], v[32:35], v[96:111]
    ds_read_b64_tr_b16 v[28:29], v14 offset:53248
    ds_read_b64_tr_b16 v[30:31], v14 offset:53760
    v_mfma_f32_32x32x16_bf16 v[80:95], v[40:43], v[36:39], v[80:95]
    ds_read_b128 v[16:19], v12 offset:49152
    v_mfma_f32_32x32x16_bf16 v[112:127], v[44:47], v[36:39], v[112:127]
    ds_read_b128 v[20:23], v12 offset:51200
    s_waitcnt lgkmcnt(6)
    v_mfma_f32_32x32x16_bf16 v[64:79], v[56:59], v[48:51], v[64:79]
    ds_read_b64_tr_b16 v[40:41], v14 offset:51200
    ds_read_b64_tr_b16 v[42:43], v14 offset:51712
    v_mfma_f32_32x32x16_bf16 v[96:111], v[60:63], v[48:51], v[96:111]
    ds_read_b64_tr_b16 v[44:45], v14 offset:55296
    ds_read_b64_tr_b16 v[46:47], v14 offset:55808
    v_mfma_f32_32x32x16_bf16 v[80:95], v[56:59], v[52:55], v[80:95]
    ds_read_b128 v[32:35], v13 offset:49152
    ds_read_b128 v[36:39], v13 offset:51200
    v_mfma_f32_32x32x16_bf16 v[112:127], v[60:63], v[52:55], v[112:127]
    s_waitcnt lgkmcnt(0)
    s_barrier
    s_waitcnt lgkmcnt(6)
    v_mfma_f32_32x32x16_bf16 v[64:79], v[24:27], v[16:19], v[64:79]
    ds_read_b64_tr_b16 v[56:57], v11 offset:8192
    ds_read_b64_tr_b16 v[58:59], v11 offset:8704
    v_mfma_f32_32x32x16_bf16 v[96:111], v[28:31], v[16:19], v[96:111]
    ds_read_b64_tr_b16 v[60:61], v11 offset:12288
    ds_read_b64_tr_b16 v[62:63], v11 offset:12800
    v_mfma_f32_32x32x16_bf16 v[80:95], v[24:27], v[20:23], v[80:95]
    ds_read_b128 v[48:51], v9 offset:8192
    v_mfma_f32_32x32x16_bf16 v[112:127], v[28:31], v[20:23], v[112:127]
    ds_read_b128 v[52:55], v9 offset:10240
    s_waitcnt lgkmcnt(6)
    v_mfma_f32_32x32x16_bf16 v[64:79], v[40:43], v[32:35], v[64:79]
    ds_read_b64_tr_b16 v[24:25], v11 offset:10240
    ds_read_b64_tr_b16 v[26:27], v11 offset:10752
    v_mfma_f32_32x32x16_bf16 v[96:111], v[44:47], v[32:35], v[96:111]
    ds_read_b64_tr_b16 v[28:29], v11 offset:14336
    ds_read_b64_tr_b16 v[30:31], v11 offset:14848
    v_mfma_f32_32x32x16_bf16 v[80:95], v[40:43], v[36:39], v[80:95]
    ds_read_b128 v[16:19], v10 offset:8192
    ds_read_b128 v[20:23], v10 offset:10240
    v_mfma_f32_32x32x16_bf16 v[112:127], v[44:47], v[36:39], v[112:127]
    s_waitcnt lgkmcnt(6)
    v_mfma_f32_32x32x16_bf16 v[64:79], v[56:59], v[48:51], v[64:79]
    v_mfma_f32_32x32x16_bf16 v[96:111], v[60:63], v[48:51], v[96:111]
    v_mfma_f32_32x32x16_bf16 v[80:95], v[56:59], v[52:55], v[80:95]
    v_mfma_f32_32x32x16_bf16 v[112:127], v[60:63], v[52:55], v[112:127]
    s_waitcnt lgkmcnt(0)
    v_mfma_f32_32x32x16_bf16 v[64:79], v[24:27], v[16:19], v[64:79]
    v_mfma_f32_32x32x16_bf16 v[96:111], v[28:31], v[16:19], v[96:111]
    v_mfma_f32_32x32x16_bf16 v[80:95], v[24:27], v[20:23], v[80:95]
    v_mfma_f32_32x32x16_bf16 v[112:127], v[28:31], v[20:23], v[112:127]
    s_barrier
    s_nop 15
G_EPI:
    v_cvt_pk_bf16_f32 v64, 0, v64
    v_cvt_pk_bf16_f32 v96, 0, v96
    v_cvt_pk_bf16_f32 v65, 0, v65
    v_cvt_pk_bf16_f32 v97, 0, v97
    v_cvt_pk_bf16_f32 v66, 0, v66
    v_cvt_pk_bf16_f32 v98, 0, v98
    v_cvt_pk_bf16_f32 v67, 0, v67
    v_cvt_pk_bf16_f32 v99, 0, v99
    v_pk_mul_f32 v[64:65], v[64:65], v[96:97]
    v_pk_mul_f32 v[66:67], v[66:67], v[98:99]
    v_cvt_pk_bf16_f32 v16, v64, v65
    v_cvt_pk_bf16_f32 v17, v66, v67
    v_cvt_pk_bf16_f32 v68, 0, v68
    v_cvt_pk_bf16_f32 v100, 0, v100
    v_cvt_pk_bf16_f32 v69, 0, v69
    v_cvt_pk_bf16_f32 v101, 0, v101
    v_cvt_pk_bf16_f32 v70, 0, v70
    v_cvt_pk_bf16_f32 v102, 0, v102
    v_cvt_pk_bf16_f32 v71, 0, v71
    v_cvt_pk_bf16_f32 v103, 0, v103
    v_pk_mul_f32 v[68:69], v[68:69], v[100:101]
    v_pk_mul_f32 v[70:71], v[70:71], v[102:103]
    v_cvt_pk_bf16_f32 v18, v68, v69
    v_cvt_pk_bf16_f32 v19, v70, v71
    s_nop 1
    v_permlane32_swap_b32 v16, v18
    v_permlane32_swap_b32 v17, v19
    s_nop 1
    buffer_store_dwordx4 v[16:19], v4, s[60:63], s46 offen offset:0 sc1
    v_cvt_pk_bf16_f32 v72, 0, v72
    v_cvt_pk_bf16_f32 v104, 0, v104
    v_cvt_pk_bf16_f32 v73, 0, v73
    v_cvt_pk_bf16_f32 v105, 0, v105
    v_cvt_pk_bf16_f32 v74, 0, v74
    v_cvt_pk_bf16_f32 v106, 0, v106
    v_cvt_pk_bf16_f32 v75, 0, v75
    v_cvt_pk_bf16_f32 v107, 0, v107
    v_pk_mul_f32 v[72:73], v[72:73], v[104:105]
    v_pk_mul_f32 v[74:75], v[74:75], v[106:107]
    v_cvt_pk_bf16_f32 v20, v72, v73
    v_cvt_pk_bf16_f32 v21, v74, v75
    v_cvt_pk_bf16_f32 v76, 0, v76
    v_cvt_pk_bf16_f32 v108, 0, v108
    v_cvt_pk_bf16_f32 v77, 0, v77
    v_cvt_pk_bf16_f32 v109, 0, v109
    v_cvt_pk_bf16_f32 v78, 0, v78
    v_cvt_pk_bf16_f32 v110, 0, v110
    v_cvt_pk_bf16_f32 v79, 0, v79
    v_cvt_pk_bf16_f32 v111, 0, v111
    v_pk_mul_f32 v[76:77], v[76:77], v[108:109]
    v_pk_mul_f32 v[78:79], v[78:79], v[110:111]
    v_cvt_pk_bf16_f32 v22, v76, v77
    v_cvt_pk_bf16_f32 v23, v78, v79
    s_nop 1
    v_permlane32_swap_b32 v20, v22
    v_permlane32_swap_b32 v21, v23
    s_nop 1
    buffer_store_dwordx4 v[20:23], v4, s[60:63], s46 offen offset:2048 sc1
    v_cvt_pk_bf16_f32 v80, 0, v80
    v_cvt_pk_bf16_f32 v112, 0, v112
    v_cvt_pk_bf16_f32 v81, 0, v81
    v_cvt_pk_bf16_f32 v113, 0, v113
    v_cvt_pk_bf16_f32 v82, 0, v82
    v_cvt_pk_bf16_f32 v114, 0, v114
    v_cvt_pk_bf16_f32 v83, 0, v83
    v_cvt_pk_bf16_f32 v115, 0, v115
    v_pk_mul_f32 v[80:81], v[80:81], v[112:113]
    v_pk_mul_f32 v[82:83], v[82:83], v[114:115]
    v_cvt_pk_bf16_f32 v24, v80, v81
    v_cvt_pk_bf16_f32 v25, v82, v83
    v_cvt_pk_bf16_f32 v84, 0, v84
    v_cvt_pk_bf16_f32 v116, 0, v116
    v_cvt_pk_bf16_f32 v85, 0, v85
    v_cvt_pk_bf16_f32 v117, 0, v117
    v_cvt_pk_bf16_f32 v86, 0, v86
    v_cvt_pk_bf16_f32 v118, 0, v118
    v_cvt_pk_bf16_f32 v87, 0, v87
    v_cvt_pk_bf16_f32 v119, 0, v119
    v_pk_mul_f32 v[84:85], v[84:85], v[116:117]
    v_pk_mul_f32 v[86:87], v[86:87], v[118:119]
    v_cvt_pk_bf16_f32 v26, v84, v85
    v_cvt_pk_bf16_f32 v27, v86, v87
    s_nop 1
    v_permlane32_swap_b32 v24, v26
    v_permlane32_swap_b32 v25, v27
    s_nop 1
    buffer_store_dwordx4 v[24:27], v4, s[60:63], s46 offen offset:512 sc1
    v_cvt_pk_bf16_f32 v88, 0, v88
    v_cvt_pk_bf16_f32 v120, 0, v120
    v_cvt_pk_bf16_f32 v89, 0, v89
    v_cvt_pk_bf16_f32 v121, 0, v121
    v_cvt_pk_bf16_f32 v90, 0, v90
    v_cvt_pk_bf16_f32 v122, 0, v122
    v_cvt_pk_bf16_f32 v91, 0, v91
    v_cvt_pk_bf16_f32 v123, 0, v123
    v_pk_mul_f32 v[88:89], v[88:89], v[120:121]
    v_pk_mul_f32 v[90:91], v[90:91], v[122:123]
    v_cvt_pk_bf16_f32 v28, v88, v89
    v_cvt_pk_bf16_f32 v29, v90, v91
    v_cvt_pk_bf16_f32 v92, 0, v92
    v_cvt_pk_bf16_f32 v124, 0, v124
    v_cvt_pk_bf16_f32 v93, 0, v93
    v_cvt_pk_bf16_f32 v125, 0, v125
    v_cvt_pk_bf16_f32 v94, 0, v94
    v_cvt_pk_bf16_f32 v126, 0, v126
    v_cvt_pk_bf16_f32 v95, 0, v95
    v_cvt_pk_bf16_f32 v127, 0, v127
    v_pk_mul_f32 v[92:93], v[92:93], v[124:125]
    v_pk_mul_f32 v[94:95], v[94:95], v[126:127]
    v_cvt_pk_bf16_f32 v30, v92, v93
    v_cvt_pk_bf16_f32 v31, v94, v95
    s_nop 1
    v_permlane32_swap_b32 v28, v30
    v_permlane32_swap_b32 v29, v31
    s_nop 1
    buffer_store_dwordx4 v[28:31], v4, s[60:63], s46 offen offset:2560 sc1
    s_barrier
    s_add_u32 s56, s12, 50331648
    s_addc_u32 s57, s13, 0
    s_mov_b32 s58, 665600
    s_mov_b32 s59, 0x00020000
    v_lshrrev_b32 v42, 1, v1
    v_lshlrev_b32 v42, 9, v42
    v_and_b32 v43, 1, v1
    v_mul_u32_u24 v43, 216, v43
    v_add_u32 v42, v42, v43
    s_lshl_b32 s40, s77, 3
    s_add_u32 s40, s40, s3
    s_lshl_b32 s40, s40, 7
    s_add_u32 s40, s40, s76
    s_lshl_b32 s40, s40, 3
    s_add_u32 s40, s40, 229376
    v_mov_b32 v40, s100
    v_mov_b32 v41, s101
    s_mov_b32 s43, 22
    s_mov_b64 exec, 5
    s_waitcnt vmcnt(0)
    buffer_store_dwordx2 v[40:41], v42, s[56:59], s40 offen sc1
    s_mov_b64 exec, -1
    s_branch F3_BEG
K1_START:
    s_mov_b32 s90, 256
    s_mov_b32 s91, 0x00020000
    s_cmp_lt_u32 s3, 5
    s_cbranch_scc1 K1_KV
    s_setprio 3
    s_lshr_b32 s14, s2, 1
    s_and_b32 s15, s2, 1
    s_lshl_b32 s15, s15, 8
    v_add_u32 v80, s15, v80
    s_sub_u32 s57, s3, 5
    s_lshr_b32 s57, s57, 1
    s_lshl_b32 s40, s2, 1
    s_add_u32 s40, s40, s57
    s_and_b32 s41, s40, 7
    s_lshl_b32 s41, s41, 3
    s_lshr_b32 s40, s40, 3
    s_lshl_b32 s40, s40, 10
    s_add_u32 s40, s40, s41
    s_lshl_b32 s56, s57, 3
    s_lshl_b32 s56, 1, s56
    s_waitcnt lgkmcnt(0)
    s_add_u32 s20, s12, 0
    s_addc_u32 s21, s13, 0
    s_mov_b32 s22, 16384
    s_mov_b32 s23, 0x00020000
    s_add_u32 s28, s12, 15728640
    s_addc_u32 s29, s13, 0
    s_mov_b32 s30, 2621440
    s_mov_b32 s31, 0x00020000
    s_lshl_b32 s3, s14, 4
    v_lshrrev_b32 v1, 5, v80
    v_add_u32 v72, s3, v1
    v_lshlrev_b32 v72, 3, v72
    v_and_b32 v2, 31, v80
    v_lshrrev_b32 v3, 2, v1
    v_and_b32 v73, 3, v1
    v_lshlrev_b32 v73, 2, v73
    v_and_b32 v74, 3, v2
    v_add_u32 v74, v73, v74
    v_xor_b32 v74, v74, v3
    v_lshlrev_b32 v74, 4, v74
    v_lshl_add_u32 v74, v3, 8, v74
    v_lshrrev_b32 v75, 2, v2
    v_lshl_add_u32 v74, v75, 14, v74
    v_bfe_u32 v75, v2, 1, 2
    v_add_u32 v75, v73, v75
    v_xor_b32 v75, v75, v3
    v_lshlrev_b32 v75, 4, v75
    v_lshl_add_u32 v75, v3, 8, v75
    v_lshrrev_b32 v81, 3, v2
    v_lshl_add_u32 v75, v81, 14, v75
    v_and_b32 v81, 1, v2
    v_lshl_add_u32 v75, v81, 3, v75
    s_lshr_b32 s25, s14, 4
    s_mul_i32 s25, s25, 327680
    s_and_b32 s26, s14, 15
    s_lshl_b32 s26, s26, 10
    s_add_u32 s25, s25, s26
    s_add_u32 s26, s25, 131072
    s_add_u32 s27, s25, 262144
    s_mov_b32 s24, 0x3acccccd
    v_mov_b32 v85, 163824
    v_mov_b32 v86, s56
    v_cmp_eq_u32 vcc, 0, v2
    s_waitcnt vmcnt(2)
    v_lshlrev_b32 v32, 16, v4
    v_and_b32 v33, 0xffff0000, v4
    v_lshlrev_b32 v34, 16, v5
    v_and_b32 v35, 0xffff0000, v5
    v_lshlrev_b32 v36, 16, v6
    v_and_b32 v37, 0xffff0000, v6
    v_lshlrev_b32 v38, 16, v7
    v_and_b32 v39, 0xffff0000, v7
    v_pk_add_f32 v[24:25], v[32:33], v[34:35]
    v_pk_add_f32 v[26:27], v[36:37], v[38:39]
    s_waitcnt vmcnt(1)
    v_lshlrev_b32 v40, 16, v8
    v_and_b32 v41, 0xffff0000, v8
    v_lshlrev_b32 v42, 16, v9
    v_and_b32 v43, 0xffff0000, v9
    v_lshlrev_b32 v44, 16, v10
    v_and_b32 v45, 0xffff0000, v10
    v_lshlrev_b32 v46, 16, v11
    v_and_b32 v47, 0xffff0000, v11
    v_pk_add_f32 v[24:25], v[24:25], v[40:41]
    v_pk_add_f32 v[26:27], v[26:27], v[42:43]
    v_pk_add_f32 v[24:25], v[24:25], v[44:45]
    v_pk_add_f32 v[26:27], v[26:27], v[46:47]
    s_waitcnt vmcnt(0)
    v_lshlrev_b32 v48, 16, v12
    v_and_b32 v49, 0xffff0000, v12
    v_lshlrev_b32 v50, 16, v13
    v_and_b32 v51, 0xffff0000, v13
    v_pk_add_f32 v[24:25], v[24:25], v[48:49]
    v_pk_add_f32 v[26:27], v[26:27], v[50:51]
    v_pk_add_f32 v[24:25], v[24:25], v[26:27]
    v_add_f32 v24, v24, v25
    s_nop 1
    v_add_f32_dpp v24, v24, v24 row_ror:8 row_mask:0xf bank_mask:0xf
    s_nop 1
    v_add_f32_dpp v24, v24, v24 row_ror:4 row_mask:0xf bank_mask:0xf
    s_nop 1
    v_add_f32_dpp v24, v24, v24 row_ror:2 row_mask:0xf bank_mask:0xf
    s_nop 1
    v_add_f32_dpp v24, v24, v24 row_ror:1 row_mask:0xf bank_mask:0xf
    v_mov_b32 v25, v24
    s_nop 1
    v_permlane16_swap_b32 v24, v25
    s_nop 1
    v_add_f32 v24, v24, v25
    v_mul_f32 v24, s24, v24
    v_mov_b32 v25, v24
    v_pk_add_f32 v[52:53], v[32:33], v[24:25] neg_lo:[0,1] neg_hi:[0,1]
    v_pk_add_f32 v[54:55], v[34:35], v[24:25] neg_lo:[0,1] neg_hi:[0,1]
    v_pk_add_f32 v[56:57], v[36:37], v[24:25] neg_lo:[0,1] neg_hi:[0,1]
    v_pk_add_f32 v[58:59], v[38:39], v[24:25] neg_lo:[0,1] neg_hi:[0,1]
    v_pk_add_f32 v[60:61], v[40:41], v[24:25] neg_lo:[0,1] neg_hi:[0,1]
    v_pk_add_f32 v[62:63], v[42:43], v[24:25] neg_lo:[0,1] neg_hi:[0,1]
    v_pk_add_f32 v[64:65], v[44:45], v[24:25] neg_lo:[0,1] neg_hi:[0,1]
    v_pk_add_f32 v[66:67], v[46:47], v[24:25] neg_lo:[0,1] neg_hi:[0,1]
    v_pk_add_f32 v[68:69], v[48:49], v[24:25] neg_lo:[0,1] neg_hi:[0,1]
    v_pk_add_f32 v[70:71], v[50:51], v[24:25] neg_lo:[0,1] neg_hi:[0,1]
    v_pk_mul_f32 v[30:31], v[52:53], v[52:53]
    v_pk_mul_f32 v[28:29], v[54:55], v[54:55]
    v_pk_fma_f32 v[30:31], v[56:57], v[56:57], v[30:31]
    v_pk_fma_f32 v[28:29], v[58:59], v[58:59], v[28:29]
    v_pk_fma_f32 v[30:31], v[60:61], v[60:61], v[30:31]
    v_pk_fma_f32 v[28:29], v[62:63], v[62:63], v[28:29]
    v_pk_fma_f32 v[30:31], v[64:65], v[64:65], v[30:31]
    v_pk_fma_f32 v[28:29], v[66:67], v[66:67], v[28:29]
    v_pk_fma_f32 v[30:31], v[68:69], v[68:69], v[30:31]
    v_pk_fma_f32 v[28:29], v[70:71], v[70:71], v[28:29]
    v_pk_add_f32 v[30:31], v[30:31], v[28:29]
    v_add_f32 v25, v30, v31
    s_nop 1
    v_add_f32_dpp v25, v25, v25 row_ror:8 row_mask:0xf bank_mask:0xf
    s_nop 1
    v_add_f32_dpp v25, v25, v25 row_ror:4 row_mask:0xf bank_mask:0xf
    s_nop 1
    v_add_f32_dpp v25, v25, v25 row_ror:2 row_mask:0xf bank_mask:0xf
    s_nop 1
    v_add_f32_dpp v25, v25, v25 row_ror:1 row_mask:0xf bank_mask:0xf
    v_mov_b32 v26, v25
    s_nop 1
    v_permlane16_swap_b32 v25, v26
    s_nop 1
    v_add_f32 v25, v25, v26
    v_mul_f32 v25, s24, v25
    v_cvt_pk_bf16_f32 v26, v24, v25
    v_and_b32 v27, 0xffff0000, v26
    v_lshlrev_b32 v26, 16, v26
    v_add_f32 v27, 0x3727c5ac, v27
    v_mov_b32 v24, v26
    v_cvt_pk_bf16_f32 v27, v27, v27
    v_mov_b32 v25, v26
    v_lshlrev_b32 v27, 16, v27
    v_sqrt_f32 v27, v27
    v_pk_add_f32 v[32:33], v[32:33], v[24:25] neg_lo:[0,1] neg_hi:[0,1]
    v_pk_add_f32 v[34:35], v[34:35], v[24:25] neg_lo:[0,1] neg_hi:[0,1]
    v_pk_add_f32 v[36:37], v[36:37], v[24:25] neg_lo:[0,1] neg_hi:[0,1]
    v_pk_add_f32 v[38:39], v[38:39], v[24:25] neg_lo:[0,1] neg_hi:[0,1]
    v_pk_add_f32 v[40:41], v[40:41], v[24:25] neg_lo:[0,1] neg_hi:[0,1]
    v_pk_add_f32 v[42:43], v[42:43], v[24:25] neg_lo:[0,1] neg_hi:[0,1]
    v_pk_add_f32 v[44:45], v[44:45], v[24:25] neg_lo:[0,1] neg_hi:[0,1]
    v_pk_add_f32 v[46:47], v[46:47], v[24:25] neg_lo:[0,1] neg_hi:[0,1]
    v_pk_add_f32 v[48:49], v[48:49], v[24:25] neg_lo:[0,1] neg_hi:[0,1]
    v_pk_add_f32 v[50:51], v[50:51], v[24:25] neg_lo:[0,1] neg_hi:[0,1]
    v_cvt_pk_bf16_f32 v27, v27, v27
    v_lshlrev_b32 v27, 16, v27
    v_rcp_f32 v28, v27
    v_mov_b32 v76, v27
    v_mov_b32 v77, v27
    v_cvt_pk_bf16_f32 v32, 0, v32
    v_cvt_pk_bf16_f32 v33, 0, v33
    v_cvt_pk_bf16_f32 v34, 0, v34
    v_cvt_pk_bf16_f32 v35, 0, v35
    v_cvt_pk_bf16_f32 v36, 0, v36
    v_cvt_pk_bf16_f32 v37, 0, v37
    v_cvt_pk_bf16_f32 v38, 0, v38
    v_cvt_pk_bf16_f32 v39, 0, v39
    v_mov_b32 v29, v28
    s_and_saveexec_b64 s[36:37], vcc
    buffer_store_dwordx2 v[26:27], v72, s[20:23], 0 offen sc1
    s_mov_b64 exec, s[36:37]
    v_pk_mul_f32 v[52:53], v[32:33], v[28:29]
    v_pk_mul_f32 v[54:55], v[34:35], v[28:29]
    v_pk_mul_f32 v[56:57], v[36:37], v[28:29]
    v_pk_mul_f32 v[58:59], v[38:39], v[28:29]
    v_pk_fma_f32 v[32:33], v[52:53], v[76:77], v[32:33] neg_lo:[1,0,0] neg_hi:[1,0,0]
    v_pk_fma_f32 v[34:35], v[54:55], v[76:77], v[34:35] neg_lo:[1,0,0] neg_hi:[1,0,0]
    v_pk_fma_f32 v[36:37], v[56:57], v[76:77], v[36:37] neg_lo:[1,0,0] neg_hi:[1,0,0]
    v_pk_fma_f32 v[38:39], v[58:59], v[76:77], v[38:39] neg_lo:[1,0,0] neg_hi:[1,0,0]
    v_pk_fma_f32 v[52:53], v[32:33], v[28:29], v[52:53]
    v_pk_fma_f32 v[54:55], v[34:35], v[28:29], v[54:55]
    v_pk_fma_f32 v[56:57], v[36:37], v[28:29], v[56:57]
    v_pk_fma_f32 v[58:59], v[38:39], v[28:29], v[58:59]
    v_cvt_pk_bf16_f32 v4, v52, v53
    v_cvt_pk_bf16_f32 v5, v54, v55
    v_cvt_pk_bf16_f32 v6, v56, v57
    v_cvt_pk_bf16_f32 v7, v58, v59
    buffer_store_dwordx4 v[4:7], v74, s[28:31], s25 offen sc1
    v_cvt_pk_bf16_f32 v40, 0, v40
    v_cvt_pk_bf16_f32 v41, 0, v41
    v_cvt_pk_bf16_f32 v42, 0, v42
    v_cvt_pk_bf16_f32 v43, 0, v43
    v_cvt_pk_bf16_f32 v44, 0, v44
    v_cvt_pk_bf16_f32 v45, 0, v45
    v_cvt_pk_bf16_f32 v46, 0, v46
    v_cvt_pk_bf16_f32 v47, 0, v47
    v_cvt_pk_bf16_f32 v48, 0, v48
    v_cvt_pk_bf16_f32 v49, 0, v49
    v_cvt_pk_bf16_f32 v50, 0, v50
    v_cvt_pk_bf16_f32 v51, 0, v51
    v_pk_mul_f32 v[60:61], v[40:41], v[28:29]
    v_pk_mul_f32 v[62:63], v[42:43], v[28:29]
    v_pk_mul_f32 v[64:65], v[44:45], v[28:29]
    v_pk_mul_f32 v[66:67], v[46:47], v[28:29]
    v_pk_mul_f32 v[68:69], v[48:49], v[28:29]
    v_pk_mul_f32 v[70:71], v[50:51], v[28:29]
    v_pk_fma_f32 v[40:41], v[60:61], v[76:77], v[40:41] neg_lo:[1,0,0] neg_hi:[1,0,0]
    v_pk_fma_f32 v[42:43], v[62:63], v[76:77], v[42:43] neg_lo:[1,0,0] neg_hi:[1,0,0]
    v_pk_fma_f32 v[44:45], v[64:65], v[76:77], v[44:45] neg_lo:[1,0,0] neg_hi:[1,0,0]
    v_pk_fma_f32 v[46:47], v[66:67], v[76:77], v[46:47] neg_lo:[1,0,0] neg_hi:[1,0,0]
    v_pk_fma_f32 v[48:49], v[68:69], v[76:77], v[48:49] neg_lo:[1,0,0] neg_hi:[1,0,0]
    v_pk_fma_f32 v[50:51], v[70:71], v[76:77], v[50:51] neg_lo:[1,0,0] neg_hi:[1,0,0]
    v_pk_fma_f32 v[60:61], v[40:41], v[28:29], v[60:61]
    v_pk_fma_f32 v[62:63], v[42:43], v[28:29], v[62:63]
    v_pk_fma_f32 v[64:65], v[44:45], v[28:29], v[64:65]
    v_pk_fma_f32 v[66:67], v[46:47], v[28:29], v[66:67]
    v_pk_fma_f32 v[68:69], v[48:49], v[28:29], v[68:69]
    v_pk_fma_f32 v[70:71], v[50:51], v[28:29], v[70:71]
    v_cvt_pk_bf16_f32 v8, v60, v61
    v_cvt_pk_bf16_f32 v9, v62, v63
    v_cvt_pk_bf16_f32 v10, v64, v65
    v_cvt_pk_bf16_f32 v11, v66, v67
    v_cvt_pk_bf16_f32 v12, v68, v69
    v_cvt_pk_bf16_f32 v13, v70, v71
    buffer_store_dwordx4 v[8:11], v74, s[28:31], s26 offen sc1
    buffer_store_dwordx2 v[12:13], v75, s[28:31], s27 offen sc1
    s_mov_b32 s41, 0
NG_LN:
    v_mov_b32 v83, 163704
    ds_read_b32 v82, v83
    ds_read_b32 v83, v83 offset:4
    s_waitcnt lgkmcnt(0)
    v_readfirstlane_b32 s100, v82
    v_readfirstlane_b32 s101, v83
    s_cmp_lg_u32 s100, 0
    s_cbranch_scc1 NG_LN_D
    s_sleep 1
    s_add_u32 s41, s41, 1
    s_cmp_lt_u32 s41, 1600000
    s_cbranch_scc1 NG_LN
NG_LN_D:
    s_waitcnt vmcnt(0)
    s_mov_b64 exec, 1
    ds_add_rtn_u32 v87, v85, v86
    s_mov_b64 exec, -1
    s_add_u32 s44, s12, 50331648
    s_addc_u32 s45, s13, 0
    s_mov_b32 s46, 665600
    s_mov_b32 s47, 0x00020000
    v_mov_b32 v82, s100
    v_mov_b32 v83, s101
    v_and_b32 v84, 63, v0
    v_lshlrev_b32 v84, 8, v84
    s_waitcnt lgkmcnt(0)
    v_readfirstlane_b32 s42, v87
    s_and_b32 s42, s42, s56
    s_cbranch_scc0 LN_SKIP
    s_mov_b64 exec, 15
    buffer_store_dwordx2 v[82:83], v84, s[44:47], s40 offen sc1
    s_mov_b64 exec, -1
    v_mov_b32 v85, 163724
    s_mov_b64 exec, 1
    ds_write_b32 v85, v83 offset:112
    ds_write_b32 v85, v82
    s_mov_b64 exec, -1
LN_SKIP:
    s_setprio 0
    s_branch K2_START
K1_TC:
    s_mov_b32 s90, 256
    s_mov_b32 s91, 0x00020000
    s_mov_b32 s41, 0
    v_mov_b32 v88, 163704
    s_mov_b64 exec, 1
    s_waitcnt lgkmcnt(0)
    s_cmp_eq_u32 s2, 0
    s_cbranch_scc1 NP_D
    buffer_load_dwordx2 v[82:83], off, s[88:91], 0 sc1
NP_L:
    s_sleep 4
    buffer_load_dwordx2 v[84:85], off, s[88:91], 0 sc1
    s_waitcnt vmcnt(1)
    v_readfirstlane_b32 s100, v82
    v_readfirstlane_b32 s101, v83
    s_cmp_lg_u32 s100, 0
    s_cbranch_scc1 NP_D
    s_sleep 4
    buffer_load_dwordx2 v[82:83], off, s[88:91], 0 sc1
    s_waitcnt vmcnt(1)
    v_readfirstlane_b32 s100, v84
    v_readfirstlane_b32 s101, v85
    s_cmp_lg_u32 s100, 0
    s_cbranch_scc1 NP_D
    s_add_u32 s41, s41, 1
    s_cmp_lt_u32 s41, 100000
    s_cbranch_scc1 NP_L
NP_D:
    v_mov_b32 v86, s100
    v_mov_b32 v87, s101
    ds_write_b32 v88, v87 offset:4
    ds_write_b32 v88, v86
    s_waitcnt vmcnt(0)
    s_mov_b64 exec, -1
    s_lshr_b32 s14, s2, 3
    s_cmp_lg_u32 s14, 30
    s_cbranch_scc1 K2_START
    s_sleep 110
    s_getpc_b64 s[60:61]
CT_k1b0:
    s_add_u32 s60, s60, F3_BEG-CT_k1b0
    s_addc_u32 s61, s61, 0
    v_subrev_u32 v126, 960, v0
    v_cmp_gt_u32 vcc, (F3_END-F3_BEG)/64, v126
    v_lshlrev_b32 v126, 6, v126
    s_and_saveexec_b64 s[62:63], vcc
    global_load_dword v127, v126, s[60:61]
    s_mov_b64 exec, s[62:63]
    s_getpc_b64 s[60:61]
CT_k1b1:
    s_add_u32 s60, s60, F3_BEG-CT_k1b1
    s_addc_u32 s61, s61, 0
    v_subrev_u32 v126, 896, v0
    v_cmp_gt_u32 vcc, (F3_END-F3_BEG)/64, v126
    v_lshlrev_b32 v126, 6, v126
    s_and_saveexec_b64 s[62:63], vcc
    global_load_dword v127, v126, s[60:61]
    s_mov_b64 exec, s[62:63]
    s_getpc_b64 s[60:61]
CT_k1b2:
    s_add_u32 s60, s60, F3_BEG-CT_k1b2
    s_addc_u32 s61, s61, 0
    v_subrev_u32 v126, 832, v0
    v_cmp_gt_u32 vcc, (F3_END-F3_BEG)/64, v126
    v_lshlrev_b32 v126, 6, v126
    s_and_saveexec_b64 s[62:63], vcc
    global_load_dword v127, v126, s[60:61]
    s_mov_b64 exec, s[62:63]
    s_getpc_b64 s[60:61]
CT_k1b3:
    s_add_u32 s60, s60, F3_BEG-CT_k1b3
    s_addc_u32 s61, s61, 0
    v_subrev_u32 v126, 768, v0
    v_cmp_gt_u32 vcc, (F3_END-F3_BEG)/64, v126
    v_lshlrev_b32 v126, 6, v126
    s_and_saveexec_b64 s[62:63], vcc
    global_load_dword v127, v126, s[60:61]
    s_mov_b64 exec, s[62:63]
    s_getpc_b64 s[60:61]
CT_k1b4:
    s_add_u32 s60, s60, F3_BEG-CT_k1b4
    s_addc_u32 s61, s61, 0
    v_subrev_u32 v126, 704, v0
    v_cmp_gt_u32 vcc, (F3_END-F3_BEG)/64, v126
    v_lshlrev_b32 v126, 6, v126
    s_and_saveexec_b64 s[62:63], vcc
    global_load_dword v127, v126, s[60:61]
    s_mov_b64 exec, s[62:63]
    s_waitcnt vmcnt(0)
    s_branch K2_START
K1_KV:
    s_lshr_b32 s15, s2, 3
    s_and_b32 s14, s15, 3
    s_lshl_b32 s14, s14, 3
    s_and_b32 s32, s2, 7
    s_add_u32 s14, s14, s32
    s_lshr_b32 s15, s15, 2
    v_mul_u32_u24 v2, 6554, v0
    v_lshrrev_b32 v2, 16, v2
    v_mul_u32_u24 v1, 10, v2
    v_sub_u32 v1, v0, v1
    s_mul_i32 s40, s15, 5
    s_add_u32 s40, s40, s3
    s_lshl_b32 s40, s40, 5
    s_add_u32 s40, s40, s14
    s_and_b32 s41, s40, 7
    s_lshl_b32 s41, s41, 3
    s_lshr_b32 s40, s40, 3
    s_lshl_b32 s40, s40, 10
    s_add_u32 s40, s40, s41
    s_add_u32 s40, s40, 65536
    s_lshl_b32 s32, s14, 6
    v_lshlrev_b32 v3, 1, v2
    v_add_u32 v3, s32, v3
    v_mul_u32_u24 v4, 1280, v3
    s_mul_i32 s33, s15, 160
    v_lshlrev_b32 v5, 4, v1
    v_add_u32 v5, s33, v5
    v_add_u32 v4, v4, v5
    v_subrev_u32 v6, 3840, v4
    v_subrev_u32 v10, 2560, v4
    v_subrev_u32 v11, 1280, v4
    v_lshlrev_b32 v7, 2, v5
    s_waitcnt lgkmcnt(0)
    s_mov_b32 s16, s6
    s_mov_b32 s17, s7
    s_mov_b32 s18, 2621440
    s_mov_b32 s19, 0x00020000
    s_mov_b32 s20, s8
    s_mov_b32 s21, s9
    s_mov_b32 s22, 2621440
    s_mov_b32 s23, 0x00020000
    s_mov_b32 s24, s10
    s_mov_b32 s25, s11
    s_mov_b32 s26, 5120
    s_mov_b32 s27, 0x00020000
    s_add_u32 s28, s12, 2621440
    s_addc_u32 s29, s13, 0
    s_mov_b32 s30, 2621440
    s_mov_b32 s31, 0x00020000
    buffer_load_dwordx4 v[60:63], v7, s[24:27], 0 offen offset:0
    buffer_load_dwordx4 v[64:67], v7, s[24:27], 0 offen offset:16
    buffer_load_dwordx4 v[68:71], v7, s[24:27], 0 offen offset:32
    buffer_load_dwordx4 v[72:75], v7, s[24:27], 0 offen offset:48
    buffer_load_dwordx4 v[16:19], v6, s[16:19], 0 offen
    buffer_load_dwordx4 v[20:23], v10, s[16:19], 0 offen
    buffer_load_dwordx4 v[24:27], v11, s[16:19], 0 offen
    buffer_load_dwordx4 v[28:31], v4, s[16:19], 0 offen
    buffer_load_dwordx4 v[32:35], v4, s[16:19], 0 offen offset:1280
    buffer_load_dwordx4 v[44:47], v4, s[20:23], 0 offen offset:0
    buffer_load_dwordx4 v[48:51], v4, s[20:23], 0 offen offset:1280
    s_mov_b32 s34, 0x05040100
    s_mov_b32 s35, 0x07060302
    v_mul_u32_u24 v8, 1168, v1
    v_lshrrev_b32 v9, 2, v2
    v_lshl_add_u32 v8, v9, 4, v8
    v_and_b32 v9, 3, v2
    v_xor_b32 v9, 3, v9
    v_lshl_add_u32 v8, v9, 2, v8
    v_add_u32 v8, 141824, v8
    v_lshrrev_b32 v12, 3, v0
    v_and_b32 v13, 7, v0
    v_mul_u32_u24 v14, 144, v12
    v_lshrrev_b32 v15, 3, v12
    v_add_u32 v15, v15, v13
    v_lshl_add_u32 v14, v15, 4, v14
    v_add_u32 v14, 141824, v14
    s_mul_i32 s33, s15, 80
    v_add_u32 v15, s33, v12
    v_lshlrev_b32 v15, 12, v15
    s_lshl_b32 s32, s14, 7
    v_lshl_add_u32 v15, v13, 4, v15
    s_add_u32 s33, s32, 163840
    s_waitcnt vmcnt(7)
    v_lshlrev_b32 v76, 16, v60
    v_and_b32 v78, 0xffff0000, v60
    v_lshlrev_b32 v80, 16, v61
    v_and_b32 v82, 0xffff0000, v61
    v_lshlrev_b32 v77, 16, v62
    v_and_b32 v79, 0xffff0000, v62
    v_lshlrev_b32 v81, 16, v63
    v_and_b32 v83, 0xffff0000, v63
    v_lshlrev_b32 v84, 16, v64
    v_and_b32 v86, 0xffff0000, v64
    v_lshlrev_b32 v88, 16, v65
    v_and_b32 v90, 0xffff0000, v65
    v_lshlrev_b32 v85, 16, v66
    v_and_b32 v87, 0xffff0000, v66
    v_lshlrev_b32 v89, 16, v67
    v_and_b32 v91, 0xffff0000, v67
    v_lshlrev_b32 v92, 16, v68
    v_and_b32 v94, 0xffff0000, v68
    v_lshlrev_b32 v96, 16, v69
    v_and_b32 v98, 0xffff0000, v69
    v_lshlrev_b32 v93, 16, v70
    v_and_b32 v95, 0xffff0000, v70
    v_lshlrev_b32 v97, 16, v71
    v_and_b32 v99, 0xffff0000, v71
    v_lshlrev_b32 v100, 16, v72
    v_and_b32 v102, 0xffff0000, v72
    v_lshlrev_b32 v104, 16, v73
    v_and_b32 v106, 0xffff0000, v73
    v_lshlrev_b32 v101, 16, v74
    v_and_b32 v103, 0xffff0000, v74
    v_lshlrev_b32 v105, 16, v75
    v_and_b32 v107, 0xffff0000, v75
    s_waitcnt vmcnt(0)
    v_lshlrev_b32 v60, 16, v16
    v_and_b32 v61, 0xffff0000, v16
    v_lshlrev_b32 v62, 16, v20
    v_and_b32 v63, 0xffff0000, v20
    v_lshlrev_b32 v64, 16, v24
    v_and_b32 v65, 0xffff0000, v24
    v_lshlrev_b32 v66, 16, v28
    v_and_b32 v67, 0xffff0000, v28
    v_lshlrev_b32 v68, 16, v32
    v_and_b32 v69, 0xffff0000, v32
    v_pk_mul_f32 v[110:111], v[60:61], v[82:83]
    v_pk_mul_f32 v[116:117], v[62:63], v[82:83]
    v_cvt_pk_bf16_f32 v108, 0, v110
    v_cvt_pk_bf16_f32 v114, 0, v116
    v_cvt_pk_bf16_f32 v109, 0, v111
    v_cvt_pk_bf16_f32 v115, 0, v117
    v_pk_mul_f32 v[110:111], v[62:63], v[80:81]
    v_pk_mul_f32 v[116:117], v[64:65], v[80:81]
    v_cvt_pk_bf16_f32 v110, 0, v110
    v_cvt_pk_bf16_f32 v116, 0, v116
    v_cvt_pk_bf16_f32 v111, 0, v111
    v_cvt_pk_bf16_f32 v117, 0, v117
    v_pk_add_f32 v[108:109], v[108:109], v[110:111]
    v_pk_add_f32 v[114:115], v[114:115], v[116:117]
    v_cvt_pk_bf16_f32 v108, 0, v108
    v_cvt_pk_bf16_f32 v114, 0, v114
    v_cvt_pk_bf16_f32 v109, 0, v109
    v_cvt_pk_bf16_f32 v115, 0, v115
    v_pk_mul_f32 v[110:111], v[64:65], v[78:79]
    v_pk_mul_f32 v[116:117], v[66:67], v[78:79]
    v_cvt_pk_bf16_f32 v110, 0, v110
    v_cvt_pk_bf16_f32 v116, 0, v116
    v_cvt_pk_bf16_f32 v111, 0, v111
    v_cvt_pk_bf16_f32 v117, 0, v117
    v_pk_add_f32 v[108:109], v[108:109], v[110:111]
    v_pk_add_f32 v[114:115], v[114:115], v[116:117]
    v_cvt_pk_bf16_f32 v108, 0, v108
    v_cvt_pk_bf16_f32 v114, 0, v114
    v_cvt_pk_bf16_f32 v109, 0, v109
    v_cvt_pk_bf16_f32 v115, 0, v115
    v_pk_mul_f32 v[110:111], v[66:67], v[76:77]
    v_pk_mul_f32 v[116:117], v[68:69], v[76:77]
    v_cvt_pk_bf16_f32 v110, 0, v110
    v_cvt_pk_bf16_f32 v116, 0, v116
    v_cvt_pk_bf16_f32 v111, 0, v111
    v_cvt_pk_bf16_f32 v117, 0, v117
    v_pk_add_f32 v[108:109], v[108:109], v[110:111]
    v_pk_add_f32 v[114:115], v[114:115], v[116:117]
    v_cvt_pk_bf16_f32 v108, 0, v108
    v_cvt_pk_bf16_f32 v114, 0, v114
    v_cvt_pk_bf16_f32 v109, 0, v109
    v_cvt_pk_bf16_f32 v115, 0, v115
    v_lshlrev_b32 v110, 16, v44
    v_lshlrev_b32 v116, 16, v48
    v_and_b32 v111, 0xffff0000, v44
    v_and_b32 v117, 0xffff0000, v48
    v_pk_mul_f32 v[108:109], v[108:109], v[110:111]
    v_pk_mul_f32 v[114:115], v[114:115], v[116:117]
    v_cvt_pk_bf16_f32 v112, v108, v109
    v_cvt_pk_bf16_f32 v118, v114, v115
    v_perm_b32 v70, v112, v118, s34
    ds_write_b32 v8, v70 offset:0
    v_perm_b32 v71, v112, v118, s35
    ds_write_b32 v8, v71 offset:144
    v_lshlrev_b32 v60, 16, v17
    v_and_b32 v61, 0xffff0000, v17
    v_lshlrev_b32 v62, 16, v21
    v_and_b32 v63, 0xffff0000, v21
    v_lshlrev_b32 v64, 16, v25
    v_and_b32 v65, 0xffff0000, v25
    v_lshlrev_b32 v66, 16, v29
    v_and_b32 v67, 0xffff0000, v29
    v_lshlrev_b32 v68, 16, v33
    v_and_b32 v69, 0xffff0000, v33
    v_pk_mul_f32 v[110:111], v[60:61], v[90:91]
    v_pk_mul_f32 v[116:117], v[62:63], v[90:91]
    v_cvt_pk_bf16_f32 v108, 0, v110
    v_cvt_pk_bf16_f32 v114, 0, v116
    v_cvt_pk_bf16_f32 v109, 0, v111
    v_cvt_pk_bf16_f32 v115, 0, v117
    v_pk_mul_f32 v[110:111], v[62:63], v[88:89]
    v_pk_mul_f32 v[116:117], v[64:65], v[88:89]
    v_cvt_pk_bf16_f32 v110, 0, v110
    v_cvt_pk_bf16_f32 v116, 0, v116
    v_cvt_pk_bf16_f32 v111, 0, v111
    v_cvt_pk_bf16_f32 v117, 0, v117
    v_pk_add_f32 v[108:109], v[108:109], v[110:111]
    v_pk_add_f32 v[114:115], v[114:115], v[116:117]
    v_cvt_pk_bf16_f32 v108, 0, v108
    v_cvt_pk_bf16_f32 v114, 0, v114
    v_cvt_pk_bf16_f32 v109, 0, v109
    v_cvt_pk_bf16_f32 v115, 0, v115
    v_pk_mul_f32 v[110:111], v[64:65], v[86:87]
    v_pk_mul_f32 v[116:117], v[66:67], v[86:87]
    v_cvt_pk_bf16_f32 v110, 0, v110
    v_cvt_pk_bf16_f32 v116, 0, v116
    v_cvt_pk_bf16_f32 v111, 0, v111
    v_cvt_pk_bf16_f32 v117, 0, v117
    v_pk_add_f32 v[108:109], v[108:109], v[110:111]
    v_pk_add_f32 v[114:115], v[114:115], v[116:117]
    v_cvt_pk_bf16_f32 v108, 0, v108
    v_cvt_pk_bf16_f32 v114, 0, v114
    v_cvt_pk_bf16_f32 v109, 0, v109
    v_cvt_pk_bf16_f32 v115, 0, v115
    v_pk_mul_f32 v[110:111], v[66:67], v[84:85]
    v_pk_mul_f32 v[116:117], v[68:69], v[84:85]
    v_cvt_pk_bf16_f32 v110, 0, v110
    v_cvt_pk_bf16_f32 v116, 0, v116
    v_cvt_pk_bf16_f32 v111, 0, v111
    v_cvt_pk_bf16_f32 v117, 0, v117
    v_pk_add_f32 v[108:109], v[108:109], v[110:111]
    v_pk_add_f32 v[114:115], v[114:115], v[116:117]
    v_cvt_pk_bf16_f32 v108, 0, v108
    v_cvt_pk_bf16_f32 v114, 0, v114
    v_cvt_pk_bf16_f32 v109, 0, v109
    v_cvt_pk_bf16_f32 v115, 0, v115
    v_lshlrev_b32 v110, 16, v45
    v_lshlrev_b32 v116, 16, v49
    v_and_b32 v111, 0xffff0000, v45
    v_and_b32 v117, 0xffff0000, v49
    v_pk_mul_f32 v[108:109], v[108:109], v[110:111]
    v_pk_mul_f32 v[114:115], v[114:115], v[116:117]
    v_cvt_pk_bf16_f32 v112, v108, v109
    v_cvt_pk_bf16_f32 v118, v114, v115
    v_perm_b32 v70, v112, v118, s34
    ds_write_b32 v8, v70 offset:288
    v_perm_b32 v71, v112, v118, s35
    ds_write_b32 v8, v71 offset:432
    v_lshlrev_b32 v60, 16, v18
    v_and_b32 v61, 0xffff0000, v18
    v_lshlrev_b32 v62, 16, v22
    v_and_b32 v63, 0xffff0000, v22
    v_lshlrev_b32 v64, 16, v26
    v_and_b32 v65, 0xffff0000, v26
    v_lshlrev_b32 v66, 16, v30
    v_and_b32 v67, 0xffff0000, v30
    v_lshlrev_b32 v68, 16, v34
    v_and_b32 v69, 0xffff0000, v34
    v_pk_mul_f32 v[110:111], v[60:61], v[98:99]
    v_pk_mul_f32 v[116:117], v[62:63], v[98:99]
    v_cvt_pk_bf16_f32 v108, 0, v110
    v_cvt_pk_bf16_f32 v114, 0, v116
    v_cvt_pk_bf16_f32 v109, 0, v111
    v_cvt_pk_bf16_f32 v115, 0, v117
    v_pk_mul_f32 v[110:111], v[62:63], v[96:97]
    v_pk_mul_f32 v[116:117], v[64:65], v[96:97]
    v_cvt_pk_bf16_f32 v110, 0, v110
    v_cvt_pk_bf16_f32 v116, 0, v116
    v_cvt_pk_bf16_f32 v111, 0, v111
    v_cvt_pk_bf16_f32 v117, 0, v117
    v_pk_add_f32 v[108:109], v[108:109], v[110:111]
    v_pk_add_f32 v[114:115], v[114:115], v[116:117]
    v_cvt_pk_bf16_f32 v108, 0, v108
    v_cvt_pk_bf16_f32 v114, 0, v114
    v_cvt_pk_bf16_f32 v109, 0, v109
    v_cvt_pk_bf16_f32 v115, 0, v115
    v_pk_mul_f32 v[110:111], v[64:65], v[94:95]
    v_pk_mul_f32 v[116:117], v[66:67], v[94:95]
    v_cvt_pk_bf16_f32 v110, 0, v110
    v_cvt_pk_bf16_f32 v116, 0, v116
    v_cvt_pk_bf16_f32 v111, 0, v111
    v_cvt_pk_bf16_f32 v117, 0, v117
    v_pk_add_f32 v[108:109], v[108:109], v[110:111]
    v_pk_add_f32 v[114:115], v[114:115], v[116:117]
    v_cvt_pk_bf16_f32 v108, 0, v108
    v_cvt_pk_bf16_f32 v114, 0, v114
    v_cvt_pk_bf16_f32 v109, 0, v109
    v_cvt_pk_bf16_f32 v115, 0, v115
    v_pk_mul_f32 v[110:111], v[66:67], v[92:93]
    v_pk_mul_f32 v[116:117], v[68:69], v[92:93]
    v_cvt_pk_bf16_f32 v110, 0, v110
    v_cvt_pk_bf16_f32 v116, 0, v116
    v_cvt_pk_bf16_f32 v111, 0, v111
    v_cvt_pk_bf16_f32 v117, 0, v117
    v_pk_add_f32 v[108:109], v[108:109], v[110:111]
    v_pk_add_f32 v[114:115], v[114:115], v[116:117]
    v_cvt_pk_bf16_f32 v108, 0, v108
    v_cvt_pk_bf16_f32 v114, 0, v114
    v_cvt_pk_bf16_f32 v109, 0, v109
    v_cvt_pk_bf16_f32 v115, 0, v115
    v_lshlrev_b32 v110, 16, v46
    v_lshlrev_b32 v116, 16, v50
    v_and_b32 v111, 0xffff0000, v46
    v_and_b32 v117, 0xffff0000, v50
    v_pk_mul_f32 v[108:109], v[108:109], v[110:111]
    v_pk_mul_f32 v[114:115], v[114:115], v[116:117]
    v_cvt_pk_bf16_f32 v112, v108, v109
    v_cvt_pk_bf16_f32 v118, v114, v115
    v_perm_b32 v70, v112, v118, s34
    ds_write_b32 v8, v70 offset:576
    v_perm_b32 v71, v112, v118, s35
    ds_write_b32 v8, v71 offset:720
    v_lshlrev_b32 v60, 16, v19
    v_and_b32 v61, 0xffff0000, v19
    v_lshlrev_b32 v62, 16, v23
    v_and_b32 v63, 0xffff0000, v23
    v_lshlrev_b32 v64, 16, v27
    v_and_b32 v65, 0xffff0000, v27
    v_lshlrev_b32 v66, 16, v31
    v_and_b32 v67, 0xffff0000, v31
    v_lshlrev_b32 v68, 16, v35
    v_and_b32 v69, 0xffff0000, v35
    v_pk_mul_f32 v[110:111], v[60:61], v[106:107]
    v_pk_mul_f32 v[116:117], v[62:63], v[106:107]
    v_cvt_pk_bf16_f32 v108, 0, v110
    v_cvt_pk_bf16_f32 v114, 0, v116
    v_cvt_pk_bf16_f32 v109, 0, v111
    v_cvt_pk_bf16_f32 v115, 0, v117
    v_pk_mul_f32 v[110:111], v[62:63], v[104:105]
    v_pk_mul_f32 v[116:117], v[64:65], v[104:105]
    v_cvt_pk_bf16_f32 v110, 0, v110
    v_cvt_pk_bf16_f32 v116, 0, v116
    v_cvt_pk_bf16_f32 v111, 0, v111
    v_cvt_pk_bf16_f32 v117, 0, v117
    v_pk_add_f32 v[108:109], v[108:109], v[110:111]
    v_pk_add_f32 v[114:115], v[114:115], v[116:117]
    v_cvt_pk_bf16_f32 v108, 0, v108
    v_cvt_pk_bf16_f32 v114, 0, v114
    v_cvt_pk_bf16_f32 v109, 0, v109
    v_cvt_pk_bf16_f32 v115, 0, v115
    v_pk_mul_f32 v[110:111], v[64:65], v[102:103]
    v_pk_mul_f32 v[116:117], v[66:67], v[102:103]
    v_cvt_pk_bf16_f32 v110, 0, v110
    v_cvt_pk_bf16_f32 v116, 0, v116
    v_cvt_pk_bf16_f32 v111, 0, v111
    v_cvt_pk_bf16_f32 v117, 0, v117
    v_pk_add_f32 v[108:109], v[108:109], v[110:111]
    v_pk_add_f32 v[114:115], v[114:115], v[116:117]
    v_cvt_pk_bf16_f32 v108, 0, v108
    v_cvt_pk_bf16_f32 v114, 0, v114
    v_cvt_pk_bf16_f32 v109, 0, v109
    v_cvt_pk_bf16_f32 v115, 0, v115
    v_pk_mul_f32 v[110:111], v[66:67], v[100:101]
    v_pk_mul_f32 v[116:117], v[68:69], v[100:101]
    v_cvt_pk_bf16_f32 v110, 0, v110
    v_cvt_pk_bf16_f32 v116, 0, v116
    v_cvt_pk_bf16_f32 v111, 0, v111
    v_cvt_pk_bf16_f32 v117, 0, v117
    v_pk_add_f32 v[108:109], v[108:109], v[110:111]
    v_pk_add_f32 v[114:115], v[114:115], v[116:117]
    v_cvt_pk_bf16_f32 v108, 0, v108
    v_cvt_pk_bf16_f32 v114, 0, v114
    v_cvt_pk_bf16_f32 v109, 0, v109
    v_cvt_pk_bf16_f32 v115, 0, v115
    v_lshlrev_b32 v110, 16, v47
    v_lshlrev_b32 v116, 16, v51
    v_and_b32 v111, 0xffff0000, v47
    v_and_b32 v117, 0xffff0000, v51
    v_pk_mul_f32 v[108:109], v[108:109], v[110:111]
    v_pk_mul_f32 v[114:115], v[114:115], v[116:117]
    v_cvt_pk_bf16_f32 v112, v108, v109
    v_cvt_pk_bf16_f32 v118, v114, v115
    v_perm_b32 v70, v112, v118, s34
    ds_write_b32 v8, v70 offset:864
    v_perm_b32 v71, v112, v118, s35
    ds_write_b32 v8, v71 offset:1008
    s_waitcnt lgkmcnt(0)
    v_mov_b32 v1, 1
    v_mov_b32 v2, 163712
    s_mov_b64 exec, 1
    ds_add_u32 v2, v1
    s_mov_b64 exec, -1
    s_mov_b32 s41, 0
KV_SP:
    ds_read_b32 v3, v2
    s_add_u32 s41, s41, 1
    s_waitcnt lgkmcnt(0)
    v_readfirstlane_b32 s42, v3
    s_cmp_ge_u32 s41, 100000
    s_cbranch_scc1 KV_SPD
    s_cmp_lt_u32 s42, 5
    s_cbranch_scc1 KV_SP
KV_SPD:
    ds_read_b128 v[16:19], v14
    ds_read_b128 v[20:23], v14 offset:5840
    s_waitcnt lgkmcnt(1)
    buffer_store_dwordx4 v[16:19], v15, s[28:31], s32 offen sc1
    s_waitcnt lgkmcnt(0)
    buffer_store_dwordx4 v[20:23], v15, s[28:31], s33 offen sc1
    v_mov_b32 v121, 163704
    ds_read_b32 v120, v121
    ds_read_b32 v121, v121 offset:4
    s_waitcnt lgkmcnt(0)
    v_readfirstlane_b32 s100, v120
    v_readfirstlane_b32 s101, v121
    s_cmp_eq_u32 s100, 0
    s_cbranch_scc1 KV_BF
    s_bfe_u32 s42, s2, 0x10002
    s_lshl_b32 s42, s42, 1
    s_sub_u32 s42, 28, s42
    s_lshr_b32 s43, s2, 3
    s_cmp_ge_u32 s43, s42
    s_cbranch_scc1 KV_BF
    s_mov_b32 s70, 1
    s_mov_b32 s71, s40
    s_branch K2_START
KV_BF:
    s_mov_b32 s41, 0
NG_KV:
    v_mov_b32 v121, 163704
    ds_read_b32 v120, v121
    ds_read_b32 v121, v121 offset:4
    s_waitcnt lgkmcnt(0)
    v_readfirstlane_b32 s100, v120
    v_readfirstlane_b32 s101, v121
    s_cmp_lg_u32 s100, 0
    s_cbranch_scc1 NG_KV_D
    s_sleep 1
    s_add_u32 s41, s41, 1
    s_cmp_lt_u32 s41, 1600000
    s_cbranch_scc1 NG_KV
NG_KV_D:
    s_waitcnt vmcnt(0)
    s_add_u32 s44, s12, 50331648
    s_addc_u32 s45, s13, 0
    s_mov_b32 s46, 665600
    s_mov_b32 s47, 0x00020000
    v_mov_b32 v120, s100
    v_mov_b32 v121, s101
    v_and_b32 v122, 63, v0
    v_lshlrev_b32 v122, 8, v122
    s_mov_b64 exec, 15
    buffer_store_dwordx2 v[120:121], v122, s[44:47], s40 offen sc1
    s_mov_b64 exec, -1
    v_mov_b32 v120, 1
    v_mov_b32 v121, 163832
    s_mov_b64 exec, 1
    ds_add_u32 v121, v120
    s_mov_b64 exec, -1
    s_branch K2_START
K2_END:
    s_endpgm
    s_nop 0
    s_nop 0
    s_nop 0
    s_nop 0
    s_nop 0
    s_nop 0
    s_nop 0
    s_nop 0
    s_nop 0
    s_nop 0
    s_nop 0
    s_nop 0
    s_nop 0
    s_nop 0
    s_nop 0
    s_nop 0
    s_nop 0
    s_nop 0
    s_nop 0
    s_nop 0
    s_nop 0
    s_nop 0
    s_nop 0
    s_nop 0
    s_nop 0
    s_nop 0
    s_nop 0
    s_nop 0
    s_nop 0
    s_nop 0
    s_nop 0
    s_nop 0
    s_nop 0
    s_nop 0
    s_nop 0
    s_nop 0
    s_nop 0
    s_nop 0
    s_nop 0
    s_nop 0
    s_nop 0
    s_nop 0
    s_nop 0
    s_nop 0
    s_nop 0
    s_nop 0
    s_nop 0
    s_nop 0
    s_nop 0
    s_nop 0
    s_nop 0
    s_nop 0
    s_nop 0
    s_nop 0
    s_nop 0
    s_nop 0
    s_nop 0
    s_nop 0
    s_nop 0
    s_nop 0
    s_nop 0
    s_nop 0
    s_nop 0
    s_nop 0
    s_nop 0
    s_nop 0
    s_nop 0
    s_nop 0
    s_nop 0
    s_nop 0
    s_nop 0
    s_nop 0
    s_nop 0
    s_nop 0
    s_nop 0
    s_nop 0
    s_nop 0
    s_nop 0
    s_nop 0
    s_nop 0
    s_nop 0
    s_nop 0
    s_nop 0
    s_nop 0
    s_nop 0
    s_nop 0
    s_nop 0
    s_nop 0
    s_nop 0
    s_nop 0
    s_nop 0
    s_nop 0
    s_nop 0
    s_nop 0
    s_nop 0
    s_nop 0
    s_nop 0
    s_nop 0
    s_nop 0
    s_nop 0
    s_nop 0
    s_nop 0
    s_nop 0
    s_nop 0
    s_nop 0
    s_nop 0
    s_nop 0
    s_nop 0
    s_nop 0
    s_nop 0
    s_nop 0
    s_nop 0
    s_nop 0
    s_nop 0
    s_nop 0
    s_nop 0
    s_nop 0
    s_nop 0
    s_nop 0
    s_nop 0
    s_nop 0
    s_nop 0
    s_nop 0
    s_nop 0
    s_nop 0
    s_nop 0
    s_nop 0
    s_nop 0
    s_nop 0
    s_nop 0
    s_nop 0
    s_nop 0
    s_nop 0
    s_nop 0
    s_nop 0
    s_nop 0
    s_nop 0
    s_nop 0
    s_nop 0
    s_nop 0
    s_nop 0
    s_nop 0
    s_nop 0
    s_nop 0
    s_nop 0
    s_nop 0
    s_nop 0
    s_nop 0
    s_nop 0
    s_nop 0
    s_nop 0
    s_nop 0
    s_nop 0
    s_nop 0
    s_nop 0
    s_nop 0
    s_nop 0
    s_nop 0
    s_nop 0
F3_BEG:
F3_C:
    s_load_dwordx2 s[10:11], s[0:1], 80
    s_and_b32 s14, s2, 7
    s_and_b32 s35, s14, 3
    s_lshl_b32 s35, s35, 1
    s_lshr_b32 s14, s14, 2
    s_add_u32 s14, s14, s35
    s_lshl_b32 s14, s14, 2
    s_lshr_b32 s15, s2, 3
    s_and_b32 s35, s15, 3
    s_add_u32 s14, s14, s35
    s_lshr_b32 s15, s15, 2
    v_and_b32 v20, 15, v1
    v_lshrrev_b32 v21, 4, v1
    v_and_b32 v22, 1, v21
    s_and_b32 s50, s3, 1
    s_bfe_u32 s51, s3, 0x10001
    s_lshr_b32 s53, s3, 2
    s_xor_b32 s53, s53, 1
    s_lshl_b32 s47, s51, 1
    s_add_u32 s47, s47, s53
    v_lshlrev_b32 v24, 10, v21
    s_lshl_b32 s49, s50, 9
    s_lshl_b32 s52, s51, 12
    s_add_u32 s49, s49, s52
    s_add_u32 s49, s49, 40960
    v_lshl_add_u32 v24, v20, 4, v24
    v_add_u32 v24, s49, v24
    v_lshl_add_u32 v4, v22, 3, v24
    v_xor_b32 v5, 8, v4
    v_bfe_u32 v24, v1, 2, 2
    v_lshl_add_u32 v24, v21, 3, v24
    v_lshl_add_u32 v25, v22, 2, v24
    v_xor_b32 v26, 1, v22
    v_lshl_add_u32 v26, v26, 2, v24
    v_and_b32 v24, 3, v1
    v_lshlrev_b32 v24, 3, v24
    s_mul_i32 s49, s51, 5120
    v_add_u32 v24, s49, v24
    s_movk_i32 s49, 160
    v_mad_u32_u24 v6, v25, s49, v24
    v_mad_u32_u24 v7, v26, s49, v24
    v_add_u32 v8, 98304, v6
    v_add_u32 v9, 98304, v7
    s_lshl_b32 s49, s50, 1
    s_add_u32 s49, s49, s51
    s_lshl_b32 s49, s49, 4
    v_add_u32 v23, s49, v20
    s_mul_i32 s54, s53, 96
    s_lshl_b32 s55, s53, 2
    s_add_u32 s55, s55, 64
    v_mul_u32_u24 v24, 160, v23
    v_lshl_add_u32 v24, v21, 3, v24
    v_add_u32 v24, 129024, v24
    v_add_u32 v2, s54, v24
    v_add_u32 v12, s55, v24
    s_lshl_b32 s36, s14, 6
    v_add_u32 v24, s36, v23
    v_mul_u32_u24 v24, 1280, v24
    v_lshl_add_u32 v24, v21, 3, v24
    s_mul_i32 s39, s15, 160
    v_add_u32 v24, s39, v24
    v_add_u32 v3, s54, v24
    v_add_u32 v13, s55, v24
    v_lshlrev_b32 v10, 4, v1
    v_lshlrev_b32 v11, 3, v1
    s_sub_u32 s49, s47, 1
    s_and_b32 s49, s49, 3
    s_mul_i32 s52, s50, 12
    s_add_u32 s49, s49, s52
    s_mul_i32 s49, s49, 2560
    s_add_u32 s49, s49, 10240
    v_add_u32 v56, s49, v10
    v_add_u32 v57, s49, v11
    s_sub_u32 s49, s47, 2
    s_and_b32 s49, s49, 3
    s_mul_i32 s52, s50, 12
    s_add_u32 s49, s49, s52
    s_mul_i32 s49, s49, 2560
    s_add_u32 s49, s49, 17920
    v_add_u32 v58, s49, v10
    v_add_u32 v59, s49, v11
    s_sub_u32 s49, s47, 3
    s_and_b32 s49, s49, 3
    s_mul_i32 s52, s50, 12
    s_add_u32 s49, s49, s52
    s_mul_i32 s49, s49, 2560
    s_add_u32 s49, s49, 25600
    v_add_u32 v60, s49, v10
    v_add_u32 v61, s49, v11
    s_sub_u32 s49, s47, 4
    s_and_b32 s49, s49, 3
    s_mul_i32 s52, s50, 12
    s_add_u32 s49, s49, s52
    s_mul_i32 s49, s49, 2560
    s_add_u32 s49, s49, 33280
    v_add_u32 v62, s49, v10
    v_add_u32 v63, s49, v11
    s_lshl_b32 s49, s50, 2
    s_add_u32 s49, s49, s47
    s_mul_i32 s49, s49, 7680
    s_add_u32 s49, s49, 10240
    v_add_u32 v10, s49, v10
    v_add_u32 v11, s49, v11
    v_lshrrev_b32 v24, 2, v1
    v_and_b32 v25, 3, v1
    v_lshlrev_b32 v14, 6, v24
    v_lshl_add_u32 v14, v25, 3, v14
    s_mul_i32 s49, s50, 5120
    s_lshl_b32 s52, s51, 5
    s_add_u32 s49, s49, s52
    s_add_u32 s49, s49, 118784
    v_add_u32 v14, s49, v14
    s_mul_i32 s49, s53, 3072
    v_add_u32 v90, s49, v14
    v_lshlrev_b32 v15, 3, v23
    v_add_u32 v15, 139264, v15
    s_cmp_eq_u32 s53, 1
    s_cselect_b64 s[44:45], -1, 0
    s_waitcnt lgkmcnt(0)
    s_mov_b32 s32, s10
    s_mov_b32 s33, s11
    s_mov_b32 s34, 2621440
    s_mov_b32 s35, 0x00020000
    s_barrier
    s_cmp_lt_u32 s3, 4
    s_cbranch_scc1 F3_EV
    s_barrier
    ds_read_b64 v[92:93], v4 offset:8192
    ds_read_b64 v[94:95], v5 offset:8192
    ds_read_b64_tr_b16 v[100:101], v8 offset:53760
    ds_read_b64_tr_b16 v[102:103], v9 offset:53760
    ds_read_b64 v[96:97], v4 offset:8448
    ds_read_b64 v[98:99], v5 offset:8448
    ds_read_b64_tr_b16 v[104:105], v8 offset:53792
    ds_read_b64_tr_b16 v[106:107], v9 offset:53792
    ds_read_b64_tr_b16 v[108:109], v8 offset:53824
    ds_read_b64_tr_b16 v[110:111], v9 offset:53824
    ds_read_b64_tr_b16 v[112:113], v8 offset:53856
    ds_read_b64_tr_b16 v[114:115], v9 offset:53856
    ds_read_b64_tr_b16 v[116:117], v8 offset:53888
    ds_read_b64_tr_b16 v[118:119], v9 offset:53888
    s_barrier
    s_waitcnt lgkmcnt(10)
    v_mfma_f32_16x16x32_bf16 v[16:19], v[100:103], v[92:95], 0
    s_waitcnt lgkmcnt(8)
    v_mfma_f32_16x16x32_bf16 v[36:39], v[100:103], v[96:99], 0
    s_waitcnt lgkmcnt(6)
    v_mfma_f32_16x16x32_bf16 v[20:23], v[104:107], v[92:95], 0
    v_mfma_f32_16x16x32_bf16 v[40:43], v[104:107], v[96:99], 0
    s_waitcnt lgkmcnt(4)
    v_mfma_f32_16x16x32_bf16 v[24:27], v[108:111], v[92:95], 0
    v_mfma_f32_16x16x32_bf16 v[44:47], v[108:111], v[96:99], 0
    s_waitcnt lgkmcnt(2)
    v_mfma_f32_16x16x32_bf16 v[28:31], v[112:115], v[92:95], 0
    v_mfma_f32_16x16x32_bf16 v[48:51], v[112:115], v[96:99], 0
    s_waitcnt lgkmcnt(0)
    v_mfma_f32_16x16x32_bf16 v[32:35], v[116:119], v[92:95], 0
    v_mfma_f32_16x16x32_bf16 v[52:55], v[116:119], v[96:99], 0
    s_barrier
    ds_read_b64 v[92:93], v4 offset:24576
    ds_read_b64 v[94:95], v5 offset:24576
    ds_read_b64_tr_b16 v[100:101], v6 offset:10240
    ds_read_b64_tr_b16 v[102:103], v7 offset:10240
    ds_read_b64 v[96:97], v4 offset:24832
    ds_read_b64 v[98:99], v5 offset:24832
    ds_read_b64_tr_b16 v[104:105], v6 offset:10272
    ds_read_b64_tr_b16 v[106:107], v7 offset:10272
    ds_read_b64_tr_b16 v[108:109], v6 offset:10304
    ds_read_b64_tr_b16 v[110:111], v7 offset:10304
    ds_read_b64_tr_b16 v[112:113], v6 offset:10336
    ds_read_b64_tr_b16 v[114:115], v7 offset:10336
    ds_read_b64_tr_b16 v[116:117], v6 offset:10368
    ds_read_b64_tr_b16 v[118:119], v7 offset:10368
    s_barrier
    s_waitcnt lgkmcnt(10)
    v_mfma_f32_16x16x32_bf16 v[16:19], v[100:103], v[92:95], v[16:19]
    s_waitcnt lgkmcnt(8)
    v_mfma_f32_16x16x32_bf16 v[36:39], v[100:103], v[96:99], v[36:39]
    s_waitcnt lgkmcnt(6)
    v_mfma_f32_16x16x32_bf16 v[20:23], v[104:107], v[92:95], v[20:23]
    v_mfma_f32_16x16x32_bf16 v[40:43], v[104:107], v[96:99], v[40:43]
    s_waitcnt lgkmcnt(4)
    v_mfma_f32_16x16x32_bf16 v[24:27], v[108:111], v[92:95], v[24:27]
    v_mfma_f32_16x16x32_bf16 v[44:47], v[108:111], v[96:99], v[44:47]
    s_waitcnt lgkmcnt(2)
    v_mfma_f32_16x16x32_bf16 v[28:31], v[112:115], v[92:95], v[28:31]
    v_mfma_f32_16x16x32_bf16 v[48:51], v[112:115], v[96:99], v[48:51]
    s_waitcnt lgkmcnt(0)
    v_mfma_f32_16x16x32_bf16 v[32:35], v[116:119], v[92:95], v[32:35]
    v_mfma_f32_16x16x32_bf16 v[52:55], v[116:119], v[96:99], v[52:55]
    s_barrier
    ds_read_b64 v[92:93], v4 offset:40960
    ds_read_b64 v[94:95], v5 offset:40960
    ds_read_b64_tr_b16 v[100:101], v6 offset:30720
    ds_read_b64_tr_b16 v[102:103], v7 offset:30720
    ds_read_b64 v[96:97], v4 offset:41216
    ds_read_b64 v[98:99], v5 offset:41216
    ds_read_b64_tr_b16 v[104:105], v6 offset:30752
    ds_read_b64_tr_b16 v[106:107], v7 offset:30752
    ds_read_b64_tr_b16 v[108:109], v6 offset:30784
    ds_read_b64_tr_b16 v[110:111], v7 offset:30784
    ds_read_b64_tr_b16 v[112:113], v6 offset:30816
    ds_read_b64_tr_b16 v[114:115], v7 offset:30816
    ds_read_b64_tr_b16 v[116:117], v6 offset:30848
    ds_read_b64_tr_b16 v[118:119], v7 offset:30848
    s_barrier
    s_waitcnt lgkmcnt(10)
    v_mfma_f32_16x16x32_bf16 v[16:19], v[100:103], v[92:95], v[16:19]
    s_waitcnt lgkmcnt(8)
    v_mfma_f32_16x16x32_bf16 v[36:39], v[100:103], v[96:99], v[36:39]
    s_waitcnt lgkmcnt(6)
    v_mfma_f32_16x16x32_bf16 v[20:23], v[104:107], v[92:95], v[20:23]
    v_mfma_f32_16x16x32_bf16 v[40:43], v[104:107], v[96:99], v[40:43]
    s_waitcnt lgkmcnt(4)
    v_mfma_f32_16x16x32_bf16 v[24:27], v[108:111], v[92:95], v[24:27]
    v_mfma_f32_16x16x32_bf16 v[44:47], v[108:111], v[96:99], v[44:47]
    s_waitcnt lgkmcnt(2)
    v_mfma_f32_16x16x32_bf16 v[28:31], v[112:115], v[92:95], v[28:31]
    v_mfma_f32_16x16x32_bf16 v[48:51], v[112:115], v[96:99], v[48:51]
    s_waitcnt lgkmcnt(0)
    v_mfma_f32_16x16x32_bf16 v[32:35], v[116:119], v[92:95], v[32:35]
    v_mfma_f32_16x16x32_bf16 v[52:55], v[116:119], v[96:99], v[52:55]
    s_barrier
    ds_read_b64 v[80:81], v15
    ds_read_b64 v[64:65], v2
    ds_read_b64 v[66:67], v2 offset:32
    ds_read_b32 v68, v12
    ds_read_b64 v[92:93], v4 offset:0
    ds_read_b64 v[94:95], v5 offset:0
    ds_read_b64_tr_b16 v[100:101], v8 offset:10240
    ds_read_b64_tr_b16 v[102:103], v9 offset:10240
    ds_read_b64 v[96:97], v4 offset:256
    ds_read_b64 v[98:99], v5 offset:256
    ds_read_b64_tr_b16 v[104:105], v8 offset:10272
    ds_read_b64_tr_b16 v[106:107], v9 offset:10272
    ds_read_b64_tr_b16 v[108:109], v8 offset:10304
    ds_read_b64_tr_b16 v[110:111], v9 offset:10304
    ds_read_b64_tr_b16 v[112:113], v8 offset:10336
    ds_read_b64_tr_b16 v[114:115], v9 offset:10336
    ds_read_b64_tr_b16 v[116:117], v8 offset:10368
    ds_read_b64_tr_b16 v[118:119], v9 offset:10368
    s_barrier
    s_waitcnt lgkmcnt(10)
    v_mfma_f32_16x16x32_bf16 v[16:19], v[100:103], v[92:95], v[16:19]
    s_waitcnt lgkmcnt(8)
    v_mfma_f32_16x16x32_bf16 v[36:39], v[100:103], v[96:99], v[36:39]
    s_waitcnt lgkmcnt(6)
    v_mfma_f32_16x16x32_bf16 v[20:23], v[104:107], v[92:95], v[20:23]
    v_mfma_f32_16x16x32_bf16 v[40:43], v[104:107], v[96:99], v[40:43]
    s_waitcnt lgkmcnt(4)
    v_mfma_f32_16x16x32_bf16 v[24:27], v[108:111], v[92:95], v[24:27]
    v_mfma_f32_16x16x32_bf16 v[44:47], v[108:111], v[96:99], v[44:47]
    s_waitcnt lgkmcnt(2)
    v_mfma_f32_16x16x32_bf16 v[28:31], v[112:115], v[92:95], v[28:31]
    v_mfma_f32_16x16x32_bf16 v[48:51], v[112:115], v[96:99], v[48:51]
    s_waitcnt lgkmcnt(0)
    v_mfma_f32_16x16x32_bf16 v[32:35], v[116:119], v[92:95], v[32:35]
    v_mfma_f32_16x16x32_bf16 v[52:55], v[116:119], v[96:99], v[52:55]
    s_barrier
    ds_read_b64 v[92:93], v4 offset:16384
    ds_read_b64 v[94:95], v5 offset:16384
    ds_read_b64_tr_b16 v[100:101], v8 offset:53760
    ds_read_b64_tr_b16 v[102:103], v9 offset:53760
    ds_read_b64 v[96:97], v4 offset:16640
    ds_read_b64 v[98:99], v5 offset:16640
    ds_read_b64_tr_b16 v[104:105], v8 offset:53792
    ds_read_b64_tr_b16 v[106:107], v9 offset:53792
    ds_read_b64_tr_b16 v[108:109], v8 offset:53824
    ds_read_b64_tr_b16 v[110:111], v9 offset:53824
    ds_read_b64_tr_b16 v[112:113], v8 offset:53856
    ds_read_b64_tr_b16 v[114:115], v9 offset:53856
    ds_read_b64_tr_b16 v[116:117], v8 offset:53888
    ds_read_b64_tr_b16 v[118:119], v9 offset:53888
    s_barrier
    v_mov_b32 v76, v80
    v_mov_b32 v77, v80
    s_waitcnt lgkmcnt(10)
    v_mfma_f32_16x16x32_bf16 v[16:19], v[100:103], v[92:95], v[16:19]
    v_mov_b32 v78, v81
    v_mov_b32 v79, v81
    s_waitcnt lgkmcnt(8)
    v_mfma_f32_16x16x32_bf16 v[36:39], v[100:103], v[96:99], v[36:39]
    v_rcp_f32 v80, v81
    s_nop 0
    s_waitcnt lgkmcnt(6)
    v_mfma_f32_16x16x32_bf16 v[20:23], v[104:107], v[92:95], v[20:23]
    v_mov_b32 v81, v80
    v_lshlrev_b32 v82, 16, v64
    v_mfma_f32_16x16x32_bf16 v[40:43], v[104:107], v[96:99], v[40:43]
    v_and_b32 v83, 0xffff0000, v64
    v_pk_add_f32 v[84:85], v[82:83], v[76:77] neg_lo:[0,1] neg_hi:[0,1]
    s_waitcnt lgkmcnt(4)
    v_mfma_f32_16x16x32_bf16 v[24:27], v[108:111], v[92:95], v[24:27]
    v_cvt_pk_bf16_f32 v84, 0, v84
    v_cvt_pk_bf16_f32 v85, 0, v85
    v_mfma_f32_16x16x32_bf16 v[44:47], v[108:111], v[96:99], v[44:47]
    v_pk_mul_f32 v[86:87], v[84:85], v[80:81]
    s_waitcnt lgkmcnt(2)
    v_mfma_f32_16x16x32_bf16 v[28:31], v[112:115], v[92:95], v[28:31]
    v_pk_fma_f32 v[84:85], v[86:87], v[78:79], v[84:85] neg_lo:[1,0,0] neg_hi:[1,0,0]
    v_mfma_f32_16x16x32_bf16 v[48:51], v[112:115], v[96:99], v[48:51]
    v_pk_fma_f32 v[86:87], v[84:85], v[80:81], v[86:87]
    s_waitcnt lgkmcnt(0)
    v_mfma_f32_16x16x32_bf16 v[32:35], v[116:119], v[92:95], v[32:35]
    v_cvt_pk_bf16_f32 v120, v86, v87
    v_mfma_f32_16x16x32_bf16 v[52:55], v[116:119], v[96:99], v[52:55]
    s_barrier
    ds_read_b64 v[92:93], v4 offset:32768
    ds_read_b64 v[94:95], v5 offset:32768
    ds_read_b64_tr_b16 v[100:101], v6 offset:10240
    ds_read_b64_tr_b16 v[102:103], v7 offset:10240
    ds_read_b64 v[96:97], v4 offset:33024
    ds_read_b64 v[98:99], v5 offset:33024
    ds_read_b64_tr_b16 v[104:105], v6 offset:10272
    ds_read_b64_tr_b16 v[106:107], v7 offset:10272
    ds_read_b64_tr_b16 v[108:109], v6 offset:10304
    ds_read_b64_tr_b16 v[110:111], v7 offset:10304
    ds_read_b64_tr_b16 v[112:113], v6 offset:10336
    ds_read_b64_tr_b16 v[114:115], v7 offset:10336
    ds_read_b64_tr_b16 v[116:117], v6 offset:10368
    ds_read_b64_tr_b16 v[118:119], v7 offset:10368
    s_barrier
    v_lshlrev_b32 v82, 16, v65
    s_waitcnt lgkmcnt(10)
    v_mfma_f32_16x16x32_bf16 v[16:19], v[100:103], v[92:95], v[16:19]
    v_and_b32 v83, 0xffff0000, v65
    s_waitcnt lgkmcnt(8)
    v_mfma_f32_16x16x32_bf16 v[36:39], v[100:103], v[96:99], v[36:39]
    v_pk_add_f32 v[84:85], v[82:83], v[76:77] neg_lo:[0,1] neg_hi:[0,1]
    s_waitcnt lgkmcnt(6)
    v_mfma_f32_16x16x32_bf16 v[20:23], v[104:107], v[92:95], v[20:23]
    v_cvt_pk_bf16_f32 v84, 0, v84
    v_mfma_f32_16x16x32_bf16 v[40:43], v[104:107], v[96:99], v[40:43]
    v_cvt_pk_bf16_f32 v85, 0, v85
    s_waitcnt lgkmcnt(4)
    v_mfma_f32_16x16x32_bf16 v[24:27], v[108:111], v[92:95], v[24:27]
    v_pk_mul_f32 v[86:87], v[84:85], v[80:81]
    v_mfma_f32_16x16x32_bf16 v[44:47], v[108:111], v[96:99], v[44:47]
    v_pk_fma_f32 v[84:85], v[86:87], v[78:79], v[84:85] neg_lo:[1,0,0] neg_hi:[1,0,0]
    s_waitcnt lgkmcnt(2)
    v_mfma_f32_16x16x32_bf16 v[28:31], v[112:115], v[92:95], v[28:31]
    v_pk_fma_f32 v[86:87], v[84:85], v[80:81], v[86:87]
    v_mfma_f32_16x16x32_bf16 v[48:51], v[112:115], v[96:99], v[48:51]
    v_cvt_pk_bf16_f32 v121, v86, v87
    s_waitcnt lgkmcnt(0)
    v_mfma_f32_16x16x32_bf16 v[32:35], v[116:119], v[92:95], v[32:35]
    v_mfma_f32_16x16x32_bf16 v[52:55], v[116:119], v[96:99], v[52:55]
    s_barrier
    ds_read_b64 v[92:93], v4 offset:49152
    ds_read_b64 v[94:95], v5 offset:49152
    ds_read_b64_tr_b16 v[100:101], v6 offset:30720
    ds_read_b64_tr_b16 v[102:103], v7 offset:30720
    ds_read_b64 v[96:97], v4 offset:49408
    ds_read_b64 v[98:99], v5 offset:49408
    ds_read_b64_tr_b16 v[104:105], v6 offset:30752
    ds_read_b64_tr_b16 v[106:107], v7 offset:30752
    ds_read_b64_tr_b16 v[108:109], v6 offset:30784
    ds_read_b64_tr_b16 v[110:111], v7 offset:30784
    ds_read_b64_tr_b16 v[112:113], v6 offset:30816
    ds_read_b64_tr_b16 v[114:115], v7 offset:30816
    ds_read_b64_tr_b16 v[116:117], v6 offset:30848
    ds_read_b64_tr_b16 v[118:119], v7 offset:30848
    s_barrier
    v_lshlrev_b32 v82, 16, v66
    s_waitcnt lgkmcnt(10)
    v_mfma_f32_16x16x32_bf16 v[16:19], v[100:103], v[92:95], v[16:19]
    v_and_b32 v83, 0xffff0000, v66
    s_waitcnt lgkmcnt(8)
    v_mfma_f32_16x16x32_bf16 v[36:39], v[100:103], v[96:99], v[36:39]
    v_pk_add_f32 v[84:85], v[82:83], v[76:77] neg_lo:[0,1] neg_hi:[0,1]
    s_waitcnt lgkmcnt(6)
    v_mfma_f32_16x16x32_bf16 v[20:23], v[104:107], v[92:95], v[20:23]
    v_cvt_pk_bf16_f32 v84, 0, v84
    v_mfma_f32_16x16x32_bf16 v[40:43], v[104:107], v[96:99], v[40:43]
    v_cvt_pk_bf16_f32 v85, 0, v85
    s_waitcnt lgkmcnt(4)
    v_mfma_f32_16x16x32_bf16 v[24:27], v[108:111], v[92:95], v[24:27]
    v_pk_mul_f32 v[86:87], v[84:85], v[80:81]
    v_mfma_f32_16x16x32_bf16 v[44:47], v[108:111], v[96:99], v[44:47]
    v_pk_fma_f32 v[84:85], v[86:87], v[78:79], v[84:85] neg_lo:[1,0,0] neg_hi:[1,0,0]
    s_waitcnt lgkmcnt(2)
    v_mfma_f32_16x16x32_bf16 v[28:31], v[112:115], v[92:95], v[28:31]
    v_pk_fma_f32 v[86:87], v[84:85], v[80:81], v[86:87]
    v_mfma_f32_16x16x32_bf16 v[48:51], v[112:115], v[96:99], v[48:51]
    v_cvt_pk_bf16_f32 v122, v86, v87
    s_waitcnt lgkmcnt(0)
    v_mfma_f32_16x16x32_bf16 v[32:35], v[116:119], v[92:95], v[32:35]
    v_mfma_f32_16x16x32_bf16 v[52:55], v[116:119], v[96:99], v[52:55]
    s_barrier
    ds_read_b64 v[92:93], v4 offset:8192
    ds_read_b64 v[94:95], v5 offset:8192
    ds_read_b64_tr_b16 v[100:101], v8 offset:10240
    ds_read_b64_tr_b16 v[102:103], v9 offset:10240
    ds_read_b64 v[96:97], v4 offset:8448
    ds_read_b64 v[98:99], v5 offset:8448
    ds_read_b64_tr_b16 v[104:105], v8 offset:10272
    ds_read_b64_tr_b16 v[106:107], v9 offset:10272
    ds_read_b64_tr_b16 v[108:109], v8 offset:10304
    ds_read_b64_tr_b16 v[110:111], v9 offset:10304
    ds_read_b64_tr_b16 v[112:113], v8 offset:10336
    ds_read_b64_tr_b16 v[114:115], v9 offset:10336
    ds_read_b64_tr_b16 v[116:117], v8 offset:10368
    ds_read_b64_tr_b16 v[118:119], v9 offset:10368
    s_barrier
    v_lshlrev_b32 v82, 16, v67
    s_waitcnt lgkmcnt(10)
    v_mfma_f32_16x16x32_bf16 v[16:19], v[100:103], v[92:95], v[16:19]
    v_and_b32 v83, 0xffff0000, v67
    s_waitcnt lgkmcnt(8)
    v_mfma_f32_16x16x32_bf16 v[36:39], v[100:103], v[96:99], v[36:39]
    v_pk_add_f32 v[84:85], v[82:83], v[76:77] neg_lo:[0,1] neg_hi:[0,1]
    s_waitcnt lgkmcnt(6)
    v_mfma_f32_16x16x32_bf16 v[20:23], v[104:107], v[92:95], v[20:23]
    v_cvt_pk_bf16_f32 v84, 0, v84
    v_mfma_f32_16x16x32_bf16 v[40:43], v[104:107], v[96:99], v[40:43]
    v_cvt_pk_bf16_f32 v85, 0, v85
    s_waitcnt lgkmcnt(4)
    v_mfma_f32_16x16x32_bf16 v[24:27], v[108:111], v[92:95], v[24:27]
    v_pk_mul_f32 v[86:87], v[84:85], v[80:81]
    v_mfma_f32_16x16x32_bf16 v[44:47], v[108:111], v[96:99], v[44:47]
    v_pk_fma_f32 v[84:85], v[86:87], v[78:79], v[84:85] neg_lo:[1,0,0] neg_hi:[1,0,0]
    s_waitcnt lgkmcnt(2)
    v_mfma_f32_16x16x32_bf16 v[28:31], v[112:115], v[92:95], v[28:31]
    v_pk_fma_f32 v[86:87], v[84:85], v[80:81], v[86:87]
    v_mfma_f32_16x16x32_bf16 v[48:51], v[112:115], v[96:99], v[48:51]
    v_cvt_pk_bf16_f32 v123, v86, v87
    s_waitcnt lgkmcnt(0)
    v_mfma_f32_16x16x32_bf16 v[32:35], v[116:119], v[92:95], v[32:35]
    v_mfma_f32_16x16x32_bf16 v[52:55], v[116:119], v[96:99], v[52:55]
    s_barrier
    ds_read_b64_tr_b16 v[70:71], v90
    ds_read_b64_tr_b16 v[72:73], v90 offset:1024
    ds_read_b64_tr_b16 v[74:75], v14 offset:2048
    ds_read_b64 v[92:93], v4 offset:24576
    ds_read_b64 v[94:95], v5 offset:24576
    ds_read_b64_tr_b16 v[100:101], v8 offset:53760
    ds_read_b64_tr_b16 v[102:103], v9 offset:53760
    ds_read_b64 v[96:97], v4 offset:24832
    ds_read_b64 v[98:99], v5 offset:24832
    ds_read_b64_tr_b16 v[104:105], v8 offset:53792
    ds_read_b64_tr_b16 v[106:107], v9 offset:53792
    ds_read_b64_tr_b16 v[108:109], v8 offset:53824
    ds_read_b64_tr_b16 v[110:111], v9 offset:53824
    ds_read_b64_tr_b16 v[112:113], v8 offset:53856
    ds_read_b64_tr_b16 v[114:115], v9 offset:53856
    ds_read_b64_tr_b16 v[116:117], v8 offset:53888
    ds_read_b64_tr_b16 v[118:119], v9 offset:53888
    s_barrier
    v_lshlrev_b32 v82, 16, v68
    s_waitcnt lgkmcnt(10)
    v_mfma_f32_16x16x32_bf16 v[16:19], v[100:103], v[92:95], v[16:19]
    v_and_b32 v83, 0xffff0000, v68
    s_waitcnt lgkmcnt(8)
    v_mfma_f32_16x16x32_bf16 v[36:39], v[100:103], v[96:99], v[36:39]
    v_pk_add_f32 v[84:85], v[82:83], v[76:77] neg_lo:[0,1] neg_hi:[0,1]
    s_waitcnt lgkmcnt(6)
    v_mfma_f32_16x16x32_bf16 v[20:23], v[104:107], v[92:95], v[20:23]
    v_cvt_pk_bf16_f32 v84, 0, v84
    v_mfma_f32_16x16x32_bf16 v[40:43], v[104:107], v[96:99], v[40:43]
    v_cvt_pk_bf16_f32 v85, 0, v85
    s_waitcnt lgkmcnt(4)
    v_mfma_f32_16x16x32_bf16 v[24:27], v[108:111], v[92:95], v[24:27]
    v_pk_mul_f32 v[86:87], v[84:85], v[80:81]
    v_mfma_f32_16x16x32_bf16 v[44:47], v[108:111], v[96:99], v[44:47]
    v_pk_fma_f32 v[84:85], v[86:87], v[78:79], v[84:85] neg_lo:[1,0,0] neg_hi:[1,0,0]
    s_waitcnt lgkmcnt(2)
    v_mfma_f32_16x16x32_bf16 v[28:31], v[112:115], v[92:95], v[28:31]
    v_pk_fma_f32 v[86:87], v[84:85], v[80:81], v[86:87]
    v_mfma_f32_16x16x32_bf16 v[48:51], v[112:115], v[96:99], v[48:51]
    v_cvt_pk_bf16_f32 v124, v86, v87
    s_waitcnt lgkmcnt(0)
    v_mfma_f32_16x16x32_bf16 v[32:35], v[116:119], v[92:95], v[32:35]
    v_mfma_f32_16x16x32_bf16 v[52:55], v[116:119], v[96:99], v[52:55]
    s_barrier
    ds_read_b64 v[92:93], v4 offset:40960
    ds_read_b64 v[94:95], v5 offset:40960
    ds_read_b64_tr_b16 v[100:101], v6 offset:10240
    ds_read_b64_tr_b16 v[102:103], v7 offset:10240
    ds_read_b64 v[96:97], v4 offset:41216
    ds_read_b64 v[98:99], v5 offset:41216
    ds_read_b64_tr_b16 v[104:105], v6 offset:10272
    ds_read_b64_tr_b16 v[106:107], v7 offset:10272
    ds_read_b64_tr_b16 v[108:109], v6 offset:10304
    ds_read_b64_tr_b16 v[110:111], v7 offset:10304
    ds_read_b64_tr_b16 v[112:113], v6 offset:10336
    ds_read_b64_tr_b16 v[114:115], v7 offset:10336
    ds_read_b64_tr_b16 v[116:117], v6 offset:10368
    ds_read_b64_tr_b16 v[118:119], v7 offset:10368
    s_barrier
    v_cndmask_b32 v74, v74, v75, s[44:45]
    v_lshlrev_b32 v84, 16, v120
    v_lshlrev_b32 v78, 16, v121
    s_waitcnt lgkmcnt(10)
    v_mfma_f32_16x16x32_bf16 v[16:19], v[100:103], v[92:95], v[16:19]
    v_and_b32 v85, 0xffff0000, v120
    v_and_b32 v79, 0xffff0000, v121
    v_lshlrev_b32 v86, 16, v70
    s_waitcnt lgkmcnt(8)
    v_mfma_f32_16x16x32_bf16 v[36:39], v[100:103], v[96:99], v[36:39]
    v_lshlrev_b32 v80, 16, v71
    v_and_b32 v87, 0xffff0000, v70
    v_and_b32 v81, 0xffff0000, v71
    s_waitcnt lgkmcnt(6)
    v_mfma_f32_16x16x32_bf16 v[20:23], v[104:107], v[92:95], v[20:23]
    v_lshlrev_b32 v82, 16, v64
    v_lshlrev_b32 v76, 16, v65
    v_mfma_f32_16x16x32_bf16 v[40:43], v[104:107], v[96:99], v[40:43]
    v_pk_mul_f32 v[84:85], v[84:85], v[86:87]
    v_pk_mul_f32 v[78:79], v[78:79], v[80:81]
    s_waitcnt lgkmcnt(4)
    v_mfma_f32_16x16x32_bf16 v[24:27], v[108:111], v[92:95], v[24:27]
    v_and_b32 v83, 0xffff0000, v64
    v_and_b32 v77, 0xffff0000, v65
    v_mfma_f32_16x16x32_bf16 v[44:47], v[108:111], v[96:99], v[44:47]
    v_cvt_pk_bf16_f32 v84, 0, v84
    v_cvt_pk_bf16_f32 v78, 0, v78
    s_waitcnt lgkmcnt(2)
    v_mfma_f32_16x16x32_bf16 v[28:31], v[112:115], v[92:95], v[28:31]
    v_cvt_pk_bf16_f32 v85, 0, v85
    v_cvt_pk_bf16_f32 v79, 0, v79
    v_mfma_f32_16x16x32_bf16 v[48:51], v[112:115], v[96:99], v[48:51]
    v_pk_add_f32 v[82:83], v[82:83], v[84:85]
    v_pk_add_f32 v[76:77], v[76:77], v[78:79]
    s_waitcnt lgkmcnt(0)
    v_mfma_f32_16x16x32_bf16 v[32:35], v[116:119], v[92:95], v[32:35]
    v_cvt_pk_bf16_f32 v64, v82, v83
    v_cvt_pk_bf16_f32 v65, v76, v77
    v_mfma_f32_16x16x32_bf16 v[52:55], v[116:119], v[96:99], v[52:55]
    s_barrier
    ds_read_b64 v[92:93], v4 offset:0
    ds_read_b64 v[94:95], v5 offset:0
    ds_read_b64_tr_b16 v[100:101], v6 offset:30720
    ds_read_b64_tr_b16 v[102:103], v7 offset:30720
    ds_read_b64 v[96:97], v4 offset:256
    ds_read_b64 v[98:99], v5 offset:256
    ds_read_b64_tr_b16 v[104:105], v6 offset:30752
    ds_read_b64_tr_b16 v[106:107], v7 offset:30752
    ds_read_b64_tr_b16 v[108:109], v6 offset:30784
    ds_read_b64_tr_b16 v[110:111], v7 offset:30784
    ds_read_b64_tr_b16 v[112:113], v6 offset:30816
    ds_read_b64_tr_b16 v[114:115], v7 offset:30816
    ds_read_b64_tr_b16 v[116:117], v6 offset:30848
    ds_read_b64_tr_b16 v[118:119], v7 offset:30848
    s_barrier
    v_lshlrev_b32 v84, 16, v122
    v_lshlrev_b32 v78, 16, v123
    v_and_b32 v85, 0xffff0000, v122
    s_waitcnt lgkmcnt(10)
    v_mfma_f32_16x16x32_bf16 v[16:19], v[100:103], v[92:95], v[16:19]
    v_and_b32 v79, 0xffff0000, v123
    v_lshlrev_b32 v86, 16, v72
    v_lshlrev_b32 v80, 16, v73
    s_waitcnt lgkmcnt(8)
    v_mfma_f32_16x16x32_bf16 v[36:39], v[100:103], v[96:99], v[36:39]
    v_and_b32 v87, 0xffff0000, v72
    v_and_b32 v81, 0xffff0000, v73
    s_waitcnt lgkmcnt(6)
    v_mfma_f32_16x16x32_bf16 v[20:23], v[104:107], v[92:95], v[20:23]
    v_lshlrev_b32 v82, 16, v66
    v_lshlrev_b32 v76, 16, v67
    v_mfma_f32_16x16x32_bf16 v[40:43], v[104:107], v[96:99], v[40:43]
    v_pk_mul_f32 v[84:85], v[84:85], v[86:87]
    v_pk_mul_f32 v[78:79], v[78:79], v[80:81]
    s_waitcnt lgkmcnt(4)
    v_mfma_f32_16x16x32_bf16 v[24:27], v[108:111], v[92:95], v[24:27]
    v_and_b32 v83, 0xffff0000, v66
    v_and_b32 v77, 0xffff0000, v67
    v_mfma_f32_16x16x32_bf16 v[44:47], v[108:111], v[96:99], v[44:47]
    v_cvt_pk_bf16_f32 v84, 0, v84
    v_cvt_pk_bf16_f32 v78, 0, v78
    s_waitcnt lgkmcnt(2)
    v_mfma_f32_16x16x32_bf16 v[28:31], v[112:115], v[92:95], v[28:31]
    v_cvt_pk_bf16_f32 v85, 0, v85
    v_cvt_pk_bf16_f32 v79, 0, v79
    v_mfma_f32_16x16x32_bf16 v[48:51], v[112:115], v[96:99], v[48:51]
    v_pk_add_f32 v[82:83], v[82:83], v[84:85]
    v_pk_add_f32 v[76:77], v[76:77], v[78:79]
    s_waitcnt lgkmcnt(0)
    v_mfma_f32_16x16x32_bf16 v[32:35], v[116:119], v[92:95], v[32:35]
    v_cvt_pk_bf16_f32 v66, v82, v83
    v_cvt_pk_bf16_f32 v67, v76, v77
    v_mfma_f32_16x16x32_bf16 v[52:55], v[116:119], v[96:99], v[52:55]
    s_barrier
    ds_read_b64 v[92:93], v4 offset:16384
    ds_read_b64 v[94:95], v5 offset:16384
    ds_read_b64_tr_b16 v[100:101], v8 offset:10240
    ds_read_b64_tr_b16 v[102:103], v9 offset:10240
    ds_read_b64 v[96:97], v4 offset:16640
    ds_read_b64 v[98:99], v5 offset:16640
    ds_read_b64_tr_b16 v[104:105], v8 offset:10272
    ds_read_b64_tr_b16 v[106:107], v9 offset:10272
    ds_read_b64_tr_b16 v[108:109], v8 offset:10304
    ds_read_b64_tr_b16 v[110:111], v9 offset:10304
    ds_read_b64_tr_b16 v[112:113], v8 offset:10336
    ds_read_b64_tr_b16 v[114:115], v9 offset:10336
    ds_read_b64_tr_b16 v[116:117], v8 offset:10368
    ds_read_b64_tr_b16 v[118:119], v9 offset:10368
    s_barrier
    v_lshlrev_b32 v84, 16, v124
    v_and_b32 v85, 0xffff0000, v124
    s_waitcnt lgkmcnt(10)
    v_mfma_f32_16x16x32_bf16 v[16:19], v[100:103], v[92:95], v[16:19]
    v_lshlrev_b32 v86, 16, v74
    s_waitcnt lgkmcnt(8)
    v_mfma_f32_16x16x32_bf16 v[36:39], v[100:103], v[96:99], v[36:39]
    v_and_b32 v87, 0xffff0000, v74
    s_waitcnt lgkmcnt(6)
    v_mfma_f32_16x16x32_bf16 v[20:23], v[104:107], v[92:95], v[20:23]
    v_lshlrev_b32 v82, 16, v68
    v_mfma_f32_16x16x32_bf16 v[40:43], v[104:107], v[96:99], v[40:43]
    v_pk_mul_f32 v[84:85], v[84:85], v[86:87]
    s_waitcnt lgkmcnt(4)
    v_mfma_f32_16x16x32_bf16 v[24:27], v[108:111], v[92:95], v[24:27]
    v_and_b32 v83, 0xffff0000, v68
    v_mfma_f32_16x16x32_bf16 v[44:47], v[108:111], v[96:99], v[44:47]
    v_cvt_pk_bf16_f32 v84, 0, v84
    s_waitcnt lgkmcnt(2)
    v_mfma_f32_16x16x32_bf16 v[28:31], v[112:115], v[92:95], v[28:31]
    v_cvt_pk_bf16_f32 v85, 0, v85
    v_mfma_f32_16x16x32_bf16 v[48:51], v[112:115], v[96:99], v[48:51]
    v_pk_add_f32 v[82:83], v[82:83], v[84:85]
    s_waitcnt lgkmcnt(0)
    v_mfma_f32_16x16x32_bf16 v[32:35], v[116:119], v[92:95], v[32:35]
    v_cvt_pk_bf16_f32 v68, v82, v83
    v_mfma_f32_16x16x32_bf16 v[52:55], v[116:119], v[96:99], v[52:55]
    s_barrier
    ds_read_b64 v[92:93], v4 offset:32768
    ds_read_b64 v[94:95], v5 offset:32768
    ds_read_b64_tr_b16 v[100:101], v8 offset:53760
    ds_read_b64_tr_b16 v[102:103], v9 offset:53760
    ds_read_b64 v[96:97], v4 offset:33024
    ds_read_b64 v[98:99], v5 offset:33024
    ds_read_b64_tr_b16 v[104:105], v8 offset:53792
    ds_read_b64_tr_b16 v[106:107], v9 offset:53792
    ds_read_b64_tr_b16 v[108:109], v8 offset:53824
    ds_read_b64_tr_b16 v[110:111], v9 offset:53824
    ds_read_b64_tr_b16 v[112:113], v8 offset:53856
    ds_read_b64_tr_b16 v[114:115], v9 offset:53856
    ds_read_b64_tr_b16 v[116:117], v8 offset:53888
    ds_read_b64_tr_b16 v[118:119], v9 offset:53888
    s_barrier
    s_waitcnt lgkmcnt(0)
    v_mfma_f32_16x16x32_bf16 v[16:19], v[100:103], v[92:95], v[16:19]
    v_mfma_f32_16x16x32_bf16 v[20:23], v[104:107], v[92:95], v[20:23]
    v_mfma_f32_16x16x32_bf16 v[24:27], v[108:111], v[92:95], v[24:27]
    v_mfma_f32_16x16x32_bf16 v[28:31], v[112:115], v[92:95], v[28:31]
    v_mfma_f32_16x16x32_bf16 v[32:35], v[116:119], v[92:95], v[32:35]
    v_mfma_f32_16x16x32_bf16 v[36:39], v[100:103], v[96:99], v[36:39]
    s_cmp_eq_u32 s47, 0
    s_cbranch_scc1 F4_So0
    ds_write_b128 v56, v[16:19]
    ds_write_b128 v56, v[20:23] offset:1024
    ds_write_b64 v57, v[24:25] offset:2048
F4_So0:
    v_mfma_f32_16x16x32_bf16 v[40:43], v[104:107], v[96:99], v[40:43]
    v_mfma_f32_16x16x32_bf16 v[44:47], v[108:111], v[96:99], v[44:47]
    s_cmp_eq_u32 s47, 1
    s_cbranch_scc1 F4_So1
    ds_write_b128 v58, v[28:31]
    ds_write_b128 v58, v[32:35] offset:1024
    ds_write_b64 v59, v[26:27] offset:2048
F4_So1:
    v_mfma_f32_16x16x32_bf16 v[48:51], v[112:115], v[96:99], v[48:51]
    v_mfma_f32_16x16x32_bf16 v[52:55], v[116:119], v[96:99], v[52:55]
    s_nop 3
    s_cmp_eq_u32 s47, 2
    s_cbranch_scc1 F4_So2
    ds_write_b128 v60, v[36:39]
    ds_write_b128 v60, v[40:43] offset:1024
    ds_write_b64 v61, v[44:45] offset:2048
F4_So2:
    s_nop 7
    s_cmp_eq_u32 s47, 3
    s_cbranch_scc1 F4_So3
    ds_write_b128 v62, v[48:51]
    ds_write_b128 v62, v[52:55] offset:1024
    ds_write_b64 v63, v[46:47] offset:2048
F4_So3:
    s_waitcnt lgkmcnt(0)
    s_branch F4_E
F3_EV:
    ds_read_b64 v[92:93], v4 offset:0
    ds_read_b64 v[94:95], v5 offset:0
    ds_read_b64_tr_b16 v[100:101], v8 offset:43520
    ds_read_b64_tr_b16 v[102:103], v9 offset:43520
    ds_read_b64 v[96:97], v4 offset:256
    ds_read_b64 v[98:99], v5 offset:256
    ds_read_b64_tr_b16 v[104:105], v8 offset:43552
    ds_read_b64_tr_b16 v[106:107], v9 offset:43552
    ds_read_b64_tr_b16 v[108:109], v8 offset:43584
    ds_read_b64_tr_b16 v[110:111], v9 offset:43584
    ds_read_b64_tr_b16 v[112:113], v8 offset:43616
    ds_read_b64_tr_b16 v[114:115], v9 offset:43616
    ds_read_b64_tr_b16 v[116:117], v8 offset:43648
    ds_read_b64_tr_b16 v[118:119], v9 offset:43648
    s_barrier
    s_waitcnt lgkmcnt(10)
    v_mfma_f32_16x16x32_bf16 v[16:19], v[100:103], v[92:95], 0
    s_waitcnt lgkmcnt(8)
    v_mfma_f32_16x16x32_bf16 v[36:39], v[100:103], v[96:99], 0
    s_waitcnt lgkmcnt(6)
    v_mfma_f32_16x16x32_bf16 v[20:23], v[104:107], v[92:95], 0
    v_mfma_f32_16x16x32_bf16 v[40:43], v[104:107], v[96:99], 0
    s_waitcnt lgkmcnt(4)
    v_mfma_f32_16x16x32_bf16 v[24:27], v[108:111], v[92:95], 0
    v_mfma_f32_16x16x32_bf16 v[44:47], v[108:111], v[96:99], 0
    s_waitcnt lgkmcnt(2)
    v_mfma_f32_16x16x32_bf16 v[28:31], v[112:115], v[92:95], 0
    v_mfma_f32_16x16x32_bf16 v[48:51], v[112:115], v[96:99], 0
    s_waitcnt lgkmcnt(0)
    v_mfma_f32_16x16x32_bf16 v[32:35], v[116:119], v[92:95], 0
    v_mfma_f32_16x16x32_bf16 v[52:55], v[116:119], v[96:99], 0
    s_barrier
    ds_read_b64 v[92:93], v4 offset:16384
    ds_read_b64 v[94:95], v5 offset:16384
    ds_read_b64_tr_b16 v[100:101], v6 offset:0
    ds_read_b64_tr_b16 v[102:103], v7 offset:0
    ds_read_b64 v[96:97], v4 offset:16640
    ds_read_b64 v[98:99], v5 offset:16640
    ds_read_b64_tr_b16 v[104:105], v6 offset:32
    ds_read_b64_tr_b16 v[106:107], v7 offset:32
    ds_read_b64_tr_b16 v[108:109], v6 offset:64
    ds_read_b64_tr_b16 v[110:111], v7 offset:64
    ds_read_b64_tr_b16 v[112:113], v6 offset:96
    ds_read_b64_tr_b16 v[114:115], v7 offset:96
    ds_read_b64_tr_b16 v[116:117], v6 offset:128
    ds_read_b64_tr_b16 v[118:119], v7 offset:128
    s_barrier
    s_waitcnt lgkmcnt(10)
    v_mfma_f32_16x16x32_bf16 v[16:19], v[100:103], v[92:95], v[16:19]
    s_waitcnt lgkmcnt(8)
    v_mfma_f32_16x16x32_bf16 v[36:39], v[100:103], v[96:99], v[36:39]
    s_waitcnt lgkmcnt(6)
    v_mfma_f32_16x16x32_bf16 v[20:23], v[104:107], v[92:95], v[20:23]
    v_mfma_f32_16x16x32_bf16 v[40:43], v[104:107], v[96:99], v[40:43]
    s_waitcnt lgkmcnt(4)
    v_mfma_f32_16x16x32_bf16 v[24:27], v[108:111], v[92:95], v[24:27]
    v_mfma_f32_16x16x32_bf16 v[44:47], v[108:111], v[96:99], v[44:47]
    s_waitcnt lgkmcnt(2)
    v_mfma_f32_16x16x32_bf16 v[28:31], v[112:115], v[92:95], v[28:31]
    v_mfma_f32_16x16x32_bf16 v[48:51], v[112:115], v[96:99], v[48:51]
    s_waitcnt lgkmcnt(0)
    v_mfma_f32_16x16x32_bf16 v[32:35], v[116:119], v[92:95], v[32:35]
    v_mfma_f32_16x16x32_bf16 v[52:55], v[116:119], v[96:99], v[52:55]
    s_barrier
    ds_read_b64 v[92:93], v4 offset:32768
    ds_read_b64 v[94:95], v5 offset:32768
    ds_read_b64_tr_b16 v[100:101], v6 offset:20480
    ds_read_b64_tr_b16 v[102:103], v7 offset:20480
    ds_read_b64 v[96:97], v4 offset:33024
    ds_read_b64 v[98:99], v5 offset:33024
    ds_read_b64_tr_b16 v[104:105], v6 offset:20512
    ds_read_b64_tr_b16 v[106:107], v7 offset:20512
    ds_read_b64_tr_b16 v[108:109], v6 offset:20544
    ds_read_b64_tr_b16 v[110:111], v7 offset:20544
    ds_read_b64_tr_b16 v[112:113], v6 offset:20576
    ds_read_b64_tr_b16 v[114:115], v7 offset:20576
    ds_read_b64_tr_b16 v[116:117], v6 offset:20608
    ds_read_b64_tr_b16 v[118:119], v7 offset:20608
    s_barrier
    s_waitcnt lgkmcnt(10)
    v_mfma_f32_16x16x32_bf16 v[16:19], v[100:103], v[92:95], v[16:19]
    s_waitcnt lgkmcnt(8)
    v_mfma_f32_16x16x32_bf16 v[36:39], v[100:103], v[96:99], v[36:39]
    s_waitcnt lgkmcnt(6)
    v_mfma_f32_16x16x32_bf16 v[20:23], v[104:107], v[92:95], v[20:23]
    v_mfma_f32_16x16x32_bf16 v[40:43], v[104:107], v[96:99], v[40:43]
    s_waitcnt lgkmcnt(4)
    v_mfma_f32_16x16x32_bf16 v[24:27], v[108:111], v[92:95], v[24:27]
    v_mfma_f32_16x16x32_bf16 v[44:47], v[108:111], v[96:99], v[44:47]
    s_waitcnt lgkmcnt(2)
    v_mfma_f32_16x16x32_bf16 v[28:31], v[112:115], v[92:95], v[28:31]
    v_mfma_f32_16x16x32_bf16 v[48:51], v[112:115], v[96:99], v[48:51]
    s_waitcnt lgkmcnt(0)
    v_mfma_f32_16x16x32_bf16 v[32:35], v[116:119], v[92:95], v[32:35]
    v_mfma_f32_16x16x32_bf16 v[52:55], v[116:119], v[96:99], v[52:55]
    s_barrier
    ds_read_b64 v[80:81], v15
    ds_read_b64 v[64:65], v2
    ds_read_b64 v[66:67], v2 offset:32
    ds_read_b32 v68, v12
    ds_read_b64 v[92:93], v4 offset:49152
    ds_read_b64 v[94:95], v5 offset:49152
    ds_read_b64_tr_b16 v[100:101], v8 offset:0
    ds_read_b64_tr_b16 v[102:103], v9 offset:0
    ds_read_b64 v[96:97], v4 offset:49408
    ds_read_b64 v[98:99], v5 offset:49408
    ds_read_b64_tr_b16 v[104:105], v8 offset:32
    ds_read_b64_tr_b16 v[106:107], v9 offset:32
    ds_read_b64_tr_b16 v[108:109], v8 offset:64
    ds_read_b64_tr_b16 v[110:111], v9 offset:64
    ds_read_b64_tr_b16 v[112:113], v8 offset:96
    ds_read_b64_tr_b16 v[114:115], v9 offset:96
    ds_read_b64_tr_b16 v[116:117], v8 offset:128
    ds_read_b64_tr_b16 v[118:119], v9 offset:128
    s_barrier
    s_waitcnt lgkmcnt(10)
    v_mfma_f32_16x16x32_bf16 v[16:19], v[100:103], v[92:95], v[16:19]
    s_waitcnt lgkmcnt(8)
    v_mfma_f32_16x16x32_bf16 v[36:39], v[100:103], v[96:99], v[36:39]
    s_waitcnt lgkmcnt(6)
    v_mfma_f32_16x16x32_bf16 v[20:23], v[104:107], v[92:95], v[20:23]
    v_mfma_f32_16x16x32_bf16 v[40:43], v[104:107], v[96:99], v[40:43]
    s_waitcnt lgkmcnt(4)
    v_mfma_f32_16x16x32_bf16 v[24:27], v[108:111], v[92:95], v[24:27]
    v_mfma_f32_16x16x32_bf16 v[44:47], v[108:111], v[96:99], v[44:47]
    s_waitcnt lgkmcnt(2)
    v_mfma_f32_16x16x32_bf16 v[28:31], v[112:115], v[92:95], v[28:31]
    v_mfma_f32_16x16x32_bf16 v[48:51], v[112:115], v[96:99], v[48:51]
    s_waitcnt lgkmcnt(0)
    v_mfma_f32_16x16x32_bf16 v[32:35], v[116:119], v[92:95], v[32:35]
    v_mfma_f32_16x16x32_bf16 v[52:55], v[116:119], v[96:99], v[52:55]
    s_barrier
    ds_read_b64 v[92:93], v4 offset:8192
    ds_read_b64 v[94:95], v5 offset:8192
    ds_read_b64_tr_b16 v[100:101], v8 offset:43520
    ds_read_b64_tr_b16 v[102:103], v9 offset:43520
    ds_read_b64 v[96:97], v4 offset:8448
    ds_read_b64 v[98:99], v5 offset:8448
    ds_read_b64_tr_b16 v[104:105], v8 offset:43552
    ds_read_b64_tr_b16 v[106:107], v9 offset:43552
    ds_read_b64_tr_b16 v[108:109], v8 offset:43584
    ds_read_b64_tr_b16 v[110:111], v9 offset:43584
    ds_read_b64_tr_b16 v[112:113], v8 offset:43616
    ds_read_b64_tr_b16 v[114:115], v9 offset:43616
    ds_read_b64_tr_b16 v[116:117], v8 offset:43648
    ds_read_b64_tr_b16 v[118:119], v9 offset:43648
    s_barrier
    v_mov_b32 v76, v80
    v_mov_b32 v77, v80
    s_waitcnt lgkmcnt(10)
    v_mfma_f32_16x16x32_bf16 v[16:19], v[100:103], v[92:95], v[16:19]
    v_mov_b32 v78, v81
    v_mov_b32 v79, v81
    s_waitcnt lgkmcnt(8)
    v_mfma_f32_16x16x32_bf16 v[36:39], v[100:103], v[96:99], v[36:39]
    v_rcp_f32 v80, v81
    s_nop 0
    s_waitcnt lgkmcnt(6)
    v_mfma_f32_16x16x32_bf16 v[20:23], v[104:107], v[92:95], v[20:23]
    v_mov_b32 v81, v80
    v_lshlrev_b32 v82, 16, v64
    v_mfma_f32_16x16x32_bf16 v[40:43], v[104:107], v[96:99], v[40:43]
    v_and_b32 v83, 0xffff0000, v64
    v_pk_add_f32 v[84:85], v[82:83], v[76:77] neg_lo:[0,1] neg_hi:[0,1]
    s_waitcnt lgkmcnt(4)
    v_mfma_f32_16x16x32_bf16 v[24:27], v[108:111], v[92:95], v[24:27]
    v_cvt_pk_bf16_f32 v84, 0, v84
    v_cvt_pk_bf16_f32 v85, 0, v85
    v_mfma_f32_16x16x32_bf16 v[44:47], v[108:111], v[96:99], v[44:47]
    v_pk_mul_f32 v[86:87], v[84:85], v[80:81]
    s_waitcnt lgkmcnt(2)
    v_mfma_f32_16x16x32_bf16 v[28:31], v[112:115], v[92:95], v[28:31]
    v_pk_fma_f32 v[84:85], v[86:87], v[78:79], v[84:85] neg_lo:[1,0,0] neg_hi:[1,0,0]
    v_mfma_f32_16x16x32_bf16 v[48:51], v[112:115], v[96:99], v[48:51]
    v_pk_fma_f32 v[86:87], v[84:85], v[80:81], v[86:87]
    s_waitcnt lgkmcnt(0)
    v_mfma_f32_16x16x32_bf16 v[32:35], v[116:119], v[92:95], v[32:35]
    v_cvt_pk_bf16_f32 v120, v86, v87
    v_mfma_f32_16x16x32_bf16 v[52:55], v[116:119], v[96:99], v[52:55]
    s_barrier
    ds_read_b64 v[92:93], v4 offset:24576
    ds_read_b64 v[94:95], v5 offset:24576
    ds_read_b64_tr_b16 v[100:101], v6 offset:0
    ds_read_b64_tr_b16 v[102:103], v7 offset:0
    ds_read_b64 v[96:97], v4 offset:24832
    ds_read_b64 v[98:99], v5 offset:24832
    ds_read_b64_tr_b16 v[104:105], v6 offset:32
    ds_read_b64_tr_b16 v[106:107], v7 offset:32
    ds_read_b64_tr_b16 v[108:109], v6 offset:64
    ds_read_b64_tr_b16 v[110:111], v7 offset:64
    ds_read_b64_tr_b16 v[112:113], v6 offset:96
    ds_read_b64_tr_b16 v[114:115], v7 offset:96
    ds_read_b64_tr_b16 v[116:117], v6 offset:128
    ds_read_b64_tr_b16 v[118:119], v7 offset:128
    s_barrier
    v_lshlrev_b32 v82, 16, v65
    s_waitcnt lgkmcnt(10)
    v_mfma_f32_16x16x32_bf16 v[16:19], v[100:103], v[92:95], v[16:19]
    v_and_b32 v83, 0xffff0000, v65
    s_waitcnt lgkmcnt(8)
    v_mfma_f32_16x16x32_bf16 v[36:39], v[100:103], v[96:99], v[36:39]
    v_pk_add_f32 v[84:85], v[82:83], v[76:77] neg_lo:[0,1] neg_hi:[0,1]
    s_waitcnt lgkmcnt(6)
    v_mfma_f32_16x16x32_bf16 v[20:23], v[104:107], v[92:95], v[20:23]
    v_cvt_pk_bf16_f32 v84, 0, v84
    v_mfma_f32_16x16x32_bf16 v[40:43], v[104:107], v[96:99], v[40:43]
    v_cvt_pk_bf16_f32 v85, 0, v85
    s_waitcnt lgkmcnt(4)
    v_mfma_f32_16x16x32_bf16 v[24:27], v[108:111], v[92:95], v[24:27]
    v_pk_mul_f32 v[86:87], v[84:85], v[80:81]
    v_mfma_f32_16x16x32_bf16 v[44:47], v[108:111], v[96:99], v[44:47]
    v_pk_fma_f32 v[84:85], v[86:87], v[78:79], v[84:85] neg_lo:[1,0,0] neg_hi:[1,0,0]
    s_waitcnt lgkmcnt(2)
    v_mfma_f32_16x16x32_bf16 v[28:31], v[112:115], v[92:95], v[28:31]
    v_pk_fma_f32 v[86:87], v[84:85], v[80:81], v[86:87]
    v_mfma_f32_16x16x32_bf16 v[48:51], v[112:115], v[96:99], v[48:51]
    v_cvt_pk_bf16_f32 v121, v86, v87
    s_waitcnt lgkmcnt(0)
    v_mfma_f32_16x16x32_bf16 v[32:35], v[116:119], v[92:95], v[32:35]
    v_mfma_f32_16x16x32_bf16 v[52:55], v[116:119], v[96:99], v[52:55]
    s_barrier
    ds_read_b64 v[92:93], v4 offset:40960
    ds_read_b64 v[94:95], v5 offset:40960
    ds_read_b64_tr_b16 v[100:101], v6 offset:20480
    ds_read_b64_tr_b16 v[102:103], v7 offset:20480
    ds_read_b64 v[96:97], v4 offset:41216
    ds_read_b64 v[98:99], v5 offset:41216
    ds_read_b64_tr_b16 v[104:105], v6 offset:20512
    ds_read_b64_tr_b16 v[106:107], v7 offset:20512
    ds_read_b64_tr_b16 v[108:109], v6 offset:20544
    ds_read_b64_tr_b16 v[110:111], v7 offset:20544
    ds_read_b64_tr_b16 v[112:113], v6 offset:20576
    ds_read_b64_tr_b16 v[114:115], v7 offset:20576
    ds_read_b64_tr_b16 v[116:117], v6 offset:20608
    ds_read_b64_tr_b16 v[118:119], v7 offset:20608
    s_barrier
    v_lshlrev_b32 v82, 16, v66
    s_waitcnt lgkmcnt(10)
    v_mfma_f32_16x16x32_bf16 v[16:19], v[100:103], v[92:95], v[16:19]
    v_and_b32 v83, 0xffff0000, v66
    s_waitcnt lgkmcnt(8)
    v_mfma_f32_16x16x32_bf16 v[36:39], v[100:103], v[96:99], v[36:39]
    v_pk_add_f32 v[84:85], v[82:83], v[76:77] neg_lo:[0,1] neg_hi:[0,1]
    s_waitcnt lgkmcnt(6)
    v_mfma_f32_16x16x32_bf16 v[20:23], v[104:107], v[92:95], v[20:23]
    v_cvt_pk_bf16_f32 v84, 0, v84
    v_mfma_f32_16x16x32_bf16 v[40:43], v[104:107], v[96:99], v[40:43]
    v_cvt_pk_bf16_f32 v85, 0, v85
    s_waitcnt lgkmcnt(4)
    v_mfma_f32_16x16x32_bf16 v[24:27], v[108:111], v[92:95], v[24:27]
    v_pk_mul_f32 v[86:87], v[84:85], v[80:81]
    v_mfma_f32_16x16x32_bf16 v[44:47], v[108:111], v[96:99], v[44:47]
    v_pk_fma_f32 v[84:85], v[86:87], v[78:79], v[84:85] neg_lo:[1,0,0] neg_hi:[1,0,0]
    s_waitcnt lgkmcnt(2)
    v_mfma_f32_16x16x32_bf16 v[28:31], v[112:115], v[92:95], v[28:31]
    v_pk_fma_f32 v[86:87], v[84:85], v[80:81], v[86:87]
    v_mfma_f32_16x16x32_bf16 v[48:51], v[112:115], v[96:99], v[48:51]
    v_cvt_pk_bf16_f32 v122, v86, v87
    s_waitcnt lgkmcnt(0)
    v_mfma_f32_16x16x32_bf16 v[32:35], v[116:119], v[92:95], v[32:35]
    v_mfma_f32_16x16x32_bf16 v[52:55], v[116:119], v[96:99], v[52:55]
    s_barrier
    ds_read_b64 v[92:93], v4 offset:0
    ds_read_b64 v[94:95], v5 offset:0
    ds_read_b64_tr_b16 v[100:101], v8 offset:0
    ds_read_b64_tr_b16 v[102:103], v9 offset:0
    ds_read_b64 v[96:97], v4 offset:256
    ds_read_b64 v[98:99], v5 offset:256
    ds_read_b64_tr_b16 v[104:105], v8 offset:32
    ds_read_b64_tr_b16 v[106:107], v9 offset:32
    ds_read_b64_tr_b16 v[108:109], v8 offset:64
    ds_read_b64_tr_b16 v[110:111], v9 offset:64
    ds_read_b64_tr_b16 v[112:113], v8 offset:96
    ds_read_b64_tr_b16 v[114:115], v9 offset:96
    ds_read_b64_tr_b16 v[116:117], v8 offset:128
    ds_read_b64_tr_b16 v[118:119], v9 offset:128
    s_barrier
    v_lshlrev_b32 v82, 16, v67
    s_waitcnt lgkmcnt(10)
    v_mfma_f32_16x16x32_bf16 v[16:19], v[100:103], v[92:95], v[16:19]
    v_and_b32 v83, 0xffff0000, v67
    s_waitcnt lgkmcnt(8)
    v_mfma_f32_16x16x32_bf16 v[36:39], v[100:103], v[96:99], v[36:39]
    v_pk_add_f32 v[84:85], v[82:83], v[76:77] neg_lo:[0,1] neg_hi:[0,1]
    s_waitcnt lgkmcnt(6)
    v_mfma_f32_16x16x32_bf16 v[20:23], v[104:107], v[92:95], v[20:23]
    v_cvt_pk_bf16_f32 v84, 0, v84
    v_mfma_f32_16x16x32_bf16 v[40:43], v[104:107], v[96:99], v[40:43]
    v_cvt_pk_bf16_f32 v85, 0, v85
    s_waitcnt lgkmcnt(4)
    v_mfma_f32_16x16x32_bf16 v[24:27], v[108:111], v[92:95], v[24:27]
    v_pk_mul_f32 v[86:87], v[84:85], v[80:81]
    v_mfma_f32_16x16x32_bf16 v[44:47], v[108:111], v[96:99], v[44:47]
    v_pk_fma_f32 v[84:85], v[86:87], v[78:79], v[84:85] neg_lo:[1,0,0] neg_hi:[1,0,0]
    s_waitcnt lgkmcnt(2)
    v_mfma_f32_16x16x32_bf16 v[28:31], v[112:115], v[92:95], v[28:31]
    v_pk_fma_f32 v[86:87], v[84:85], v[80:81], v[86:87]
    v_mfma_f32_16x16x32_bf16 v[48:51], v[112:115], v[96:99], v[48:51]
    v_cvt_pk_bf16_f32 v123, v86, v87
    s_waitcnt lgkmcnt(0)
    v_mfma_f32_16x16x32_bf16 v[32:35], v[116:119], v[92:95], v[32:35]
    v_mfma_f32_16x16x32_bf16 v[52:55], v[116:119], v[96:99], v[52:55]
    s_barrier
    ds_read_b64 v[92:93], v4 offset:16384
    ds_read_b64 v[94:95], v5 offset:16384
    ds_read_b64_tr_b16 v[100:101], v8 offset:43520
    ds_read_b64_tr_b16 v[102:103], v9 offset:43520
    ds_read_b64 v[96:97], v4 offset:16640
    ds_read_b64 v[98:99], v5 offset:16640
    ds_read_b64_tr_b16 v[104:105], v8 offset:43552
    ds_read_b64_tr_b16 v[106:107], v9 offset:43552
    ds_read_b64_tr_b16 v[108:109], v8 offset:43584
    ds_read_b64_tr_b16 v[110:111], v9 offset:43584
    ds_read_b64_tr_b16 v[112:113], v8 offset:43616
    ds_read_b64_tr_b16 v[114:115], v9 offset:43616
    ds_read_b64_tr_b16 v[116:117], v8 offset:43648
    ds_read_b64_tr_b16 v[118:119], v9 offset:43648
    s_barrier
    v_lshlrev_b32 v82, 16, v68
    s_waitcnt lgkmcnt(10)
    v_mfma_f32_16x16x32_bf16 v[16:19], v[100:103], v[92:95], v[16:19]
    v_and_b32 v83, 0xffff0000, v68
    s_waitcnt lgkmcnt(8)
    v_mfma_f32_16x16x32_bf16 v[36:39], v[100:103], v[96:99], v[36:39]
    v_pk_add_f32 v[84:85], v[82:83], v[76:77] neg_lo:[0,1] neg_hi:[0,1]
    s_waitcnt lgkmcnt(6)
    v_mfma_f32_16x16x32_bf16 v[20:23], v[104:107], v[92:95], v[20:23]
    v_cvt_pk_bf16_f32 v84, 0, v84
    v_mfma_f32_16x16x32_bf16 v[40:43], v[104:107], v[96:99], v[40:43]
    v_cvt_pk_bf16_f32 v85, 0, v85
    s_waitcnt lgkmcnt(4)
    v_mfma_f32_16x16x32_bf16 v[24:27], v[108:111], v[92:95], v[24:27]
    v_pk_mul_f32 v[86:87], v[84:85], v[80:81]
    v_mfma_f32_16x16x32_bf16 v[44:47], v[108:111], v[96:99], v[44:47]
    v_pk_fma_f32 v[84:85], v[86:87], v[78:79], v[84:85] neg_lo:[1,0,0] neg_hi:[1,0,0]
    s_waitcnt lgkmcnt(2)
    v_mfma_f32_16x16x32_bf16 v[28:31], v[112:115], v[92:95], v[28:31]
    v_pk_fma_f32 v[86:87], v[84:85], v[80:81], v[86:87]
    v_mfma_f32_16x16x32_bf16 v[48:51], v[112:115], v[96:99], v[48:51]
    v_cvt_pk_bf16_f32 v124, v86, v87
    s_waitcnt lgkmcnt(0)
    v_mfma_f32_16x16x32_bf16 v[32:35], v[116:119], v[92:95], v[32:35]
    v_mfma_f32_16x16x32_bf16 v[52:55], v[116:119], v[96:99], v[52:55]
    s_barrier
    ds_read_b64_tr_b16 v[70:71], v90
    ds_read_b64_tr_b16 v[72:73], v90 offset:1024
    ds_read_b64_tr_b16 v[74:75], v14 offset:2048
    ds_read_b64 v[92:93], v4 offset:32768
    ds_read_b64 v[94:95], v5 offset:32768
    ds_read_b64_tr_b16 v[100:101], v6 offset:0
    ds_read_b64_tr_b16 v[102:103], v7 offset:0
    ds_read_b64 v[96:97], v4 offset:33024
    ds_read_b64 v[98:99], v5 offset:33024
    ds_read_b64_tr_b16 v[104:105], v6 offset:32
    ds_read_b64_tr_b16 v[106:107], v7 offset:32
    ds_read_b64_tr_b16 v[108:109], v6 offset:64
    ds_read_b64_tr_b16 v[110:111], v7 offset:64
    ds_read_b64_tr_b16 v[112:113], v6 offset:96
    ds_read_b64_tr_b16 v[114:115], v7 offset:96
    ds_read_b64_tr_b16 v[116:117], v6 offset:128
    ds_read_b64_tr_b16 v[118:119], v7 offset:128
    s_barrier
    s_waitcnt lgkmcnt(10)
    v_mfma_f32_16x16x32_bf16 v[16:19], v[100:103], v[92:95], v[16:19]
    s_waitcnt lgkmcnt(8)
    v_mfma_f32_16x16x32_bf16 v[36:39], v[100:103], v[96:99], v[36:39]
    s_waitcnt lgkmcnt(6)
    v_mfma_f32_16x16x32_bf16 v[20:23], v[104:107], v[92:95], v[20:23]
    v_mfma_f32_16x16x32_bf16 v[40:43], v[104:107], v[96:99], v[40:43]
    s_waitcnt lgkmcnt(4)
    v_mfma_f32_16x16x32_bf16 v[24:27], v[108:111], v[92:95], v[24:27]
    v_mfma_f32_16x16x32_bf16 v[44:47], v[108:111], v[96:99], v[44:47]
    s_waitcnt lgkmcnt(2)
    v_mfma_f32_16x16x32_bf16 v[28:31], v[112:115], v[92:95], v[28:31]
    v_mfma_f32_16x16x32_bf16 v[48:51], v[112:115], v[96:99], v[48:51]
    s_waitcnt lgkmcnt(0)
    v_mfma_f32_16x16x32_bf16 v[32:35], v[116:119], v[92:95], v[32:35]
    v_mfma_f32_16x16x32_bf16 v[52:55], v[116:119], v[96:99], v[52:55]
    s_barrier
    ds_read_b64 v[92:93], v4 offset:49152
    ds_read_b64 v[94:95], v5 offset:49152
    ds_read_b64_tr_b16 v[100:101], v6 offset:20480
    ds_read_b64_tr_b16 v[102:103], v7 offset:20480
    ds_read_b64 v[96:97], v4 offset:49408
    ds_read_b64 v[98:99], v5 offset:49408
    ds_read_b64_tr_b16 v[104:105], v6 offset:20512
    ds_read_b64_tr_b16 v[106:107], v7 offset:20512
    ds_read_b64_tr_b16 v[108:109], v6 offset:20544
    ds_read_b64_tr_b16 v[110:111], v7 offset:20544
    ds_read_b64_tr_b16 v[112:113], v6 offset:20576
    ds_read_b64_tr_b16 v[114:115], v7 offset:20576
    ds_read_b64_tr_b16 v[116:117], v6 offset:20608
    ds_read_b64_tr_b16 v[118:119], v7 offset:20608
    s_barrier
    v_cndmask_b32 v74, v74, v75, s[44:45]
    v_lshlrev_b32 v84, 16, v120
    v_lshlrev_b32 v78, 16, v121
    s_waitcnt lgkmcnt(10)
    v_mfma_f32_16x16x32_bf16 v[16:19], v[100:103], v[92:95], v[16:19]
    v_and_b32 v85, 0xffff0000, v120
    v_and_b32 v79, 0xffff0000, v121
    v_lshlrev_b32 v86, 16, v70
    s_waitcnt lgkmcnt(8)
    v_mfma_f32_16x16x32_bf16 v[36:39], v[100:103], v[96:99], v[36:39]
    v_lshlrev_b32 v80, 16, v71
    v_and_b32 v87, 0xffff0000, v70
    v_and_b32 v81, 0xffff0000, v71
    s_waitcnt lgkmcnt(6)
    v_mfma_f32_16x16x32_bf16 v[20:23], v[104:107], v[92:95], v[20:23]
    v_lshlrev_b32 v82, 16, v64
    v_lshlrev_b32 v76, 16, v65
    v_mfma_f32_16x16x32_bf16 v[40:43], v[104:107], v[96:99], v[40:43]
    v_pk_mul_f32 v[84:85], v[84:85], v[86:87]
    v_pk_mul_f32 v[78:79], v[78:79], v[80:81]
    s_waitcnt lgkmcnt(4)
    v_mfma_f32_16x16x32_bf16 v[24:27], v[108:111], v[92:95], v[24:27]
    v_and_b32 v83, 0xffff0000, v64
    v_and_b32 v77, 0xffff0000, v65
    v_mfma_f32_16x16x32_bf16 v[44:47], v[108:111], v[96:99], v[44:47]
    v_cvt_pk_bf16_f32 v84, 0, v84
    v_cvt_pk_bf16_f32 v78, 0, v78
    s_waitcnt lgkmcnt(2)
    v_mfma_f32_16x16x32_bf16 v[28:31], v[112:115], v[92:95], v[28:31]
    v_cvt_pk_bf16_f32 v85, 0, v85
    v_cvt_pk_bf16_f32 v79, 0, v79
    v_mfma_f32_16x16x32_bf16 v[48:51], v[112:115], v[96:99], v[48:51]
    v_pk_add_f32 v[82:83], v[82:83], v[84:85]
    v_pk_add_f32 v[76:77], v[76:77], v[78:79]
    s_waitcnt lgkmcnt(0)
    v_mfma_f32_16x16x32_bf16 v[32:35], v[116:119], v[92:95], v[32:35]
    v_cvt_pk_bf16_f32 v64, v82, v83
    v_cvt_pk_bf16_f32 v65, v76, v77
    v_mfma_f32_16x16x32_bf16 v[52:55], v[116:119], v[96:99], v[52:55]
    s_barrier
    ds_read_b64 v[92:93], v4 offset:8192
    ds_read_b64 v[94:95], v5 offset:8192
    ds_read_b64_tr_b16 v[100:101], v8 offset:0
    ds_read_b64_tr_b16 v[102:103], v9 offset:0
    ds_read_b64 v[96:97], v4 offset:8448
    ds_read_b64 v[98:99], v5 offset:8448
    ds_read_b64_tr_b16 v[104:105], v8 offset:32
    ds_read_b64_tr_b16 v[106:107], v9 offset:32
    ds_read_b64_tr_b16 v[108:109], v8 offset:64
    ds_read_b64_tr_b16 v[110:111], v9 offset:64
    ds_read_b64_tr_b16 v[112:113], v8 offset:96
    ds_read_b64_tr_b16 v[114:115], v9 offset:96
    ds_read_b64_tr_b16 v[116:117], v8 offset:128
    ds_read_b64_tr_b16 v[118:119], v9 offset:128
    s_barrier
    v_lshlrev_b32 v84, 16, v122
    v_lshlrev_b32 v78, 16, v123
    v_and_b32 v85, 0xffff0000, v122
    s_waitcnt lgkmcnt(10)
    v_mfma_f32_16x16x32_bf16 v[16:19], v[100:103], v[92:95], v[16:19]
    v_and_b32 v79, 0xffff0000, v123
    v_lshlrev_b32 v86, 16, v72
    v_lshlrev_b32 v80, 16, v73
    s_waitcnt lgkmcnt(8)
    v_mfma_f32_16x16x32_bf16 v[36:39], v[100:103], v[96:99], v[36:39]
    v_and_b32 v87, 0xffff0000, v72
    v_and_b32 v81, 0xffff0000, v73
    s_waitcnt lgkmcnt(6)
    v_mfma_f32_16x16x32_bf16 v[20:23], v[104:107], v[92:95], v[20:23]
    v_lshlrev_b32 v82, 16, v66
    v_lshlrev_b32 v76, 16, v67
    v_mfma_f32_16x16x32_bf16 v[40:43], v[104:107], v[96:99], v[40:43]
    v_pk_mul_f32 v[84:85], v[84:85], v[86:87]
    v_pk_mul_f32 v[78:79], v[78:79], v[80:81]
    s_waitcnt lgkmcnt(4)
    v_mfma_f32_16x16x32_bf16 v[24:27], v[108:111], v[92:95], v[24:27]
    v_and_b32 v83, 0xffff0000, v66
    v_and_b32 v77, 0xffff0000, v67
    v_mfma_f32_16x16x32_bf16 v[44:47], v[108:111], v[96:99], v[44:47]
    v_cvt_pk_bf16_f32 v84, 0, v84
    v_cvt_pk_bf16_f32 v78, 0, v78
    s_waitcnt lgkmcnt(2)
    v_mfma_f32_16x16x32_bf16 v[28:31], v[112:115], v[92:95], v[28:31]
    v_cvt_pk_bf16_f32 v85, 0, v85
    v_cvt_pk_bf16_f32 v79, 0, v79
    v_mfma_f32_16x16x32_bf16 v[48:51], v[112:115], v[96:99], v[48:51]
    v_pk_add_f32 v[82:83], v[82:83], v[84:85]
    v_pk_add_f32 v[76:77], v[76:77], v[78:79]
    s_waitcnt lgkmcnt(0)
    v_mfma_f32_16x16x32_bf16 v[32:35], v[116:119], v[92:95], v[32:35]
    v_cvt_pk_bf16_f32 v66, v82, v83
    v_cvt_pk_bf16_f32 v67, v76, v77
    v_mfma_f32_16x16x32_bf16 v[52:55], v[116:119], v[96:99], v[52:55]
    s_barrier
    ds_read_b64 v[92:93], v4 offset:24576
    ds_read_b64 v[94:95], v5 offset:24576
    ds_read_b64_tr_b16 v[100:101], v8 offset:43520
    ds_read_b64_tr_b16 v[102:103], v9 offset:43520
    ds_read_b64 v[96:97], v4 offset:24832
    ds_read_b64 v[98:99], v5 offset:24832
    ds_read_b64_tr_b16 v[104:105], v8 offset:43552
    ds_read_b64_tr_b16 v[106:107], v9 offset:43552
    ds_read_b64_tr_b16 v[108:109], v8 offset:43584
    ds_read_b64_tr_b16 v[110:111], v9 offset:43584
    ds_read_b64_tr_b16 v[112:113], v8 offset:43616
    ds_read_b64_tr_b16 v[114:115], v9 offset:43616
    ds_read_b64_tr_b16 v[116:117], v8 offset:43648
    ds_read_b64_tr_b16 v[118:119], v9 offset:43648
    s_barrier
    v_lshlrev_b32 v84, 16, v124
    v_and_b32 v85, 0xffff0000, v124
    s_waitcnt lgkmcnt(10)
    v_mfma_f32_16x16x32_bf16 v[16:19], v[100:103], v[92:95], v[16:19]
    v_lshlrev_b32 v86, 16, v74
    s_waitcnt lgkmcnt(8)
    v_mfma_f32_16x16x32_bf16 v[36:39], v[100:103], v[96:99], v[36:39]
    v_and_b32 v87, 0xffff0000, v74
    s_waitcnt lgkmcnt(6)
    v_mfma_f32_16x16x32_bf16 v[20:23], v[104:107], v[92:95], v[20:23]
    v_lshlrev_b32 v82, 16, v68
    v_mfma_f32_16x16x32_bf16 v[40:43], v[104:107], v[96:99], v[40:43]
    v_pk_mul_f32 v[84:85], v[84:85], v[86:87]
    s_waitcnt lgkmcnt(4)
    v_mfma_f32_16x16x32_bf16 v[24:27], v[108:111], v[92:95], v[24:27]
    v_and_b32 v83, 0xffff0000, v68
    v_mfma_f32_16x16x32_bf16 v[44:47], v[108:111], v[96:99], v[44:47]
    v_cvt_pk_bf16_f32 v84, 0, v84
    s_waitcnt lgkmcnt(2)
    v_mfma_f32_16x16x32_bf16 v[28:31], v[112:115], v[92:95], v[28:31]
    v_cvt_pk_bf16_f32 v85, 0, v85
    v_mfma_f32_16x16x32_bf16 v[48:51], v[112:115], v[96:99], v[48:51]
    v_pk_add_f32 v[82:83], v[82:83], v[84:85]
    s_waitcnt lgkmcnt(0)
    v_mfma_f32_16x16x32_bf16 v[32:35], v[116:119], v[92:95], v[32:35]
    v_cvt_pk_bf16_f32 v68, v82, v83
    v_mfma_f32_16x16x32_bf16 v[52:55], v[116:119], v[96:99], v[52:55]
    s_barrier
    ds_read_b64 v[92:93], v4 offset:40960
    ds_read_b64 v[94:95], v5 offset:40960
    ds_read_b64_tr_b16 v[100:101], v6 offset:0
    ds_read_b64_tr_b16 v[102:103], v7 offset:0
    ds_read_b64 v[96:97], v4 offset:41216
    ds_read_b64 v[98:99], v5 offset:41216
    ds_read_b64_tr_b16 v[104:105], v6 offset:32
    ds_read_b64_tr_b16 v[106:107], v7 offset:32
    ds_read_b64_tr_b16 v[108:109], v6 offset:64
    ds_read_b64_tr_b16 v[110:111], v7 offset:64
    ds_read_b64_tr_b16 v[112:113], v6 offset:96
    ds_read_b64_tr_b16 v[114:115], v7 offset:96
    ds_read_b64_tr_b16 v[116:117], v6 offset:128
    ds_read_b64_tr_b16 v[118:119], v7 offset:128
    s_waitcnt lgkmcnt(0)
    v_mfma_f32_16x16x32_bf16 v[16:19], v[100:103], v[92:95], v[16:19]
    v_mfma_f32_16x16x32_bf16 v[20:23], v[104:107], v[92:95], v[20:23]
    v_mfma_f32_16x16x32_bf16 v[24:27], v[108:111], v[92:95], v[24:27]
    v_mfma_f32_16x16x32_bf16 v[28:31], v[112:115], v[92:95], v[28:31]
    v_mfma_f32_16x16x32_bf16 v[32:35], v[116:119], v[92:95], v[32:35]
    v_mfma_f32_16x16x32_bf16 v[36:39], v[100:103], v[96:99], v[36:39]
    s_cmp_eq_u32 s47, 0
    s_cbranch_scc1 F4_Se0
    ds_write_b128 v56, v[16:19]
    ds_write_b128 v56, v[20:23] offset:1024
    ds_write_b64 v57, v[24:25] offset:2048
F4_Se0:
    v_mfma_f32_16x16x32_bf16 v[40:43], v[104:107], v[96:99], v[40:43]
    v_mfma_f32_16x16x32_bf16 v[44:47], v[108:111], v[96:99], v[44:47]
    s_cmp_eq_u32 s47, 1
    s_cbranch_scc1 F4_Se1
    ds_write_b128 v58, v[28:31]
    ds_write_b128 v58, v[32:35] offset:1024
    ds_write_b64 v59, v[26:27] offset:2048
F4_Se1:
    v_mfma_f32_16x16x32_bf16 v[48:51], v[112:115], v[96:99], v[48:51]
    v_mfma_f32_16x16x32_bf16 v[52:55], v[116:119], v[96:99], v[52:55]
    s_nop 3
    s_cmp_eq_u32 s47, 2
    s_cbranch_scc1 F4_Se2
    ds_write_b128 v60, v[36:39]
    ds_write_b128 v60, v[40:43] offset:1024
    ds_write_b64 v61, v[44:45] offset:2048
F4_Se2:
    s_nop 7
    s_cmp_eq_u32 s47, 3
    s_cbranch_scc1 F4_Se3
    ds_write_b128 v62, v[48:51]
    ds_write_b128 v62, v[52:55] offset:1024
    ds_write_b64 v63, v[46:47] offset:2048
F4_Se3:
    s_waitcnt lgkmcnt(0)
F4_E:
    s_barrier
    ds_read_b128 v[92:95], v10 offset:0
    ds_read_b128 v[96:99], v10 offset:1024
    ds_read_b64 v[100:101], v11 offset:2048
    ds_read_b128 v[102:105], v10 offset:2560
    ds_read_b128 v[106:109], v10 offset:3584
    ds_read_b64 v[110:111], v11 offset:4608
    ds_read_b128 v[80:83], v10 offset:5120
    ds_read_b128 v[84:87], v10 offset:6144
    ds_read_b64 v[88:89], v11 offset:7168
    s_cmp_lg_u32 s47, 0
    s_cbranch_scc1 F4_O0
    s_waitcnt lgkmcnt(6)
    v_pk_add_f32 v[70:71], v[16:17], v[92:93]
    v_pk_add_f32 v[72:73], v[18:19], v[94:95]
    v_pk_add_f32 v[74:75], v[20:21], v[96:97]
    v_pk_add_f32 v[76:77], v[22:23], v[98:99]
    v_pk_add_f32 v[78:79], v[24:25], v[100:101]
F4_O0:
    s_cmp_lg_u32 s47, 1
    s_cbranch_scc1 F4_O1
    s_waitcnt lgkmcnt(6)
    v_pk_add_f32 v[70:71], v[28:29], v[92:93]
    v_pk_add_f32 v[72:73], v[30:31], v[94:95]
    v_pk_add_f32 v[74:75], v[32:33], v[96:97]
    v_pk_add_f32 v[76:77], v[34:35], v[98:99]
    v_pk_add_f32 v[78:79], v[26:27], v[100:101]
F4_O1:
    s_cmp_lg_u32 s47, 2
    s_cbranch_scc1 F4_O2
    s_waitcnt lgkmcnt(6)
    v_pk_add_f32 v[70:71], v[36:37], v[92:93]
    v_pk_add_f32 v[72:73], v[38:39], v[94:95]
    v_pk_add_f32 v[74:75], v[40:41], v[96:97]
    v_pk_add_f32 v[76:77], v[42:43], v[98:99]
    v_pk_add_f32 v[78:79], v[44:45], v[100:101]
F4_O2:
    s_cmp_lg_u32 s47, 3
    s_cbranch_scc1 F4_O3
    s_waitcnt lgkmcnt(6)
    v_pk_add_f32 v[70:71], v[48:49], v[92:93]
    v_pk_add_f32 v[72:73], v[50:51], v[94:95]
    v_pk_add_f32 v[74:75], v[52:53], v[96:97]
    v_pk_add_f32 v[76:77], v[54:55], v[98:99]
    v_pk_add_f32 v[78:79], v[46:47], v[100:101]
F4_O3:
    s_waitcnt lgkmcnt(0)
    v_pk_add_f32 v[80:81], v[80:81], v[102:103]
    v_pk_add_f32 v[82:83], v[82:83], v[104:105]
    v_pk_add_f32 v[84:85], v[84:85], v[106:107]
    v_pk_add_f32 v[86:87], v[86:87], v[108:109]
    v_pk_add_f32 v[88:89], v[88:89], v[110:111]
    v_pk_add_f32 v[70:71], v[70:71], v[80:81]
    v_pk_add_f32 v[72:73], v[72:73], v[82:83]
    v_pk_add_f32 v[74:75], v[74:75], v[84:85]
    v_pk_add_f32 v[76:77], v[76:77], v[86:87]
    v_pk_add_f32 v[78:79], v[78:79], v[88:89]
    v_cvt_pk_bf16_f32 v70, 0, v70
    v_cvt_pk_bf16_f32 v71, 0, v71
    v_lshlrev_b32 v80, 16, v64
    v_and_b32 v81, 0xffff0000, v64
    v_cvt_pk_bf16_f32 v72, 0, v72
    v_cvt_pk_bf16_f32 v73, 0, v73
    v_lshlrev_b32 v82, 16, v65
    v_and_b32 v83, 0xffff0000, v65
    v_cvt_pk_bf16_f32 v74, 0, v74
    v_cvt_pk_bf16_f32 v75, 0, v75
    v_lshlrev_b32 v84, 16, v66
    v_and_b32 v85, 0xffff0000, v66
    v_cvt_pk_bf16_f32 v76, 0, v76
    v_cvt_pk_bf16_f32 v77, 0, v77
    v_lshlrev_b32 v86, 16, v67
    v_and_b32 v87, 0xffff0000, v67
    v_cvt_pk_bf16_f32 v78, 0, v78
    v_cvt_pk_bf16_f32 v79, 0, v79
    v_lshlrev_b32 v88, 16, v68
    v_and_b32 v89, 0xffff0000, v68
    v_pk_add_f32 v[70:71], v[70:71], v[80:81]
    v_pk_add_f32 v[72:73], v[72:73], v[82:83]
    v_pk_add_f32 v[74:75], v[74:75], v[84:85]
    v_pk_add_f32 v[76:77], v[76:77], v[86:87]
    v_pk_add_f32 v[78:79], v[78:79], v[88:89]
    v_cvt_pk_bf16_f32 v92, v70, v71
    v_cvt_pk_bf16_f32 v93, v72, v73
    v_cvt_pk_bf16_f32 v94, v74, v75
    v_cvt_pk_bf16_f32 v95, v76, v77
    v_cvt_pk_bf16_f32 v96, v78, v79
    buffer_store_dwordx2 v[92:93], v3, s[32:35], 0 offen
    buffer_store_dwordx2 v[94:95], v3, s[32:35], 0 offen offset:32
    buffer_store_dword v96, v13, s[32:35], 0 offen
    s_endpgm
F3_LS:
F3_LK:
    s_lshl_b32 s50, s14, 1
    s_add_u32 s50, s50, s3
    s_lshl_b32 s50, s50, 10
    s_and_b32 s51, s15, 1
    s_lshl_b32 s51, s51, 9
    s_add_u32 s50, s50, s51
    s_mov_b32 s48, 0
    s_lshl_b32 s51, s48, 3
    s_add_u32 s50, s50, s51
    s_add_u32 s50, s50, 229376
    s_lshl_b32 s48, s48, 13
    s_add_u32 s48, s48, s35
    s_add_u32 s53, s35, 221184
    s_mov_b32 s49, s37
    s_mov_b32 s60, s16
    s_mov_b32 s61, s17
    s_mov_b32 s62, s18
    s_mov_b32 s63, s19
    v_mov_b32 v12, 163720
    v_mov_b32 v13, 1
    s_mov_b32 s51, 0
    s_buffer_load_dwordx16 s[4:19], s[44:47], s50 offset:0 glc
    s_buffer_load_dwordx16 s[20:35], s[44:47], s50 offset:64 glc
    s_buffer_load_dwordx16 s[64:79], s[44:47], s50 offset:128 glc
    s_buffer_load_dwordx8 s[36:43], s[44:47], s50 offset:192 glc
    s_waitcnt lgkmcnt(0)
    s_cmp_eq_u64 s[4:5], s[100:101]
    s_cbranch_scc1 F5_N0
F5_M0:
    s_buffer_load_dwordx16 s[4:19], s[44:47], s50 offset:0 glc
    s_buffer_load_dwordx16 s[20:35], s[44:47], s50 offset:64 glc
    s_buffer_load_dwordx16 s[64:79], s[44:47], s50 offset:128 glc
    s_buffer_load_dwordx8 s[36:43], s[44:47], s50 offset:192 glc
    s_add_u32 s51, s51, 1
    s_cmp_ge_u32 s51, 100000
    s_waitcnt lgkmcnt(0)
    s_cbranch_scc1 F5_N0
    s_cmp_eq_u64 s[4:5], s[100:101]
    s_cbranch_scc1 F5_N0
    s_sleep 1
    s_branch F5_M0
F5_N0:
    s_add_u32 m0, s49, 40960
    s_add_u32 s52, s48, 8192
    buffer_load_dwordx4 v2, s[60:63], s48 offen offset:0 sc1 lds
    buffer_load_dwordx4 v2, s[60:63], s48 offen offset:1024 sc1 lds
    buffer_load_dwordx4 v2, s[60:63], s48 offen offset:2048 sc1 lds
    buffer_load_dwordx4 v2, s[60:63], s48 offen offset:3072 sc1 lds
    s_cmp_ge_u32 s52, s53
    s_cselect_b32 s48, 221184, 0
    s_sub_u32 s48, s52, s48
    s_cmp_eq_u64 s[6:7], s[100:101]
    s_cbranch_scc1 F5_N1
F5_M1:
    s_buffer_load_dwordx16 s[4:19], s[44:47], s50 offset:0 glc
    s_buffer_load_dwordx16 s[20:35], s[44:47], s50 offset:64 glc
    s_buffer_load_dwordx16 s[64:79], s[44:47], s50 offset:128 glc
    s_buffer_load_dwordx8 s[36:43], s[44:47], s50 offset:192 glc
    s_add_u32 s51, s51, 1
    s_cmp_ge_u32 s51, 100000
    s_waitcnt lgkmcnt(0)
    s_cbranch_scc1 F5_N1
    s_cmp_eq_u64 s[6:7], s[100:101]
    s_cbranch_scc1 F5_N1
    s_sleep 1
    s_branch F5_M1
F5_N1:
    s_add_u32 m0, s49, 49152
    s_add_u32 s52, s48, 8192
    buffer_load_dwordx4 v2, s[60:63], s48 offen offset:0 sc1 lds
    buffer_load_dwordx4 v2, s[60:63], s48 offen offset:1024 sc1 lds
    buffer_load_dwordx4 v2, s[60:63], s48 offen offset:2048 sc1 lds
    buffer_load_dwordx4 v2, s[60:63], s48 offen offset:3072 sc1 lds
    s_cmp_ge_u32 s52, s53
    s_cselect_b32 s48, 221184, 0
    s_sub_u32 s48, s52, s48
    s_cmp_eq_u64 s[8:9], s[100:101]
    s_cbranch_scc1 F5_N2
F5_M2:
    s_buffer_load_dwordx16 s[4:19], s[44:47], s50 offset:0 glc
    s_buffer_load_dwordx16 s[20:35], s[44:47], s50 offset:64 glc
    s_buffer_load_dwordx16 s[64:79], s[44:47], s50 offset:128 glc
    s_buffer_load_dwordx8 s[36:43], s[44:47], s50 offset:192 glc
    s_add_u32 s51, s51, 1
    s_cmp_ge_u32 s51, 100000
    s_waitcnt lgkmcnt(0)
    s_cbranch_scc1 F5_N2
    s_cmp_eq_u64 s[8:9], s[100:101]
    s_cbranch_scc1 F5_N2
    s_sleep 1
    s_branch F5_M2
F5_N2:
    s_add_u32 m0, s49, 57344
    s_add_u32 s52, s48, 8192
    buffer_load_dwordx4 v2, s[60:63], s48 offen offset:0 sc1 lds
    buffer_load_dwordx4 v2, s[60:63], s48 offen offset:1024 sc1 lds
    buffer_load_dwordx4 v2, s[60:63], s48 offen offset:2048 sc1 lds
    buffer_load_dwordx4 v2, s[60:63], s48 offen offset:3072 sc1 lds
    s_cmp_ge_u32 s52, s53
    s_cselect_b32 s48, 221184, 0
    s_sub_u32 s48, s52, s48
    s_cmp_eq_u64 s[10:11], s[100:101]
    s_cbranch_scc1 F5_N3
F5_M3:
    s_buffer_load_dwordx16 s[4:19], s[44:47], s50 offset:0 glc
    s_buffer_load_dwordx16 s[20:35], s[44:47], s50 offset:64 glc
    s_buffer_load_dwordx16 s[64:79], s[44:47], s50 offset:128 glc
    s_buffer_load_dwordx8 s[36:43], s[44:47], s50 offset:192 glc
    s_add_u32 s51, s51, 1
    s_cmp_ge_u32 s51, 100000
    s_waitcnt lgkmcnt(0)
    s_cbranch_scc1 F5_N3
    s_cmp_eq_u64 s[10:11], s[100:101]
    s_cbranch_scc1 F5_N3
    s_sleep 1
    s_branch F5_M3
F5_N3:
    s_add_u32 m0, s49, 65536
    s_add_u32 s52, s48, 8192
    buffer_load_dwordx4 v2, s[60:63], s48 offen offset:0 sc1 lds
    buffer_load_dwordx4 v2, s[60:63], s48 offen offset:1024 sc1 lds
    buffer_load_dwordx4 v2, s[60:63], s48 offen offset:2048 sc1 lds
    buffer_load_dwordx4 v2, s[60:63], s48 offen offset:3072 sc1 lds
    s_cmp_ge_u32 s52, s53
    s_cselect_b32 s48, 221184, 0
    s_sub_u32 s48, s52, s48
    ds_write_b32 v12, v13
    s_waitcnt vmcnt(12)
    s_barrier
    s_cmp_eq_u64 s[12:13], s[100:101]
    s_cbranch_scc1 F5_N4
F5_M4:
    s_buffer_load_dwordx16 s[4:19], s[44:47], s50 offset:0 glc
    s_buffer_load_dwordx16 s[20:35], s[44:47], s50 offset:64 glc
    s_buffer_load_dwordx16 s[64:79], s[44:47], s50 offset:128 glc
    s_buffer_load_dwordx8 s[36:43], s[44:47], s50 offset:192 glc
    s_add_u32 s51, s51, 1
    s_cmp_ge_u32 s51, 100000
    s_waitcnt lgkmcnt(0)
    s_cbranch_scc1 F5_N4
    s_cmp_eq_u64 s[12:13], s[100:101]
    s_cbranch_scc1 F5_N4
    s_sleep 1
    s_branch F5_M4
F5_N4:
    s_add_u32 m0, s49, 73728
    s_add_u32 s52, s48, 8192
    buffer_load_dwordx4 v2, s[60:63], s48 offen offset:0 sc1 lds
    buffer_load_dwordx4 v2, s[60:63], s48 offen offset:1024 sc1 lds
    buffer_load_dwordx4 v2, s[60:63], s48 offen offset:2048 sc1 lds
    buffer_load_dwordx4 v2, s[60:63], s48 offen offset:3072 sc1 lds
    s_cmp_ge_u32 s52, s53
    s_cselect_b32 s48, 221184, 0
    s_sub_u32 s48, s52, s48
    s_cmp_eq_u64 s[14:15], s[100:101]
    s_cbranch_scc1 F5_N5
F5_M5:
    s_buffer_load_dwordx16 s[4:19], s[44:47], s50 offset:0 glc
    s_buffer_load_dwordx16 s[20:35], s[44:47], s50 offset:64 glc
    s_buffer_load_dwordx16 s[64:79], s[44:47], s50 offset:128 glc
    s_buffer_load_dwordx8 s[36:43], s[44:47], s50 offset:192 glc
    s_add_u32 s51, s51, 1
    s_cmp_ge_u32 s51, 100000
    s_waitcnt lgkmcnt(0)
    s_cbranch_scc1 F5_N5
    s_cmp_eq_u64 s[14:15], s[100:101]
    s_cbranch_scc1 F5_N5
    s_sleep 1
    s_branch F5_M5
F5_N5:
    s_add_u32 m0, s49, 81920
    s_add_u32 s52, s48, 8192
    buffer_load_dwordx4 v2, s[60:63], s48 offen offset:0 sc1 lds
    buffer_load_dwordx4 v2, s[60:63], s48 offen offset:1024 sc1 lds
    buffer_load_dwordx4 v2, s[60:63], s48 offen offset:2048 sc1 lds
    buffer_load_dwordx4 v2, s[60:63], s48 offen offset:3072 sc1 lds
    s_cmp_ge_u32 s52, s53
    s_cselect_b32 s48, 221184, 0
    s_sub_u32 s48, s52, s48
    s_waitcnt vmcnt(16)
    s_barrier
    s_cmp_eq_u64 s[16:17], s[100:101]
    s_cbranch_scc1 F5_N6
F5_M6:
    s_buffer_load_dwordx16 s[4:19], s[44:47], s50 offset:0 glc
    s_buffer_load_dwordx16 s[20:35], s[44:47], s50 offset:64 glc
    s_buffer_load_dwordx16 s[64:79], s[44:47], s50 offset:128 glc
    s_buffer_load_dwordx8 s[36:43], s[44:47], s50 offset:192 glc
    s_add_u32 s51, s51, 1
    s_cmp_ge_u32 s51, 100000
    s_waitcnt lgkmcnt(0)
    s_cbranch_scc1 F5_N6
    s_cmp_eq_u64 s[16:17], s[100:101]
    s_cbranch_scc1 F5_N6
    s_sleep 1
    s_branch F5_M6
F5_N6:
    s_add_u32 m0, s49, 90112
    s_add_u32 s52, s48, 8192
    buffer_load_dwordx4 v2, s[60:63], s48 offen offset:0 sc1 lds
    buffer_load_dwordx4 v2, s[60:63], s48 offen offset:1024 sc1 lds
    buffer_load_dwordx4 v2, s[60:63], s48 offen offset:2048 sc1 lds
    buffer_load_dwordx4 v2, s[60:63], s48 offen offset:3072 sc1 lds
    s_cmp_ge_u32 s52, s53
    s_cselect_b32 s48, 221184, 0
    s_sub_u32 s48, s52, s48
    s_waitcnt vmcnt(16)
    s_barrier
    s_cmp_eq_u64 s[18:19], s[100:101]
    s_cbranch_scc1 F5_N7
F5_M7:
    s_buffer_load_dwordx16 s[4:19], s[44:47], s50 offset:0 glc
    s_buffer_load_dwordx16 s[20:35], s[44:47], s50 offset:64 glc
    s_buffer_load_dwordx16 s[64:79], s[44:47], s50 offset:128 glc
    s_buffer_load_dwordx8 s[36:43], s[44:47], s50 offset:192 glc
    s_add_u32 s51, s51, 1
    s_cmp_ge_u32 s51, 100000
    s_waitcnt lgkmcnt(0)
    s_cbranch_scc1 F5_N7
    s_cmp_eq_u64 s[18:19], s[100:101]
    s_cbranch_scc1 F5_N7
    s_sleep 1
    s_branch F5_M7
F5_N7:
    s_add_u32 m0, s49, 40960
    s_add_u32 s52, s48, 8192
    buffer_load_dwordx4 v2, s[60:63], s48 offen offset:0 sc1 lds
    buffer_load_dwordx4 v2, s[60:63], s48 offen offset:1024 sc1 lds
    buffer_load_dwordx4 v2, s[60:63], s48 offen offset:2048 sc1 lds
    buffer_load_dwordx4 v2, s[60:63], s48 offen offset:3072 sc1 lds
    s_cmp_ge_u32 s52, s53
    s_cselect_b32 s48, 221184, 0
    s_sub_u32 s48, s52, s48
    s_waitcnt vmcnt(16)
    s_barrier
    s_cmp_eq_u64 s[20:21], s[100:101]
    s_cbranch_scc1 F5_N8
F5_M8:
    s_buffer_load_dwordx16 s[20:35], s[44:47], s50 offset:64 glc
    s_buffer_load_dwordx16 s[64:79], s[44:47], s50 offset:128 glc
    s_buffer_load_dwordx8 s[36:43], s[44:47], s50 offset:192 glc
    s_add_u32 s51, s51, 1
    s_cmp_ge_u32 s51, 100000
    s_waitcnt lgkmcnt(0)
    s_cbranch_scc1 F5_N8
    s_cmp_eq_u64 s[20:21], s[100:101]
    s_cbranch_scc1 F5_N8
    s_sleep 1
    s_branch F5_M8
F5_N8:
    s_add_u32 m0, s49, 49152
    s_add_u32 s52, s48, 8192
    buffer_load_dwordx4 v2, s[60:63], s48 offen offset:0 sc1 lds
    buffer_load_dwordx4 v2, s[60:63], s48 offen offset:1024 sc1 lds
    buffer_load_dwordx4 v2, s[60:63], s48 offen offset:2048 sc1 lds
    buffer_load_dwordx4 v2, s[60:63], s48 offen offset:3072 sc1 lds
    s_cmp_ge_u32 s52, s53
    s_cselect_b32 s48, 221184, 0
    s_sub_u32 s48, s52, s48
    s_waitcnt vmcnt(16)
    s_barrier
    s_cmp_eq_u64 s[22:23], s[100:101]
    s_cbranch_scc1 F5_N9
F5_M9:
    s_buffer_load_dwordx16 s[20:35], s[44:47], s50 offset:64 glc
    s_buffer_load_dwordx16 s[64:79], s[44:47], s50 offset:128 glc
    s_buffer_load_dwordx8 s[36:43], s[44:47], s50 offset:192 glc
    s_add_u32 s51, s51, 1
    s_cmp_ge_u32 s51, 100000
    s_waitcnt lgkmcnt(0)
    s_cbranch_scc1 F5_N9
    s_cmp_eq_u64 s[22:23], s[100:101]
    s_cbranch_scc1 F5_N9
    s_sleep 1
    s_branch F5_M9
F5_N9:
    s_add_u32 m0, s49, 57344
    s_add_u32 s52, s48, 8192
    buffer_load_dwordx4 v2, s[60:63], s48 offen offset:0 sc1 lds
    buffer_load_dwordx4 v2, s[60:63], s48 offen offset:1024 sc1 lds
    buffer_load_dwordx4 v2, s[60:63], s48 offen offset:2048 sc1 lds
    buffer_load_dwordx4 v2, s[60:63], s48 offen offset:3072 sc1 lds
    s_cmp_ge_u32 s52, s53
    s_cselect_b32 s48, 221184, 0
    s_sub_u32 s48, s52, s48
    s_waitcnt vmcnt(16)
    s_barrier
    s_cmp_eq_u64 s[24:25], s[100:101]
    s_cbranch_scc1 F5_N10
F5_M10:
    s_buffer_load_dwordx16 s[20:35], s[44:47], s50 offset:64 glc
    s_buffer_load_dwordx16 s[64:79], s[44:47], s50 offset:128 glc
    s_buffer_load_dwordx8 s[36:43], s[44:47], s50 offset:192 glc
    s_add_u32 s51, s51, 1
    s_cmp_ge_u32 s51, 100000
    s_waitcnt lgkmcnt(0)
    s_cbranch_scc1 F5_N10
    s_cmp_eq_u64 s[24:25], s[100:101]
    s_cbranch_scc1 F5_N10
    s_sleep 1
    s_branch F5_M10
F5_N10:
    s_add_u32 m0, s49, 65536
    s_add_u32 s52, s48, 8192
    buffer_load_dwordx4 v2, s[60:63], s48 offen offset:0 sc1 lds
    buffer_load_dwordx4 v2, s[60:63], s48 offen offset:1024 sc1 lds
    buffer_load_dwordx4 v2, s[60:63], s48 offen offset:2048 sc1 lds
    buffer_load_dwordx4 v2, s[60:63], s48 offen offset:3072 sc1 lds
    s_cmp_ge_u32 s52, s53
    s_cselect_b32 s48, 221184, 0
    s_sub_u32 s48, s52, s48
    s_waitcnt vmcnt(16)
    s_barrier
    s_cmp_eq_u64 s[26:27], s[100:101]
    s_cbranch_scc1 F5_N11
F5_M11:
    s_buffer_load_dwordx16 s[20:35], s[44:47], s50 offset:64 glc
    s_buffer_load_dwordx16 s[64:79], s[44:47], s50 offset:128 glc
    s_buffer_load_dwordx8 s[36:43], s[44:47], s50 offset:192 glc
    s_add_u32 s51, s51, 1
    s_cmp_ge_u32 s51, 100000
    s_waitcnt lgkmcnt(0)
    s_cbranch_scc1 F5_N11
    s_cmp_eq_u64 s[26:27], s[100:101]
    s_cbranch_scc1 F5_N11
    s_sleep 1
    s_branch F5_M11
F5_N11:
    s_add_u32 m0, s49, 73728
    s_add_u32 s52, s48, 8192
    buffer_load_dwordx4 v2, s[60:63], s48 offen offset:0 sc1 lds
    buffer_load_dwordx4 v2, s[60:63], s48 offen offset:1024 sc1 lds
    buffer_load_dwordx4 v2, s[60:63], s48 offen offset:2048 sc1 lds
    buffer_load_dwordx4 v2, s[60:63], s48 offen offset:3072 sc1 lds
    s_cmp_ge_u32 s52, s53
    s_cselect_b32 s48, 221184, 0
    s_sub_u32 s48, s52, s48
    s_waitcnt vmcnt(16)
    s_barrier
    s_cmp_eq_u64 s[28:29], s[100:101]
    s_cbranch_scc1 F5_N12
F5_M12:
    s_buffer_load_dwordx16 s[20:35], s[44:47], s50 offset:64 glc
    s_buffer_load_dwordx16 s[64:79], s[44:47], s50 offset:128 glc
    s_buffer_load_dwordx8 s[36:43], s[44:47], s50 offset:192 glc
    s_add_u32 s51, s51, 1
    s_cmp_ge_u32 s51, 100000
    s_waitcnt lgkmcnt(0)
    s_cbranch_scc1 F5_N12
    s_cmp_eq_u64 s[28:29], s[100:101]
    s_cbranch_scc1 F5_N12
    s_sleep 1
    s_branch F5_M12
F5_N12:
    s_add_u32 m0, s49, 81920
    s_add_u32 s52, s48, 8192
    buffer_load_dwordx4 v2, s[60:63], s48 offen offset:0 sc1 lds
    buffer_load_dwordx4 v2, s[60:63], s48 offen offset:1024 sc1 lds
    buffer_load_dwordx4 v2, s[60:63], s48 offen offset:2048 sc1 lds
    buffer_load_dwordx4 v2, s[60:63], s48 offen offset:3072 sc1 lds
    s_cmp_ge_u32 s52, s53
    s_cselect_b32 s48, 221184, 0
    s_sub_u32 s48, s52, s48
    s_waitcnt vmcnt(16)
    s_barrier
    s_cmp_eq_u64 s[30:31], s[100:101]
    s_cbranch_scc1 F5_N13
F5_M13:
    s_buffer_load_dwordx16 s[20:35], s[44:47], s50 offset:64 glc
    s_buffer_load_dwordx16 s[64:79], s[44:47], s50 offset:128 glc
    s_buffer_load_dwordx8 s[36:43], s[44:47], s50 offset:192 glc
    s_add_u32 s51, s51, 1
    s_cmp_ge_u32 s51, 100000
    s_waitcnt lgkmcnt(0)
    s_cbranch_scc1 F5_N13
    s_cmp_eq_u64 s[30:31], s[100:101]
    s_cbranch_scc1 F5_N13
    s_sleep 1
    s_branch F5_M13
F5_N13:
    s_add_u32 m0, s49, 90112
    s_add_u32 s52, s48, 8192
    buffer_load_dwordx4 v2, s[60:63], s48 offen offset:0 sc1 lds
    buffer_load_dwordx4 v2, s[60:63], s48 offen offset:1024 sc1 lds
    buffer_load_dwordx4 v2, s[60:63], s48 offen offset:2048 sc1 lds
    buffer_load_dwordx4 v2, s[60:63], s48 offen offset:3072 sc1 lds
    s_cmp_ge_u32 s52, s53
    s_cselect_b32 s48, 221184, 0
    s_sub_u32 s48, s52, s48
    s_waitcnt vmcnt(16)
    s_barrier
    s_cmp_eq_u64 s[32:33], s[100:101]
    s_cbranch_scc1 F5_N14
F5_M14:
    s_buffer_load_dwordx16 s[20:35], s[44:47], s50 offset:64 glc
    s_buffer_load_dwordx16 s[64:79], s[44:47], s50 offset:128 glc
    s_buffer_load_dwordx8 s[36:43], s[44:47], s50 offset:192 glc
    s_add_u32 s51, s51, 1
    s_cmp_ge_u32 s51, 100000
    s_waitcnt lgkmcnt(0)
    s_cbranch_scc1 F5_N14
    s_cmp_eq_u64 s[32:33], s[100:101]
    s_cbranch_scc1 F5_N14
    s_sleep 1
    s_branch F5_M14
F5_N14:
    s_add_u32 m0, s49, 40960
    s_add_u32 s52, s48, 8192
    buffer_load_dwordx4 v2, s[60:63], s48 offen offset:0 sc1 lds
    buffer_load_dwordx4 v2, s[60:63], s48 offen offset:1024 sc1 lds
    buffer_load_dwordx4 v2, s[60:63], s48 offen offset:2048 sc1 lds
    buffer_load_dwordx4 v2, s[60:63], s48 offen offset:3072 sc1 lds
    s_cmp_ge_u32 s52, s53
    s_cselect_b32 s48, 221184, 0
    s_sub_u32 s48, s52, s48
    s_waitcnt vmcnt(16)
    s_barrier
    s_cmp_eq_u64 s[34:35], s[100:101]
    s_cbranch_scc1 F5_N15
F5_M15:
    s_buffer_load_dwordx16 s[20:35], s[44:47], s50 offset:64 glc
    s_buffer_load_dwordx16 s[64:79], s[44:47], s50 offset:128 glc
    s_buffer_load_dwordx8 s[36:43], s[44:47], s50 offset:192 glc
    s_add_u32 s51, s51, 1
    s_cmp_ge_u32 s51, 100000
    s_waitcnt lgkmcnt(0)
    s_cbranch_scc1 F5_N15
    s_cmp_eq_u64 s[34:35], s[100:101]
    s_cbranch_scc1 F5_N15
    s_sleep 1
    s_branch F5_M15
F5_N15:
    s_add_u32 m0, s49, 49152
    s_add_u32 s52, s48, 8192
    buffer_load_dwordx4 v2, s[60:63], s48 offen offset:0 sc1 lds
    buffer_load_dwordx4 v2, s[60:63], s48 offen offset:1024 sc1 lds
    buffer_load_dwordx4 v2, s[60:63], s48 offen offset:2048 sc1 lds
    buffer_load_dwordx4 v2, s[60:63], s48 offen offset:3072 sc1 lds
    s_cmp_ge_u32 s52, s53
    s_cselect_b32 s48, 221184, 0
    s_sub_u32 s48, s52, s48
    s_waitcnt vmcnt(16)
    s_barrier
    s_cmp_eq_u64 s[64:65], s[100:101]
    s_cbranch_scc1 F5_N16
F5_M16:
    s_buffer_load_dwordx16 s[64:79], s[44:47], s50 offset:128 glc
    s_buffer_load_dwordx8 s[36:43], s[44:47], s50 offset:192 glc
    s_add_u32 s51, s51, 1
    s_cmp_ge_u32 s51, 100000
    s_waitcnt lgkmcnt(0)
    s_cbranch_scc1 F5_N16
    s_cmp_eq_u64 s[64:65], s[100:101]
    s_cbranch_scc1 F5_N16
    s_sleep 1
    s_branch F5_M16
F5_N16:
    s_add_u32 m0, s49, 57344
    s_add_u32 s52, s48, 8192
    buffer_load_dwordx4 v2, s[60:63], s48 offen offset:0 sc1 lds
    buffer_load_dwordx4 v2, s[60:63], s48 offen offset:1024 sc1 lds
    buffer_load_dwordx4 v2, s[60:63], s48 offen offset:2048 sc1 lds
    buffer_load_dwordx4 v2, s[60:63], s48 offen offset:3072 sc1 lds
    s_cmp_ge_u32 s52, s53
    s_cselect_b32 s48, 221184, 0
    s_sub_u32 s48, s52, s48
    s_waitcnt vmcnt(16)
    s_barrier
    s_cmp_eq_u64 s[66:67], s[100:101]
    s_cbranch_scc1 F5_N17
F5_M17:
    s_buffer_load_dwordx16 s[64:79], s[44:47], s50 offset:128 glc
    s_buffer_load_dwordx8 s[36:43], s[44:47], s50 offset:192 glc
    s_add_u32 s51, s51, 1
    s_cmp_ge_u32 s51, 100000
    s_waitcnt lgkmcnt(0)
    s_cbranch_scc1 F5_N17
    s_cmp_eq_u64 s[66:67], s[100:101]
    s_cbranch_scc1 F5_N17
    s_sleep 1
    s_branch F5_M17
F5_N17:
    s_add_u32 m0, s49, 65536
    s_add_u32 s52, s48, 8192
    buffer_load_dwordx4 v2, s[60:63], s48 offen offset:0 sc1 lds
    buffer_load_dwordx4 v2, s[60:63], s48 offen offset:1024 sc1 lds
    buffer_load_dwordx4 v2, s[60:63], s48 offen offset:2048 sc1 lds
    buffer_load_dwordx4 v2, s[60:63], s48 offen offset:3072 sc1 lds
    s_cmp_ge_u32 s52, s53
    s_cselect_b32 s48, 221184, 0
    s_sub_u32 s48, s52, s48
    s_waitcnt vmcnt(16)
    s_barrier
    s_cmp_eq_u64 s[68:69], s[100:101]
    s_cbranch_scc1 F5_N18
F5_M18:
    s_buffer_load_dwordx16 s[64:79], s[44:47], s50 offset:128 glc
    s_buffer_load_dwordx8 s[36:43], s[44:47], s50 offset:192 glc
    s_add_u32 s51, s51, 1
    s_cmp_ge_u32 s51, 100000
    s_waitcnt lgkmcnt(0)
    s_cbranch_scc1 F5_N18
    s_cmp_eq_u64 s[68:69], s[100:101]
    s_cbranch_scc1 F5_N18
    s_sleep 1
    s_branch F5_M18
F5_N18:
    s_add_u32 m0, s49, 73728
    s_add_u32 s52, s48, 8192
    buffer_load_dwordx4 v2, s[60:63], s48 offen offset:0 sc1 lds
    buffer_load_dwordx4 v2, s[60:63], s48 offen offset:1024 sc1 lds
    buffer_load_dwordx4 v2, s[60:63], s48 offen offset:2048 sc1 lds
    buffer_load_dwordx4 v2, s[60:63], s48 offen offset:3072 sc1 lds
    s_cmp_ge_u32 s52, s53
    s_cselect_b32 s48, 221184, 0
    s_sub_u32 s48, s52, s48
    s_waitcnt vmcnt(16)
    s_barrier
    s_cmp_eq_u64 s[70:71], s[100:101]
    s_cbranch_scc1 F5_N19
F5_M19:
    s_buffer_load_dwordx16 s[64:79], s[44:47], s50 offset:128 glc
    s_buffer_load_dwordx8 s[36:43], s[44:47], s50 offset:192 glc
    s_add_u32 s51, s51, 1
    s_cmp_ge_u32 s51, 100000
    s_waitcnt lgkmcnt(0)
    s_cbranch_scc1 F5_N19
    s_cmp_eq_u64 s[70:71], s[100:101]
    s_cbranch_scc1 F5_N19
    s_sleep 1
    s_branch F5_M19
F5_N19:
    s_add_u32 m0, s49, 81920
    s_add_u32 s52, s48, 8192
    buffer_load_dwordx4 v2, s[60:63], s48 offen offset:0 sc1 lds
    buffer_load_dwordx4 v2, s[60:63], s48 offen offset:1024 sc1 lds
    buffer_load_dwordx4 v2, s[60:63], s48 offen offset:2048 sc1 lds
    buffer_load_dwordx4 v2, s[60:63], s48 offen offset:3072 sc1 lds
    s_cmp_ge_u32 s52, s53
    s_cselect_b32 s48, 221184, 0
    s_sub_u32 s48, s52, s48
    s_waitcnt vmcnt(16)
    s_barrier
    s_cmp_eq_u64 s[72:73], s[100:101]
    s_cbranch_scc1 F5_N20
F5_M20:
    s_buffer_load_dwordx16 s[64:79], s[44:47], s50 offset:128 glc
    s_buffer_load_dwordx8 s[36:43], s[44:47], s50 offset:192 glc
    s_add_u32 s51, s51, 1
    s_cmp_ge_u32 s51, 100000
    s_waitcnt lgkmcnt(0)
    s_cbranch_scc1 F5_N20
    s_cmp_eq_u64 s[72:73], s[100:101]
    s_cbranch_scc1 F5_N20
    s_sleep 1
    s_branch F5_M20
F5_N20:
    s_add_u32 m0, s49, 90112
    s_add_u32 s52, s48, 8192
    buffer_load_dwordx4 v2, s[60:63], s48 offen offset:0 sc1 lds
    buffer_load_dwordx4 v2, s[60:63], s48 offen offset:1024 sc1 lds
    buffer_load_dwordx4 v2, s[60:63], s48 offen offset:2048 sc1 lds
    buffer_load_dwordx4 v2, s[60:63], s48 offen offset:3072 sc1 lds
    s_cmp_ge_u32 s52, s53
    s_cselect_b32 s48, 221184, 0
    s_sub_u32 s48, s52, s48
    s_waitcnt vmcnt(16)
    s_barrier
    s_cmp_eq_u64 s[74:75], s[100:101]
    s_cbranch_scc1 F5_N21
F5_M21:
    s_buffer_load_dwordx16 s[64:79], s[44:47], s50 offset:128 glc
    s_buffer_load_dwordx8 s[36:43], s[44:47], s50 offset:192 glc
    s_add_u32 s51, s51, 1
    s_cmp_ge_u32 s51, 100000
    s_waitcnt lgkmcnt(0)
    s_cbranch_scc1 F5_N21
    s_cmp_eq_u64 s[74:75], s[100:101]
    s_cbranch_scc1 F5_N21
    s_sleep 1
    s_branch F5_M21
F5_N21:
    s_add_u32 m0, s49, 40960
    s_add_u32 s52, s48, 8192
    buffer_load_dwordx4 v2, s[60:63], s48 offen offset:0 sc1 lds
    buffer_load_dwordx4 v2, s[60:63], s48 offen offset:1024 sc1 lds
    buffer_load_dwordx4 v2, s[60:63], s48 offen offset:2048 sc1 lds
    buffer_load_dwordx4 v2, s[60:63], s48 offen offset:3072 sc1 lds
    s_cmp_ge_u32 s52, s53
    s_cselect_b32 s48, 221184, 0
    s_sub_u32 s48, s52, s48
    s_waitcnt vmcnt(16)
    s_barrier
    s_cmp_eq_u64 s[76:77], s[100:101]
    s_cbranch_scc1 F5_N22
F5_M22:
    s_buffer_load_dwordx16 s[64:79], s[44:47], s50 offset:128 glc
    s_buffer_load_dwordx8 s[36:43], s[44:47], s50 offset:192 glc
    s_add_u32 s51, s51, 1
    s_cmp_ge_u32 s51, 100000
    s_waitcnt lgkmcnt(0)
    s_cbranch_scc1 F5_N22
    s_cmp_eq_u64 s[76:77], s[100:101]
    s_cbranch_scc1 F5_N22
    s_sleep 1
    s_branch F5_M22
F5_N22:
    s_add_u32 m0, s49, 49152
    s_add_u32 s52, s48, 8192
    buffer_load_dwordx4 v2, s[60:63], s48 offen offset:0 sc1 lds
    buffer_load_dwordx4 v2, s[60:63], s48 offen offset:1024 sc1 lds
    buffer_load_dwordx4 v2, s[60:63], s48 offen offset:2048 sc1 lds
    buffer_load_dwordx4 v2, s[60:63], s48 offen offset:3072 sc1 lds
    s_cmp_ge_u32 s52, s53
    s_cselect_b32 s48, 221184, 0
    s_sub_u32 s48, s52, s48
    s_waitcnt vmcnt(16)
    s_barrier
    s_cmp_eq_u64 s[78:79], s[100:101]
    s_cbranch_scc1 F5_N23
F5_M23:
    s_buffer_load_dwordx16 s[64:79], s[44:47], s50 offset:128 glc
    s_buffer_load_dwordx8 s[36:43], s[44:47], s50 offset:192 glc
    s_add_u32 s51, s51, 1
    s_cmp_ge_u32 s51, 100000
    s_waitcnt lgkmcnt(0)
    s_cbranch_scc1 F5_N23
    s_cmp_eq_u64 s[78:79], s[100:101]
    s_cbranch_scc1 F5_N23
    s_sleep 1
    s_branch F5_M23
F5_N23:
    s_add_u32 m0, s49, 57344
    s_add_u32 s52, s48, 8192
    buffer_load_dwordx4 v2, s[60:63], s48 offen offset:0 sc1 lds
    buffer_load_dwordx4 v2, s[60:63], s48 offen offset:1024 sc1 lds
    buffer_load_dwordx4 v2, s[60:63], s48 offen offset:2048 sc1 lds
    buffer_load_dwordx4 v2, s[60:63], s48 offen offset:3072 sc1 lds
    s_cmp_ge_u32 s52, s53
    s_cselect_b32 s48, 221184, 0
    s_sub_u32 s48, s52, s48
    s_waitcnt vmcnt(16)
    s_barrier
    s_cmp_eq_u64 s[36:37], s[100:101]
    s_cbranch_scc1 F5_N24
F5_M24:
    s_buffer_load_dwordx8 s[36:43], s[44:47], s50 offset:192 glc
    s_add_u32 s51, s51, 1
    s_cmp_ge_u32 s51, 100000
    s_waitcnt lgkmcnt(0)
    s_cbranch_scc1 F5_N24
    s_cmp_eq_u64 s[36:37], s[100:101]
    s_cbranch_scc1 F5_N24
    s_sleep 1
    s_branch F5_M24
F5_N24:
    s_add_u32 m0, s49, 65536
    s_add_u32 s52, s48, 8192
    buffer_load_dwordx4 v2, s[60:63], s48 offen offset:0 sc1 lds
    buffer_load_dwordx4 v2, s[60:63], s48 offen offset:1024 sc1 lds
    buffer_load_dwordx4 v2, s[60:63], s48 offen offset:2048 sc1 lds
    buffer_load_dwordx4 v2, s[60:63], s48 offen offset:3072 sc1 lds
    s_cmp_ge_u32 s52, s53
    s_cselect_b32 s48, 221184, 0
    s_sub_u32 s48, s52, s48
    s_waitcnt vmcnt(16)
    s_barrier
    s_cmp_eq_u64 s[38:39], s[100:101]
    s_cbranch_scc1 F5_N25
F5_M25:
    s_buffer_load_dwordx8 s[36:43], s[44:47], s50 offset:192 glc
    s_add_u32 s51, s51, 1
    s_cmp_ge_u32 s51, 100000
    s_waitcnt lgkmcnt(0)
    s_cbranch_scc1 F5_N25
    s_cmp_eq_u64 s[38:39], s[100:101]
    s_cbranch_scc1 F5_N25
    s_sleep 1
    s_branch F5_M25
F5_N25:
    s_add_u32 m0, s49, 73728
    s_add_u32 s52, s48, 8192
    buffer_load_dwordx4 v2, s[60:63], s48 offen offset:0 sc1 lds
    buffer_load_dwordx4 v2, s[60:63], s48 offen offset:1024 sc1 lds
    buffer_load_dwordx4 v2, s[60:63], s48 offen offset:2048 sc1 lds
    buffer_load_dwordx4 v2, s[60:63], s48 offen offset:3072 sc1 lds
    s_cmp_ge_u32 s52, s53
    s_cselect_b32 s48, 221184, 0
    s_sub_u32 s48, s52, s48
    s_waitcnt vmcnt(16)
    s_barrier
    s_cmp_eq_u64 s[40:41], s[100:101]
    s_cbranch_scc1 F5_N26
F5_M26:
    s_buffer_load_dwordx8 s[36:43], s[44:47], s50 offset:192 glc
    s_add_u32 s51, s51, 1
    s_cmp_ge_u32 s51, 100000
    s_waitcnt lgkmcnt(0)
    s_cbranch_scc1 F5_N26
    s_cmp_eq_u64 s[40:41], s[100:101]
    s_cbranch_scc1 F5_N26
    s_sleep 1
    s_branch F5_M26
F5_N26:
    s_add_u32 m0, s49, 81920
    s_add_u32 s52, s48, 8192
    buffer_load_dwordx4 v2, s[60:63], s48 offen offset:0 sc1 lds
    buffer_load_dwordx4 v2, s[60:63], s48 offen offset:1024 sc1 lds
    buffer_load_dwordx4 v2, s[60:63], s48 offen offset:2048 sc1 lds
    buffer_load_dwordx4 v2, s[60:63], s48 offen offset:3072 sc1 lds
    s_cmp_ge_u32 s52, s53
    s_cselect_b32 s48, 221184, 0
    s_sub_u32 s48, s52, s48
    s_waitcnt vmcnt(16)
    s_barrier
    s_waitcnt vmcnt(12)
    s_barrier
    s_waitcnt vmcnt(8)
    s_barrier
    s_waitcnt vmcnt(4)
    s_barrier
    s_waitcnt vmcnt(0)
    s_barrier
    s_endpgm
F3_H:
    s_and_b32 s14, s2, 7
    s_and_b32 s35, s14, 3
    s_lshl_b32 s35, s35, 1
    s_lshr_b32 s14, s14, 2
    s_add_u32 s14, s14, s35
    s_lshl_b32 s14, s14, 2
    s_lshr_b32 s15, s2, 3
    s_and_b32 s35, s15, 3
    s_add_u32 s14, s14, s35
    s_lshr_b32 s15, s15, 2
    v_lshlrev_b32 v2, 4, v1
    s_and_b32 s33, s3, 1
    s_mul_i32 s38, s33, 5120
    s_load_dwordx2 s[28:29], s[0:1], 0
    s_add_u32 s24, s12, 41943040
    s_addc_u32 s25, s13, 0
    s_mov_b32 s26, 2621440
    s_mov_b32 s27, 0x00020000
    s_add_u32 s44, s12, 50331648
    s_addc_u32 s45, s13, 0
    s_mov_b32 s46, 665600
    s_mov_b32 s47, 0x00020000
    s_add_u32 s16, s12, 0
    s_addc_u32 s17, s13, 0
    s_mov_b32 s18, 16384
    s_mov_b32 s19, 0x00020000
    s_lshl_b32 s4, s14, 3
    s_add_u32 s4, s4, s15
    s_mul_i32 s4, s4, 10240
    s_lshl_b32 s35, s33, 6
    s_add_u32 s4, s4, s35
    s_lshl_b32 s5, s14, 1
    s_add_u32 s5, s5, s33
    s_lshl_b32 s6, s5, 8
    s_lshl_b32 s7, s5, 3
    s_mul_i32 s5, s5, 40960
    s_mul_i32 s35, s15, 160
    s_add_u32 s5, s5, s35
    v_add_u32 v16, 0, v1
    v_mul_u32_u24 v17, 6554, v16
    v_lshrrev_b32 v17, 16, v17
    v_mul_u32_u24 v18, 10, v17
    v_sub_u32 v18, v16, v18
    v_mul_u32_u24 v17, 1280, v17
    v_lshl_add_u32 v24, v18, 4, v17
    v_add_u32 v16, 64, v1
    v_mul_u32_u24 v17, 6554, v16
    v_lshrrev_b32 v17, 16, v17
    v_mul_u32_u24 v18, 10, v17
    v_sub_u32 v18, v16, v18
    v_mul_u32_u24 v17, 1280, v17
    v_lshl_add_u32 v25, v18, 4, v17
    v_add_u32 v16, 128, v1
    v_mul_u32_u24 v17, 6554, v16
    v_lshrrev_b32 v17, 16, v17
    v_mul_u32_u24 v18, 10, v17
    v_sub_u32 v18, v16, v18
    v_mul_u32_u24 v17, 1280, v17
    v_lshl_add_u32 v26, v18, 4, v17
    v_add_u32 v16, 192, v1
    v_mul_u32_u24 v17, 6554, v16
    v_lshrrev_b32 v17, 16, v17
    v_mul_u32_u24 v18, 10, v17
    v_sub_u32 v18, v16, v18
    v_mul_u32_u24 v17, 1280, v17
    v_lshl_add_u32 v27, v18, 4, v17
    v_add_u32 v16, 256, v1
    v_mul_u32_u24 v17, 6554, v16
    v_lshrrev_b32 v17, 16, v17
    v_mul_u32_u24 v18, 10, v17
    v_sub_u32 v18, v16, v18
    v_mul_u32_u24 v17, 1280, v17
    v_lshl_add_u32 v28, v18, 4, v17
    v_lshrrev_b32 v16, 2, v1
    v_and_b32 v17, 3, v1
    v_lshlrev_b32 v3, 7, v16
    v_lshl_add_u32 v3, v17, 4, v3
    v_lshlrev_b32 v14, 2, v1
    s_lshr_b32 s35, s14, 4
    s_mul_i32 s35, s35, 640
    s_mul_i32 s36, s15, 80
    s_add_u32 s35, s35, s36
    v_add_u32 v16, s35, v1
    v_lshlrev_b32 v16, 4, v16
    v_add_u32 v16, 491520, v16
    v_add_u32 v17, 1024, v16
    v_min_u32 v18, 23, v1
    s_lshl_b32 s7, s7, 7
    s_sub_u32 s7, s7, 128
    v_lshl_add_u32 v18, v18, 3, s7
    v_cmp_gt_u32 vcc, 16, v1
    v_cndmask_b32 v17, v18, v17, vcc
    s_waitcnt lgkmcnt(0)
    s_mov_b32 s30, 2621440
    s_mov_b32 s31, 0x00020000
    s_cmp_eq_u32 s64, 1
    s_cselect_b32 s34, 21, 0
    s_cselect_b32 s32, 16, 0
    s_cselect_b32 s57, 4, 12
    v_mov_b32 v6, 163776
    s_cmp_lt_u32 s3, 12
    s_add_u32 s20, s12, 24117248
    s_addc_u32 s21, s13, 0
    s_mov_b32 s22, 2211840
    s_mov_b32 s23, 0x00020000
    s_mov_b32 s32, s34
    s_add_u32 s44, s12, 50331648
    s_addc_u32 s45, s13, 0
    s_mov_b32 s46, 665600
    s_mov_b32 s47, 0x00020000
    s_lshl_b32 s48, s15, 1
    s_add_u32 s48, s48, s33
    s_lshl_b32 s48, s48, 8
    s_mov_b32 s36, 0
    s_mul_i32 s36, s36, 10240
    s_mul_i32 s53, s15, 276480
    s_add_u32 s53, s53, s38
    s_add_u32 s36, s36, s53
    s_add_u32 s53, s53, 276480
    v_mov_b32 v11, 163724
    s_mov_b32 s41, 0
LC_NW:
    ds_read_b32 v10, v11 offset:0
    s_add_u32 s41, s41, 1
    s_waitcnt lgkmcnt(0)
    v_readfirstlane_b32 s42, v10
    s_cmp_ge_u32 s42, 1
    s_cbranch_scc1 LC_NW_D
    s_sleep 8
    s_cmp_lt_u32 s41, 1600000
    s_cbranch_scc1 LC_NW
LC_NW_D:
    ds_read_b32 v10, v11 offset:112
    s_mov_b32 s100, s42
    s_waitcnt lgkmcnt(0)
    v_readfirstlane_b32 s101, v10
LC_WB:
    s_cmp_ge_u32 s43, 12
    s_cbranch_scc1 LC_WN
    s_barrier
    s_add_u32 s43, s43, 1
    s_branch LC_WB
LC_WN:
    s_cmp_eq_u32 s64, 1
    s_cbranch_scc1 LC_W0_D
    s_mov_b32 s41, 0
LC_W0:
    ds_read_b32 v7, v6 offset:0
    s_add_u32 s41, s41, 1
    s_waitcnt lgkmcnt(0)
    v_readfirstlane_b32 s42, v7
    s_cmp_ge_u32 s42, s57
    s_cbranch_scc1 LC_W0_D
    s_sleep 2
    s_cmp_lt_u32 s41, 1600000
    s_cbranch_scc1 LC_W0
LC_W0_D:
    s_mov_b32 s41, 0
    s_branch F5_WP
F5_WF:
    s_add_u32 s41, s41, 1
    s_cmp_ge_u32 s41, 100000
    s_cbranch_scc1 F5_WD
    s_sleep 1
F5_WP:
    s_buffer_load_dwordx16 s[64:79], s[44:47], s48 offset:655360 glc
    s_buffer_load_dwordx4 s[80:83], s[44:47], s48 offset:655424 glc
    s_cmp_gt_u32 s43, s32
    s_cbranch_scc1 F5_WT0
    s_barrier
    s_add_u32 s43, s43, 1
F5_WT0:
    s_cmp_gt_u32 s43, s32
    s_cbranch_scc1 F5_WT1
    s_barrier
    s_add_u32 s43, s43, 1
F5_WT1:
    s_waitcnt lgkmcnt(0)
    s_cmp_eq_u64 s[64:65], s[100:101]
    s_cbranch_scc0 F5_WF
    s_cmp_eq_u64 s[66:67], s[100:101]
    s_cbranch_scc0 F5_WF
    s_cmp_eq_u64 s[68:69], s[100:101]
    s_cbranch_scc0 F5_WF
    s_cmp_eq_u64 s[70:71], s[100:101]
    s_cbranch_scc0 F5_WF
    s_cmp_eq_u64 s[72:73], s[100:101]
    s_cbranch_scc0 F5_WF
    s_cmp_eq_u64 s[74:75], s[100:101]
    s_cbranch_scc0 F5_WF
    s_cmp_eq_u64 s[76:77], s[100:101]
    s_cbranch_scc0 F5_WF
    s_cmp_eq_u64 s[78:79], s[100:101]
    s_cbranch_scc0 F5_WF
    s_cmp_eq_u64 s[80:81], s[100:101]
    s_cbranch_scc0 F5_WF
    s_cmp_eq_u64 s[82:83], s[100:101]
    s_cbranch_scc0 F5_WF
F5_WD:
    s_add_u32 m0, s38, 141824
    s_add_u32 s34, s36, 4096
    buffer_load_dwordx4 v2, s[20:23], s36 offen offset:0 sc1 lds
    buffer_load_dwordx4 v2, s[20:23], s36 offen offset:1024 sc1 lds
    buffer_load_dwordx4 v2, s[20:23], s36 offen offset:2048 sc1 lds
    buffer_load_dwordx4 v2, s[20:23], s36 offen offset:3072 sc1 lds
    s_add_u32 m0, s38, 145920
    s_add_u32 s36, s36, 10240
    buffer_load_dwordx4 v2, s[20:23], s34 offen sc1 lds
    s_add_u32 m0, s38, 152064
    s_add_u32 s34, s36, 4096
    buffer_load_dwordx4 v2, s[20:23], s36 offen offset:0 sc1 lds
    buffer_load_dwordx4 v2, s[20:23], s36 offen offset:1024 sc1 lds
    buffer_load_dwordx4 v2, s[20:23], s36 offen offset:2048 sc1 lds
    buffer_load_dwordx4 v2, s[20:23], s36 offen offset:3072 sc1 lds
    s_add_u32 m0, s38, 156160
    s_add_u32 s36, s36, 10240
    buffer_load_dwordx4 v2, s[20:23], s34 offen sc1 lds
    s_min_u32 s49, s32, 17
F5_A2:
    s_cmp_gt_u32 s43, s49
    s_cbranch_scc1 F5_B2
    s_barrier
    s_add_u32 s43, s43, 1
    s_branch F5_A2
F5_B2:
    s_add_u32 m0, s38, 0
    s_add_u32 s34, s36, 4096
    buffer_load_dwordx4 v2, s[20:23], s36 offen offset:0 sc1 lds
    buffer_load_dwordx4 v2, s[20:23], s36 offen offset:1024 sc1 lds
    buffer_load_dwordx4 v2, s[20:23], s36 offen offset:2048 sc1 lds
    buffer_load_dwordx4 v2, s[20:23], s36 offen offset:3072 sc1 lds
    s_add_u32 m0, s38, 4096
    s_add_u32 s36, s36, 10240
    buffer_load_dwordx4 v2, s[20:23], s34 offen sc1 lds
    s_min_u32 s49, s32, 17
F5_A3:
    s_cmp_gt_u32 s43, s49
    s_cbranch_scc1 F5_B3
    s_barrier
    s_add_u32 s43, s43, 1
    s_branch F5_A3
F5_B3:
    s_add_u32 m0, s38, 10240
    s_add_u32 s34, s36, 4096
    buffer_load_dwordx4 v2, s[20:23], s36 offen offset:0 sc1 lds
    buffer_load_dwordx4 v2, s[20:23], s36 offen offset:1024 sc1 lds
    buffer_load_dwordx4 v2, s[20:23], s36 offen offset:2048 sc1 lds
    buffer_load_dwordx4 v2, s[20:23], s36 offen offset:3072 sc1 lds
    s_add_u32 m0, s38, 14336
    s_add_u32 s36, s36, 10240
    buffer_load_dwordx4 v2, s[20:23], s34 offen sc1 lds
    s_min_u32 s49, s32, 18
F5_A4:
    s_cmp_gt_u32 s43, s49
    s_cbranch_scc1 F5_B4
    s_barrier
    s_add_u32 s43, s43, 1
    s_branch F5_A4
F5_B4:
    s_add_u32 m0, s38, 20480
    s_add_u32 s34, s36, 4096
    buffer_load_dwordx4 v2, s[20:23], s36 offen offset:0 sc1 lds
    buffer_load_dwordx4 v2, s[20:23], s36 offen offset:1024 sc1 lds
    buffer_load_dwordx4 v2, s[20:23], s36 offen offset:2048 sc1 lds
    buffer_load_dwordx4 v2, s[20:23], s36 offen offset:3072 sc1 lds
    s_add_u32 m0, s38, 24576
    s_add_u32 s36, s36, 10240
    buffer_load_dwordx4 v2, s[20:23], s34 offen sc1 lds
    s_min_u32 s49, s32, 18
F5_A5:
    s_cmp_gt_u32 s43, s49
    s_cbranch_scc1 F5_B5
    s_barrier
    s_add_u32 s43, s43, 1
    s_branch F5_A5
F5_B5:
    s_add_u32 m0, s38, 30720
    s_add_u32 s34, s36, 4096
    buffer_load_dwordx4 v2, s[20:23], s36 offen offset:0 sc1 lds
    buffer_load_dwordx4 v2, s[20:23], s36 offen offset:1024 sc1 lds
    buffer_load_dwordx4 v2, s[20:23], s36 offen offset:2048 sc1 lds
    buffer_load_dwordx4 v2, s[20:23], s36 offen offset:3072 sc1 lds
    s_add_u32 m0, s38, 34816
    s_add_u32 s36, s36, 10240
    buffer_load_dwordx4 v2, s[20:23], s34 offen sc1 lds
    s_min_u32 s49, s32, 21
F5_A6:
    s_cmp_gt_u32 s43, s49
    s_cbranch_scc1 F5_B6
    s_barrier
    s_add_u32 s43, s43, 1
    s_branch F5_A6
F5_B6:
    s_mov_b32 s41, 0
LC_W6:
    ds_read_b32 v7, v6 offset:0
    s_add_u32 s41, s41, 1
    s_waitcnt lgkmcnt(0)
    v_readfirstlane_b32 s42, v7
    s_cmp_ge_u32 s42, s57
    s_cbranch_scc1 LC_W6_D
    s_cmp_lt_u32 s41, 1600000
    s_cbranch_scc1 LC_W6
LC_W6_D:
    s_add_u32 m0, s38, 98304
    s_add_u32 s34, s36, 4096
    buffer_load_dwordx4 v2, s[20:23], s36 offen offset:0 sc1 lds
    buffer_load_dwordx4 v2, s[20:23], s36 offen offset:1024 sc1 lds
    buffer_load_dwordx4 v2, s[20:23], s36 offen offset:2048 sc1 lds
    buffer_load_dwordx4 v2, s[20:23], s36 offen offset:3072 sc1 lds
    s_add_u32 m0, s38, 102400
    s_add_u32 s36, s36, 10240
    buffer_load_dwordx4 v2, s[20:23], s34 offen sc1 lds
    s_min_u32 s49, s32, 21
F5_A7:
    s_cmp_gt_u32 s43, s49
    s_cbranch_scc1 F5_B7
    s_barrier
    s_add_u32 s43, s43, 1
    s_branch F5_A7
F5_B7:
    s_add_u32 m0, s38, 108544
    s_add_u32 s34, s36, 4096
    buffer_load_dwordx4 v2, s[20:23], s36 offen offset:0 sc1 lds
    buffer_load_dwordx4 v2, s[20:23], s36 offen offset:1024 sc1 lds
    buffer_load_dwordx4 v2, s[20:23], s36 offen offset:2048 sc1 lds
    buffer_load_dwordx4 v2, s[20:23], s36 offen offset:3072 sc1 lds
    s_add_u32 m0, s38, 112640
    s_add_u32 s36, s36, 10240
    buffer_load_dwordx4 v2, s[20:23], s34 offen sc1 lds
F5_D:
    s_cmp_gt_u32 s43, s32
    s_cbranch_scc1 F5_E
    s_barrier
    s_add_u32 s43, s43, 1
    s_branch F5_D
F5_E:
    s_waitcnt vmcnt(35)
    s_barrier
    s_waitcnt vmcnt(30)
    s_barrier
    s_add_u32 m0, s38, 129024
    s_nop 0
    buffer_load_dwordx4 v24, s[28:31], s5 offen lds
    s_add_u32 m0, s38, 130048
    s_nop 0
    buffer_load_dwordx4 v25, s[28:31], s5 offen lds
    s_add_u32 m0, s38, 131072
    s_nop 0
    buffer_load_dwordx4 v26, s[28:31], s5 offen lds
    s_add_u32 m0, s38, 132096
    s_nop 0
    buffer_load_dwordx4 v27, s[28:31], s5 offen lds
    s_add_u32 m0, s38, 133120
    s_nop 0
    buffer_load_dwordx4 v28, s[28:31], s5 offen lds
    s_lshl_b32 s7, s33, 8
    s_add_u32 m0, s7, 139264
    s_nop 0
    buffer_load_dword v14, s[16:19], s6 offen sc1 lds
    s_waitcnt vmcnt(31)
    s_barrier
    s_add_u32 m0, s38, 141824
    s_add_u32 s34, s36, 4096
    buffer_load_dwordx4 v2, s[20:23], s36 offen offset:0 sc1 lds
    buffer_load_dwordx4 v2, s[20:23], s36 offen offset:1024 sc1 lds
    buffer_load_dwordx4 v2, s[20:23], s36 offen offset:2048 sc1 lds
    buffer_load_dwordx4 v2, s[20:23], s36 offen offset:3072 sc1 lds
    s_add_u32 m0, s38, 145920
    s_add_u32 s36, s36, 10240
    buffer_load_dwordx4 v2, s[20:23], s34 offen sc1 lds
    s_waitcnt vmcnt(31)
    s_barrier
    s_add_u32 m0, s38, 152064
    s_add_u32 s34, s36, 4096
    buffer_load_dwordx4 v2, s[20:23], s36 offen offset:0 sc1 lds
    buffer_load_dwordx4 v2, s[20:23], s36 offen offset:1024 sc1 lds
    buffer_load_dwordx4 v2, s[20:23], s36 offen offset:2048 sc1 lds
    buffer_load_dwordx4 v2, s[20:23], s36 offen offset:3072 sc1 lds
    s_add_u32 m0, s38, 156160
    s_add_u32 s36, s36, 10240
    buffer_load_dwordx4 v2, s[20:23], s34 offen sc1 lds
    s_waitcnt vmcnt(31)
    s_barrier
    s_add_u32 m0, s38, 0
    s_add_u32 s34, s36, 4096
    buffer_load_dwordx4 v2, s[20:23], s36 offen offset:0 sc1 lds
    buffer_load_dwordx4 v2, s[20:23], s36 offen offset:1024 sc1 lds
    buffer_load_dwordx4 v2, s[20:23], s36 offen offset:2048 sc1 lds
    buffer_load_dwordx4 v2, s[20:23], s36 offen offset:3072 sc1 lds
    s_add_u32 m0, s38, 4096
    s_add_u32 s36, s36, 10240
    buffer_load_dwordx4 v2, s[20:23], s34 offen sc1 lds
    s_waitcnt vmcnt(31)
    s_barrier
    s_add_u32 m0, s38, 10240
    s_add_u32 s34, s36, 4096
    buffer_load_dwordx4 v2, s[20:23], s36 offen offset:0 sc1 lds
    buffer_load_dwordx4 v2, s[20:23], s36 offen offset:1024 sc1 lds
    buffer_load_dwordx4 v2, s[20:23], s36 offen offset:2048 sc1 lds
    buffer_load_dwordx4 v2, s[20:23], s36 offen offset:3072 sc1 lds
    s_add_u32 m0, s38, 14336
    s_add_u32 s36, s36, 10240
    buffer_load_dwordx4 v2, s[20:23], s34 offen sc1 lds
    s_waitcnt vmcnt(20)
    s_barrier
    s_add_u32 m0, s38, 20480
    s_add_u32 s34, s36, 4096
    buffer_load_dwordx4 v2, s[20:23], s36 offen offset:0 sc1 lds
    buffer_load_dwordx4 v2, s[20:23], s36 offen offset:1024 sc1 lds
    buffer_load_dwordx4 v2, s[20:23], s36 offen offset:2048 sc1 lds
    buffer_load_dwordx4 v2, s[20:23], s36 offen offset:3072 sc1 lds
    s_add_u32 m0, s38, 24576
    s_add_u32 s36, s36, 10240
    buffer_load_dwordx4 v2, s[20:23], s34 offen sc1 lds
    s_barrier
    s_add_u32 m0, s38, 30720
    s_add_u32 s34, s36, 4096
    buffer_load_dwordx4 v2, s[20:23], s36 offen offset:0 sc1 lds
    buffer_load_dwordx4 v2, s[20:23], s36 offen offset:1024 sc1 lds
    buffer_load_dwordx4 v2, s[20:23], s36 offen offset:2048 sc1 lds
    buffer_load_dwordx4 v2, s[20:23], s36 offen offset:3072 sc1 lds
    s_add_u32 m0, s38, 34816
    s_add_u32 s36, s36, 10240
    buffer_load_dwordx4 v2, s[20:23], s34 offen sc1 lds
    s_mov_b32 s58, 0
    buffer_load_dwordx2 v[10:11], v16, s[44:47], 0 offen sc1
    buffer_load_dwordx2 v[12:13], v17, s[44:47], 0 offen sc1
    s_waitcnt vmcnt(25)
    s_barrier
    s_add_u32 m0, s38, 98304
    s_add_u32 s34, s36, 4096
    buffer_load_dwordx4 v2, s[20:23], s36 offen offset:0 sc1 lds
    buffer_load_dwordx4 v2, s[20:23], s36 offen offset:1024 sc1 lds
    buffer_load_dwordx4 v2, s[20:23], s36 offen offset:2048 sc1 lds
    buffer_load_dwordx4 v2, s[20:23], s36 offen offset:3072 sc1 lds
    s_add_u32 m0, s38, 102400
    s_add_u32 s36, s36, 10240
    buffer_load_dwordx4 v2, s[20:23], s34 offen sc1 lds
    s_waitcnt vmcnt(25)
    s_barrier
    s_add_u32 m0, s38, 108544
    s_add_u32 s34, s36, 4096
    buffer_load_dwordx4 v2, s[20:23], s36 offen offset:0 sc1 lds
    buffer_load_dwordx4 v2, s[20:23], s36 offen offset:1024 sc1 lds
    buffer_load_dwordx4 v2, s[20:23], s36 offen offset:2048 sc1 lds
    buffer_load_dwordx4 v2, s[20:23], s36 offen offset:3072 sc1 lds
    s_add_u32 m0, s38, 112640
    s_add_u32 s36, s36, 10240
    buffer_load_dwordx4 v2, s[20:23], s34 offen sc1 lds
    s_cmp_lg_u32 s58, 0
    s_cbranch_scc1 YX_E9
    s_waitcnt vmcnt(10)
    s_mov_b32 s41, 0
YX_C9:
    v_cmp_ne_u64 vcc, s[100:101], v[10:11]
    v_cmp_ne_u64 s[8:9], s[100:101], v[12:13]
    s_or_b64 vcc, vcc, s[8:9]
    s_cbranch_scc0 YX_D9
    buffer_load_dwordx2 v[10:11], v16, s[44:47], 0 offen sc1
    buffer_load_dwordx2 v[12:13], v17, s[44:47], 0 offen sc1
    s_branch YX_E9
YX_D9:
    s_add_u32 m0, s38, 118784
    s_add_u32 s7, s4, 0
    buffer_load_dwordx4 v3, s[24:27], s7 offen sc1 lds
    s_add_u32 m0, s38, 119808
    s_add_u32 s7, s4, 2048
    buffer_load_dwordx4 v3, s[24:27], s7 offen sc1 lds
    s_add_u32 m0, s38, 120832
    s_add_u32 s7, s4, 4096
    buffer_load_dwordx4 v3, s[24:27], s7 offen sc1 lds
    s_add_u32 m0, s38, 121856
    s_add_u32 s7, s4, 6144
    buffer_load_dwordx4 v3, s[24:27], s7 offen sc1 lds
    s_add_u32 m0, s38, 122880
    s_add_u32 s7, s4, 8192
    buffer_load_dwordx4 v3, s[24:27], s7 offen sc1 lds
    s_mov_b32 s58, 9
YX_E9:
    s_waitcnt vmcnt(25)
    s_barrier
    s_add_u32 m0, s38, 141824
    s_add_u32 s34, s36, 4096
    buffer_load_dwordx4 v2, s[20:23], s36 offen offset:0 sc1 lds
    buffer_load_dwordx4 v2, s[20:23], s36 offen offset:1024 sc1 lds
    buffer_load_dwordx4 v2, s[20:23], s36 offen offset:2048 sc1 lds
    buffer_load_dwordx4 v2, s[20:23], s36 offen offset:3072 sc1 lds
    s_add_u32 m0, s38, 145920
    s_add_u32 s36, s36, 10240
    buffer_load_dwordx4 v2, s[20:23], s34 offen sc1 lds
    s_waitcnt vmcnt(25)
    s_barrier
    s_add_u32 m0, s38, 152064
    s_add_u32 s34, s36, 4096
    buffer_load_dwordx4 v2, s[20:23], s36 offen offset:0 sc1 lds
    buffer_load_dwordx4 v2, s[20:23], s36 offen offset:1024 sc1 lds
    buffer_load_dwordx4 v2, s[20:23], s36 offen offset:2048 sc1 lds
    buffer_load_dwordx4 v2, s[20:23], s36 offen offset:3072 sc1 lds
    s_add_u32 m0, s38, 156160
    s_add_u32 s36, s36, 10240
    buffer_load_dwordx4 v2, s[20:23], s34 offen sc1 lds
    s_cmp_lg_u32 s58, 0
    s_cbranch_scc1 YX_E11
    s_waitcnt vmcnt(10)
    s_mov_b32 s41, 0
YX_C11:
    v_cmp_ne_u64 vcc, s[100:101], v[10:11]
    v_cmp_ne_u64 s[8:9], s[100:101], v[12:13]
    s_or_b64 vcc, vcc, s[8:9]
    s_cbranch_scc0 YX_D11
    buffer_load_dwordx2 v[10:11], v16, s[44:47], 0 offen sc1
    buffer_load_dwordx2 v[12:13], v17, s[44:47], 0 offen sc1
    s_branch YX_E11
YX_D11:
    s_add_u32 m0, s38, 118784
    s_add_u32 s7, s4, 0
    buffer_load_dwordx4 v3, s[24:27], s7 offen sc1 lds
    s_add_u32 m0, s38, 119808
    s_add_u32 s7, s4, 2048
    buffer_load_dwordx4 v3, s[24:27], s7 offen sc1 lds
    s_add_u32 m0, s38, 120832
    s_add_u32 s7, s4, 4096
    buffer_load_dwordx4 v3, s[24:27], s7 offen sc1 lds
    s_add_u32 m0, s38, 121856
    s_add_u32 s7, s4, 6144
    buffer_load_dwordx4 v3, s[24:27], s7 offen sc1 lds
    s_add_u32 m0, s38, 122880
    s_add_u32 s7, s4, 8192
    buffer_load_dwordx4 v3, s[24:27], s7 offen sc1 lds
    s_mov_b32 s58, 11
YX_E11:
    s_waitcnt vmcnt(25)
    s_barrier
    s_add_u32 m0, s38, 0
    s_add_u32 s34, s36, 4096
    buffer_load_dwordx4 v2, s[20:23], s36 offen offset:0 sc1 lds
    buffer_load_dwordx4 v2, s[20:23], s36 offen offset:1024 sc1 lds
    buffer_load_dwordx4 v2, s[20:23], s36 offen offset:2048 sc1 lds
    buffer_load_dwordx4 v2, s[20:23], s36 offen offset:3072 sc1 lds
    s_add_u32 m0, s38, 4096
    s_add_u32 s36, s36, 10240
    buffer_load_dwordx4 v2, s[20:23], s34 offen sc1 lds
    s_waitcnt vmcnt(25)
    s_barrier
    s_add_u32 m0, s38, 10240
    s_add_u32 s34, s36, 4096
    buffer_load_dwordx4 v2, s[20:23], s36 offen offset:0 sc1 lds
    buffer_load_dwordx4 v2, s[20:23], s36 offen offset:1024 sc1 lds
    buffer_load_dwordx4 v2, s[20:23], s36 offen offset:2048 sc1 lds
    buffer_load_dwordx4 v2, s[20:23], s36 offen offset:3072 sc1 lds
    s_add_u32 m0, s38, 14336
    s_add_u32 s36, s36, 10240
    buffer_load_dwordx4 v2, s[20:23], s34 offen sc1 lds
    s_cmp_lg_u32 s58, 0
    s_cbranch_scc1 YX_E13
    s_waitcnt vmcnt(10)
    s_mov_b32 s41, 0
YX_C13:
    v_cmp_ne_u64 vcc, s[100:101], v[10:11]
    v_cmp_ne_u64 s[8:9], s[100:101], v[12:13]
    s_or_b64 vcc, vcc, s[8:9]
    s_cbranch_scc0 YX_D13
    buffer_load_dwordx2 v[10:11], v16, s[44:47], 0 offen sc1
    buffer_load_dwordx2 v[12:13], v17, s[44:47], 0 offen sc1
    s_add_u32 s41, s41, 1
    s_waitcnt vmcnt(0)
    s_cmp_lt_u32 s41, 100000
    s_cbranch_scc1 YX_C13
YX_D13:
    s_add_u32 m0, s38, 118784
    s_add_u32 s7, s4, 0
    buffer_load_dwordx4 v3, s[24:27], s7 offen sc1 lds
    s_add_u32 m0, s38, 119808
    s_add_u32 s7, s4, 2048
    buffer_load_dwordx4 v3, s[24:27], s7 offen sc1 lds
    s_add_u32 m0, s38, 120832
    s_add_u32 s7, s4, 4096
    buffer_load_dwordx4 v3, s[24:27], s7 offen sc1 lds
    s_add_u32 m0, s38, 121856
    s_add_u32 s7, s4, 6144
    buffer_load_dwordx4 v3, s[24:27], s7 offen sc1 lds
    s_add_u32 m0, s38, 122880
    s_add_u32 s7, s4, 8192
    buffer_load_dwordx4 v3, s[24:27], s7 offen sc1 lds
    s_mov_b32 s58, 13
YX_E13:
    s_waitcnt vmcnt(25)
    s_barrier
    s_add_u32 m0, s38, 20480
    s_add_u32 s34, s36, 4096
    buffer_load_dwordx4 v2, s[20:23], s36 offen offset:0 sc1 lds
    buffer_load_dwordx4 v2, s[20:23], s36 offen offset:1024 sc1 lds
    buffer_load_dwordx4 v2, s[20:23], s36 offen offset:2048 sc1 lds
    buffer_load_dwordx4 v2, s[20:23], s36 offen offset:3072 sc1 lds
    s_add_u32 m0, s38, 24576
    s_add_u32 s36, s36, 10240
    buffer_load_dwordx4 v2, s[20:23], s34 offen sc1 lds
    s_waitcnt vmcnt(25)
    s_barrier
    s_add_u32 m0, s38, 30720
    s_add_u32 s34, s36, 4096
    buffer_load_dwordx4 v2, s[20:23], s36 offen offset:0 sc1 lds
    buffer_load_dwordx4 v2, s[20:23], s36 offen offset:1024 sc1 lds
    buffer_load_dwordx4 v2, s[20:23], s36 offen offset:2048 sc1 lds
    buffer_load_dwordx4 v2, s[20:23], s36 offen offset:3072 sc1 lds
    s_add_u32 m0, s38, 34816
    s_add_u32 s36, s36, 10240
    buffer_load_dwordx4 v2, s[20:23], s34 offen sc1 lds
    s_waitcnt vmcnt(25)
    s_barrier
    s_add_u32 m0, s38, 98304
    s_add_u32 s34, s36, 4096
    buffer_load_dwordx4 v2, s[20:23], s36 offen offset:0 sc1 lds
    buffer_load_dwordx4 v2, s[20:23], s36 offen offset:1024 sc1 lds
    buffer_load_dwordx4 v2, s[20:23], s36 offen offset:2048 sc1 lds
    buffer_load_dwordx4 v2, s[20:23], s36 offen offset:3072 sc1 lds
    s_add_u32 m0, s38, 102400
    s_add_u32 s36, s36, 10240
    buffer_load_dwordx4 v2, s[20:23], s34 offen sc1 lds
    s_waitcnt vmcnt(15)
    s_waitcnt vmcnt(25)
    s_barrier
    s_add_u32 m0, s38, 108544
    s_add_u32 s34, s36, 4096
    buffer_load_dwordx4 v2, s[20:23], s36 offen offset:0 sc1 lds
    buffer_load_dwordx4 v2, s[20:23], s36 offen offset:1024 sc1 lds
    buffer_load_dwordx4 v2, s[20:23], s36 offen offset:2048 sc1 lds
    buffer_load_dwordx4 v2, s[20:23], s36 offen offset:3072 sc1 lds
    s_add_u32 m0, s38, 112640
    s_add_u32 s36, s36, 10240
    buffer_load_dwordx4 v2, s[20:23], s34 offen sc1 lds
    s_waitcnt vmcnt(25)
    s_barrier
    s_add_u32 m0, s38, 141824
    s_add_u32 s34, s36, 4096
    buffer_load_dwordx4 v2, s[20:23], s36 offen offset:0 sc1 lds
    buffer_load_dwordx4 v2, s[20:23], s36 offen offset:1024 sc1 lds
    buffer_load_dwordx4 v2, s[20:23], s36 offen offset:2048 sc1 lds
    buffer_load_dwordx4 v2, s[20:23], s36 offen offset:3072 sc1 lds
    s_add_u32 m0, s38, 145920
    s_add_u32 s36, s36, 10240
    buffer_load_dwordx4 v2, s[20:23], s34 offen sc1 lds
    s_waitcnt vmcnt(25)
    s_barrier
    s_add_u32 m0, s38, 152064
    s_add_u32 s34, s36, 4096
    buffer_load_dwordx4 v2, s[20:23], s36 offen offset:0 sc1 lds
    buffer_load_dwordx4 v2, s[20:23], s36 offen offset:1024 sc1 lds
    buffer_load_dwordx4 v2, s[20:23], s36 offen offset:2048 sc1 lds
    buffer_load_dwordx4 v2, s[20:23], s36 offen offset:3072 sc1 lds
    s_add_u32 m0, s38, 156160
    s_add_u32 s36, s36, 10240
    buffer_load_dwordx4 v2, s[20:23], s34 offen sc1 lds
    s_waitcnt vmcnt(25)
    s_barrier
    s_add_u32 m0, s38, 0
    s_add_u32 s34, s36, 4096
    buffer_load_dwordx4 v2, s[20:23], s36 offen offset:0 sc1 lds
    buffer_load_dwordx4 v2, s[20:23], s36 offen offset:1024 sc1 lds
    buffer_load_dwordx4 v2, s[20:23], s36 offen offset:2048 sc1 lds
    buffer_load_dwordx4 v2, s[20:23], s36 offen offset:3072 sc1 lds
    s_add_u32 m0, s38, 4096
    s_add_u32 s36, s36, 10240
    buffer_load_dwordx4 v2, s[20:23], s34 offen sc1 lds
    s_waitcnt vmcnt(25)
    s_barrier
    s_waitcnt vmcnt(20)
    s_barrier
    s_waitcnt vmcnt(15)
    s_barrier
    s_waitcnt vmcnt(10)
    s_barrier
    s_waitcnt vmcnt(5)
    s_barrier
    s_waitcnt vmcnt(0)
    s_barrier
    s_endpgm
F3_END:
.section .rodata,"a"
.p2align 6
.amdhsa_kernel mid_kernel
  .amdhsa_next_free_vgpr 128
  .amdhsa_next_free_sgpr 102
  .amdhsa_accum_offset 128
  .amdhsa_group_segment_fixed_size 0
  .amdhsa_kernarg_size 104
  .amdhsa_user_sgpr_count 2
  .amdhsa_user_sgpr_kernarg_segment_ptr 1
  .amdhsa_system_sgpr_workgroup_id_x 1
.end_amdhsa_kernel
```
